```python
import torch

def _softmax(x, axis=-1):
    return torch.softmax(x, dim=axis)
def _gelu(x):
    return torch.nn.functional.gelu(x, approximate="tanh")
def _silu(x):
    return torch.nn.functional.silu(x)
def _sigmoid(x):
    return torch.sigmoid(x)
def _layernorm(x, axis=-1, eps=1e-5):
    m = x.mean(dim=axis, keepdim=True)
    v = x.var(dim=axis, keepdim=True, unbiased=False)
    return (x - m) / torch.sqrt(v + eps)
def _scatter_add(tgt, idx, src, axis=0):
    return tgt.clone().index_add_(axis, idx, src)
def _segment_sum(src, seg, n):
    out = torch.zeros((n,) + src.shape[1:], dtype=src.dtype)
    return out.index_add_(0, seg, src)
def _pad(x, pw):
    flat = tuple(v for pair in reversed(pw) for v in pair)
    return torch.nn.functional.pad(x, flat)

kernel_name = 'recurrent_scan__gqa_block_cached__mixer_channel_mlp__prompt'

def setup_inputs():

    _w = (lambda a: (lambda t: t.to(torch.bfloat16) if t.is_floating_point() else t)(torch.as_tensor(a)))
    def _A_setup():
        B, Sq, D = 1, 2048, 640
        Hq, Hkv, Sk, Dh = 32, 32, 2048, 128
        assert Hq % Hkv == 0, (Hq, Hkv)
        return {
            "x": _w((lambda *s: torch.randn(*s, dtype=torch.bfloat16) * 0.05)(B, Sq, D)),
            "k_cache": _w((lambda *s: torch.randn(*s, dtype=torch.bfloat16) * 1.6)(B, Hkv, Sk, Dh)),
            "v_cache": _w((lambda *s: torch.randn(*s, dtype=torch.bfloat16) * 0.8)(B, Hkv, Sk, Dh)),
            "wq": _w((lambda *s: torch.randn(*s, dtype=torch.bfloat16) * 1.6)(D, Hq * Dh) * (D ** -0.5)),
            "wo": _w((lambda *s: torch.randn(*s, dtype=torch.bfloat16) * 0.8)(Hq * Dh, D) * ((Hq * Dh) ** -0.5)),
        }
    _A_in = _A_setup()

    def _B_setup():
        B, S, D, F = 1, 2048, 640, 1728
        return {
            "x": _w((lambda *s: torch.randn(*s, dtype=torch.bfloat16) * 0.05)(B, S, D)),
            "w1": _w((lambda *s: torch.randn(*s, dtype=torch.bfloat16) * 3.2)(D, F) * (D ** -0.5)),
            "b1": _w((lambda *s: torch.randn(*s, dtype=torch.bfloat16) * 1.6)(F)),
            "w2": _w((lambda *s: torch.randn(*s, dtype=torch.bfloat16) * 0.2)(F, D) * (F ** -0.5)),
            "b2": _w((lambda *s: torch.randn(*s, dtype=torch.bfloat16) * 0.2)(D)),
        }
    _B_in = _B_setup()

    return {
        "A_x": _A_in["x"],
        "A_k_cache": _A_in["k_cache"],
        "A_v_cache": _A_in["v_cache"],
        "A_wq": _A_in["wq"],
        "A_wo": _A_in["wo"],
        "B_x": _B_in["x"],
        "B_w1": _B_in["w1"],
        "B_b1": _B_in["b1"],
        "B_w2": _B_in["w2"],
        "B_b2": _B_in["b2"],
    }

def reference(A_x, A_k_cache, A_v_cache, A_wq, A_wo, B_x, B_w1, B_b1, B_w2, B_b2):
    def _A_ref(x, k_cache, v_cache, wq, wo):
        B, Sq, D = x.shape
        Hq, Dh = 32, 128
        Hkv = k_cache.shape[1]
        rep = Hq // Hkv
        q = (lambda x, *d: x.permute(*d))((x @ wq).reshape(B, Sq, Hq, Dh), 0, 2, 1, 3)
        k = (lambda x, n, axis: torch.repeat_interleave(x, n, dim=axis))(k_cache, rep, axis=1)
        v = (lambda x, n, axis: torch.repeat_interleave(x, n, dim=axis))(v_cache, rep, axis=1)
        scores = torch.einsum("bhqd,bhkd->bhqk", q, k) * (Dh ** -0.5)
        p = _softmax(scores, axis=-1)
        o = torch.einsum("bhqk,bhkd->bhqd", p, v)
        return (lambda x, *d: x.permute(*d))(o, 0, 2, 1, 3).reshape(B, Sq, Hq * Dh) @ wo

    def _B_ref(x, w1, b1, w2, b2):
        y = _layernorm(x, axis=-1)
        h = _gelu(torch.einsum("bsd,df->bsf", y, w1) + b1)
        return torch.einsum("bsf,fd->bsd", h, w2) + b2

    x = A_x
    xn = _layernorm(x, axis=-1)
    s = _A_ref(xn, A_k_cache, A_v_cache, A_wq, A_wo)
    g = _silu(_B_ref(xn, B_w1, B_b1, B_w2, B_b2))
    return x + s * g
```

```asm
; @launch grid=(256,1,1) block=(256,1,1) lds=163840
.amdgcn_target "amdgcn-amd-amdhsa--gfx950"
.text
.globl recurrent_scan__gqa_block_cached__mixer_channel_mlp__prompt_kernel
.p2align 8
.type recurrent_scan__gqa_block_cached__mixer_channel_mlp__prompt_kernel,@function
recurrent_scan__gqa_block_cached__mixer_channel_mlp__prompt_kernel:
    s_load_dwordx2 s[76:77], s[0:1], 0
    s_load_dwordx2 s[64:65], s[0:1], 0x60
    s_load_dwordx2 s[62:63], s[0:1], 0x58
    s_load_dwordx2 s[70:71], s[0:1], 24
    s_load_dwordx2 s[72:73], s[0:1], 48
    s_load_dwordx2 s[66:67], s[0:1], 8
    s_load_dwordx2 s[68:69], s[0:1], 16
    s_load_dwordx2 s[74:75], s[0:1], 56
    s_memrealtime s[100:101]
    s_cmp_ge_u32 s2, 0x100
    s_cbranch_scc1 FZ_end
    s_and_b32 s54, s2, 7
    s_lshl_b32 s54, s54, 2
    s_bfe_u32 s55, s2, 0x20003
    s_add_u32 s39, s54, s55
    s_lshr_b32 s40, s2, 5
    v_and_b32 v200, 63, v0
    v_lshrrev_b32 v201, 6, v0
    v_lshrrev_b32 v106, 4, v0
    v_readfirstlane_b32 s41, v201
    s_lshl_b32 s3, s2, 3
    v_add_u32 v106, s3, v106
    v_and_b32 v107, 15, v0
    v_mul_u32_u24 v102, 0x500, v106
    v_lshl_add_u32 v102, v107, 4, v102
    s_lshl_b32 s54, s40, 5
    s_and_b32 s55, s2, 31
    s_cmp_eq_u32 s55, 0
    s_cselect_b32 s55, s54, 0x40000000
    v_mov_b32 v202, 0x40000000
    v_mov_b32 v203, s55
    v_cmp_eq_u32 vcc, 0, v0
    s_waitcnt lgkmcnt(0)
    s_nop 1
    v_cndmask_b32 v202, v202, v203, vcc
    s_and_b32 s100, s100, 0x7ffffff8
    s_or_b32 s100, s100, 0x80000000
    s_mov_b32 s32, s62
    s_mov_b32 s33, s63
    s_mov_b32 s34, 0x100
    s_mov_b32 s35, 0x20000
    v_mov_b32 v203, s100
    buffer_store_dword v203, v202, s[32:35], 0 offen sc1
    s_mov_b32 s24, s76
    s_mov_b32 s25, s77
    s_mov_b32 s26, 0x280000
    s_mov_b32 s27, 0x20000
    s_cmp_ge_u32 s41, 2
    s_cbranch_scc1 FZ_nox
    buffer_load_dwordx4 v[72:75], v102, s[24:27], 0 offen offset:0
    buffer_load_dwordx4 v[76:79], v102, s[24:27], 0 offen offset:256
    buffer_load_dwordx4 v[80:83], v102, s[24:27], 0 offen offset:512
    buffer_load_dwordx4 v[84:87], v102, s[24:27], 0 offen offset:768
    buffer_load_dwordx4 v[88:91], v102, s[24:27], 0 offen offset:1024
FZ_nox:
    v_lshrrev_b32 v202, 4, v200
    v_and_b32 v203, 15, v200
    v_lshlrev_b32 v204, 2, v202
    v_xor_b32 v204, v203, v204
    v_lshlrev_b32 v204, 4, v204
    v_lshl_add_u32 v205, v201, 3, v202
    v_lshl_add_u32 v204, v205, 13, v204
    s_lshl_b32 s54, s39, 8
    v_add_u32 v17, s54, v204
    v_add_u32 v18, 0x7c00, v17
    v_lshrrev_b32 v204, 3, v200
    v_lshl_add_u32 v204, v201, 3, v204
    v_mul_u32_u24 v19, 0xd80, v204
    v_and_b32 v204, 1, v202
    v_and_b32 v205, 1, v201
    v_lshl_add_u32 v204, v205, 1, v204
    v_lshlrev_b32 v204, 1, v204
    v_and_b32 v205, 7, v200
    v_xor_b32 v204, v204, v205
    v_lshl_add_u32 v19, v204, 4, v19
    s_lshl_b32 s54, s39, 7
    v_add_u32 v19, s54, v19
    s_mov_b32 s12, s70
    s_mov_b32 s13, s71
    s_mov_b32 s14, 0x500000
    s_mov_b32 s15, 0x20000
    s_mov_b32 s16, s72
    s_mov_b32 s17, s73
    s_mov_b32 s18, 0x21c000
    s_mov_b32 s19, 0x20000
    s_cmp_lt_u32 s39, 27
    s_cselect_b32 s18, 0x21c000, 0
    s_lshl_b32 s54, s41, 11
    s_add_u32 s47, s54, 0x1c000
    s_mov_b32 s37, s54
    s_add_u32 s38, s54, 0x10000
    s_lshl_b32 s54, s41, 10
    s_add_u32 s48, s54, 0x1e000
    s_mov_b32 s44, 0
    s_mov_b32 s45, 0
    s_mov_b32 s46, 0
    s_add_u32 m0, s47, 0
    s_nop 0
    buffer_load_dwordx4 v17, s[12:15], s44 offen offset:0 lds
    buffer_load_dwordx4 v18, s[12:15], s44 offen offset:1024 lds
    s_add_u32 m0, s48, 0
    s_add_u32 s44, s44, 0x40000
    buffer_load_dwordx4 v19, s[16:19], s45 offen lds
    s_add_u32 s45, s45, 0x1b000
    s_add_u32 m0, s47, 0x3000
    s_nop 0
    buffer_load_dwordx4 v17, s[12:15], s44 offen offset:0 lds
    buffer_load_dwordx4 v18, s[12:15], s44 offen offset:1024 lds
    s_add_u32 m0, s48, 0x3000
    s_add_u32 s44, s44, 0x40000
    buffer_load_dwordx4 v19, s[16:19], s45 offen lds
    s_add_u32 s45, s45, 0x1b000
    s_add_u32 m0, s47, 0x6000
    s_nop 0
    buffer_load_dwordx4 v17, s[12:15], s44 offen offset:0 lds
    buffer_load_dwordx4 v18, s[12:15], s44 offen offset:1024 lds
    s_add_u32 m0, s48, 0x6000
    s_add_u32 s44, s44, 0x40000
    buffer_load_dwordx4 v19, s[16:19], s45 offen lds
    s_add_u32 s45, s45, 0x1b000
    s_lshl_b32 s54, s40, 4
    s_lshl_b32 s55, s41, 2
    s_add_u32 s42, s54, s55
    s_lshl_b32 s54, s42, 10
    v_lshlrev_b32 v20, 4, v200
    v_add_u32 v20, s54, v20
    s_add_u32 s20, s64, 0
    s_addc_u32 s21, s65, 0
    s_mov_b32 s22, 0x280000
    s_mov_b32 s23, 0x20000
    s_add_u32 s96, s64, 0x3800000
    s_addc_u32 s97, s65, 0
    s_mov_b32 s98, 0x8000
    s_mov_b32 s99, 0x20000
    v_lshrrev_b32 v202, 2, v107
    v_lshlrev_b32 v103, 17, v202
    v_lshrrev_b32 v202, 4, v106
    v_lshl_add_u32 v103, v202, 10, v103
    v_and_b32 v202, 3, v107
    v_lshl_add_u32 v103, v202, 8, v103
    v_and_b32 v202, 15, v106
    v_lshl_add_u32 v103, v202, 4, v103
    s_lshl_b32 s54, s39, 19
    s_add_u32 s4, s66, s54
    s_addc_u32 s5, s67, 0
    s_mov_b32 s6, 0x80000
    s_mov_b32 s7, 0x20000
    s_add_u32 s8, s68, s54
    s_addc_u32 s9, s69, 0
    s_mov_b32 s10, 0x80000
    s_mov_b32 s11, 0x20000
    v_lshrrev_b32 v202, 4, v200
    v_lshl_add_u32 v202, v201, 3, v202
    v_and_b32 v203, 15, v200
    v_add_u32 v205, 0, v202
    v_and_b32 v204, 15, v205
    v_xor_b32 v204, v203, v204
    v_lshlrev_b32 v204, 4, v204
    v_lshl_add_u32 v1, v202, 8, v204
    v_and_b32 v204, 7, v205
    v_lshlrev_b32 v204, 1, v204
    v_xor_b32 v204, v203, v204
    v_lshlrev_b32 v204, 4, v204
    v_lshl_add_u32 v3, v202, 8, v204
    v_add_u32 v205, 4, v202
    v_and_b32 v204, 15, v205
    v_xor_b32 v204, v203, v204
    v_lshlrev_b32 v204, 4, v204
    v_lshl_add_u32 v2, v202, 8, v204
    v_and_b32 v204, 7, v205
    v_lshlrev_b32 v204, 1, v204
    v_xor_b32 v204, v203, v204
    v_lshlrev_b32 v204, 4, v204
    v_lshl_add_u32 v4, v202, 8, v204
    v_lshrrev_b32 v202, 4, v200
    v_xor_b32 v204, v202, v203
    v_lshlrev_b32 v204, 4, v204
    v_lshl_add_u32 v5, v203, 8, v204
    v_xor_b32 v6, 64, v5
    v_xor_b32 v7, 0x80, v5
    v_xor_b32 v8, 0xc0, v5
    v_lshrrev_b32 v204, 2, v203
    v_lshl_add_u32 v204, v202, 2, v204
    v_and_b32 v205, 7, v204
    v_lshlrev_b32 v205, 5, v205
    v_lshl_add_u32 v205, v204, 8, v205
    v_and_b32 v204, 3, v203
    v_lshl_add_u32 v205, v204, 3, v205
    v_add_u32 v9, 0x10000, v205
    v_xor_b32 v10, 32, v9
    v_xor_b32 v11, 64, v9
    v_xor_b32 v12, 0x60, v9
    v_xor_b32 v13, 0x80, v9
    v_xor_b32 v14, 0xa0, v9
    v_xor_b32 v15, 0xc0, v9
    v_xor_b32 v16, 0xe0, v9
    v_lshrrev_b32 v202, 4, v200
    v_bfe_u32 v203, v200, 2, 2
    v_and_b32 v204, 3, v200
    v_lshl_add_u32 v205, v202, 3, v203
    v_lshlrev_b32 v21, 8, v205
    v_lshl_add_u32 v21, v203, 6, v21
    v_lshl_add_u32 v21, v204, 4, v21
    v_add_u32 v21, 0x1c000, v21
    v_xor_b32 v22, 64, v21
    v_xor_b32 v23, 0x80, v21
    v_xor_b32 v24, 0xc0, v21
    v_lshlrev_b32 v25, 7, v205
    v_lshl_add_u32 v25, v204, 3, v25
    v_lshrrev_b32 v203, 1, v203
    v_and_b32 v202, 1, v202
    v_lshl_add_u32 v203, v202, 1, v203
    v_lshl_add_u32 v25, v203, 5, v25
    v_add_u32 v25, 0x1e000, v25
    v_xor_b32 v26, 32, v25
    v_xor_b32 v27, 64, v25
    v_xor_b32 v28, 0x60, v25
    s_mov_b32 s50, s37
    s_mov_b32 s51, s38
    s_mov_b32 s36, 0
    s_mov_b32 s49, 5
    s_mov_b32 s52, 0x3e0293ee
    s_mov_b32 s53, 0x3e0293ee
    s_cmp_ge_u32 s41, 2
    s_cbranch_scc1 FZ_noln
    s_mov_b32 s56, 0x3acccccd
    s_mov_b32 s57, 0x3727c5ac
    s_mov_b32 s58, 0x80000
    s_mov_b32 s59, 0x100000
    s_mov_b32 s60, 0x180000
    s_mov_b32 s61, 0x200000
    s_waitcnt vmcnt(9)
    v_lshlrev_b32 v32, 16, v72
    v_and_b32 v33, 0xffff0000, v72
    v_lshlrev_b32 v34, 16, v73
    v_and_b32 v35, 0xffff0000, v73
    v_lshlrev_b32 v36, 16, v74
    v_and_b32 v37, 0xffff0000, v74
    v_lshlrev_b32 v38, 16, v75
    v_and_b32 v39, 0xffff0000, v75
    v_lshlrev_b32 v40, 16, v76
    v_and_b32 v41, 0xffff0000, v76
    v_lshlrev_b32 v42, 16, v77
    v_and_b32 v43, 0xffff0000, v77
    v_lshlrev_b32 v44, 16, v78
    v_and_b32 v45, 0xffff0000, v78
    v_lshlrev_b32 v46, 16, v79
    v_and_b32 v47, 0xffff0000, v79
    v_lshlrev_b32 v48, 16, v80
    v_and_b32 v49, 0xffff0000, v80
    v_lshlrev_b32 v50, 16, v81
    v_and_b32 v51, 0xffff0000, v81
    v_lshlrev_b32 v52, 16, v82
    v_and_b32 v53, 0xffff0000, v82
    v_lshlrev_b32 v54, 16, v83
    v_and_b32 v55, 0xffff0000, v83
    v_lshlrev_b32 v56, 16, v84
    v_and_b32 v57, 0xffff0000, v84
    v_lshlrev_b32 v58, 16, v85
    v_and_b32 v59, 0xffff0000, v85
    v_lshlrev_b32 v60, 16, v86
    v_and_b32 v61, 0xffff0000, v86
    v_lshlrev_b32 v62, 16, v87
    v_and_b32 v63, 0xffff0000, v87
    v_lshlrev_b32 v64, 16, v88
    v_and_b32 v65, 0xffff0000, v88
    v_lshlrev_b32 v66, 16, v89
    v_and_b32 v67, 0xffff0000, v89
    v_lshlrev_b32 v68, 16, v90
    v_and_b32 v69, 0xffff0000, v90
    v_lshlrev_b32 v70, 16, v91
    v_and_b32 v71, 0xffff0000, v91
    v_pk_add_f32 v[92:93], v[32:33], v[36:37]
    v_pk_add_f32 v[104:105], v[34:35], v[38:39]
    v_pk_add_f32 v[92:93], v[92:93], v[40:41]
    v_pk_add_f32 v[104:105], v[104:105], v[42:43]
    v_pk_add_f32 v[92:93], v[92:93], v[44:45]
    v_pk_add_f32 v[104:105], v[104:105], v[46:47]
    v_pk_add_f32 v[92:93], v[92:93], v[48:49]
    v_pk_add_f32 v[104:105], v[104:105], v[50:51]
    v_pk_add_f32 v[92:93], v[92:93], v[52:53]
    v_pk_add_f32 v[104:105], v[104:105], v[54:55]
    v_pk_add_f32 v[92:93], v[92:93], v[56:57]
    v_pk_add_f32 v[104:105], v[104:105], v[58:59]
    v_pk_add_f32 v[92:93], v[92:93], v[60:61]
    v_pk_add_f32 v[104:105], v[104:105], v[62:63]
    v_pk_add_f32 v[92:93], v[92:93], v[64:65]
    v_pk_add_f32 v[104:105], v[104:105], v[66:67]
    v_pk_add_f32 v[92:93], v[92:93], v[68:69]
    v_pk_add_f32 v[104:105], v[104:105], v[70:71]
    v_pk_add_f32 v[92:93], v[92:93], v[104:105]
    v_add_f32 v94, v92, v93
    s_nop 1
    v_add_f32_dpp v94, v94, v94 row_ror:8 row_mask:0xf bank_mask:0xf
    s_nop 1
    v_add_f32_dpp v94, v94, v94 row_ror:4 row_mask:0xf bank_mask:0xf
    s_nop 1
    v_add_f32_dpp v94, v94, v94 row_ror:2 row_mask:0xf bank_mask:0xf
    s_nop 1
    v_add_f32_dpp v94, v94, v94 row_ror:1 row_mask:0xf bank_mask:0xf
    v_mul_f32 v94, s56, v94
    v_pk_add_f32 v[100:101], v[32:33], v[94:95] op_sel_hi:[1,0] neg_lo:[0,1] neg_hi:[0,1]
    v_pk_mul_f32 v[92:93], v[100:101], v[100:101]
    v_pk_add_f32 v[110:111], v[34:35], v[94:95] op_sel_hi:[1,0] neg_lo:[0,1] neg_hi:[0,1]
    v_pk_mul_f32 v[104:105], v[110:111], v[110:111]
    v_pk_add_f32 v[100:101], v[36:37], v[94:95] op_sel_hi:[1,0] neg_lo:[0,1] neg_hi:[0,1]
    v_pk_fma_f32 v[92:93], v[100:101], v[100:101], v[92:93]
    v_pk_add_f32 v[110:111], v[38:39], v[94:95] op_sel_hi:[1,0] neg_lo:[0,1] neg_hi:[0,1]
    v_pk_fma_f32 v[104:105], v[110:111], v[110:111], v[104:105]
    v_pk_add_f32 v[100:101], v[40:41], v[94:95] op_sel_hi:[1,0] neg_lo:[0,1] neg_hi:[0,1]
    v_pk_fma_f32 v[92:93], v[100:101], v[100:101], v[92:93]
    v_pk_add_f32 v[110:111], v[42:43], v[94:95] op_sel_hi:[1,0] neg_lo:[0,1] neg_hi:[0,1]
    v_pk_fma_f32 v[104:105], v[110:111], v[110:111], v[104:105]
    v_pk_add_f32 v[100:101], v[44:45], v[94:95] op_sel_hi:[1,0] neg_lo:[0,1] neg_hi:[0,1]
    v_pk_fma_f32 v[92:93], v[100:101], v[100:101], v[92:93]
    v_pk_add_f32 v[110:111], v[46:47], v[94:95] op_sel_hi:[1,0] neg_lo:[0,1] neg_hi:[0,1]
    v_pk_fma_f32 v[104:105], v[110:111], v[110:111], v[104:105]
    v_pk_add_f32 v[100:101], v[48:49], v[94:95] op_sel_hi:[1,0] neg_lo:[0,1] neg_hi:[0,1]
    v_pk_fma_f32 v[92:93], v[100:101], v[100:101], v[92:93]
    v_pk_add_f32 v[110:111], v[50:51], v[94:95] op_sel_hi:[1,0] neg_lo:[0,1] neg_hi:[0,1]
    v_pk_fma_f32 v[104:105], v[110:111], v[110:111], v[104:105]
    v_pk_add_f32 v[100:101], v[52:53], v[94:95] op_sel_hi:[1,0] neg_lo:[0,1] neg_hi:[0,1]
    v_pk_fma_f32 v[92:93], v[100:101], v[100:101], v[92:93]
    v_pk_add_f32 v[110:111], v[54:55], v[94:95] op_sel_hi:[1,0] neg_lo:[0,1] neg_hi:[0,1]
    v_pk_fma_f32 v[104:105], v[110:111], v[110:111], v[104:105]
    v_pk_add_f32 v[100:101], v[56:57], v[94:95] op_sel_hi:[1,0] neg_lo:[0,1] neg_hi:[0,1]
    v_pk_fma_f32 v[92:93], v[100:101], v[100:101], v[92:93]
    v_pk_add_f32 v[110:111], v[58:59], v[94:95] op_sel_hi:[1,0] neg_lo:[0,1] neg_hi:[0,1]
    v_pk_fma_f32 v[104:105], v[110:111], v[110:111], v[104:105]
    v_pk_add_f32 v[100:101], v[60:61], v[94:95] op_sel_hi:[1,0] neg_lo:[0,1] neg_hi:[0,1]
    v_pk_fma_f32 v[92:93], v[100:101], v[100:101], v[92:93]
    v_pk_add_f32 v[110:111], v[62:63], v[94:95] op_sel_hi:[1,0] neg_lo:[0,1] neg_hi:[0,1]
    v_pk_fma_f32 v[104:105], v[110:111], v[110:111], v[104:105]
    v_pk_add_f32 v[100:101], v[64:65], v[94:95] op_sel_hi:[1,0] neg_lo:[0,1] neg_hi:[0,1]
    v_pk_fma_f32 v[92:93], v[100:101], v[100:101], v[92:93]
    v_pk_add_f32 v[110:111], v[66:67], v[94:95] op_sel_hi:[1,0] neg_lo:[0,1] neg_hi:[0,1]
    v_pk_fma_f32 v[104:105], v[110:111], v[110:111], v[104:105]
    v_pk_add_f32 v[100:101], v[68:69], v[94:95] op_sel_hi:[1,0] neg_lo:[0,1] neg_hi:[0,1]
    v_pk_fma_f32 v[92:93], v[100:101], v[100:101], v[92:93]
    v_pk_add_f32 v[110:111], v[70:71], v[94:95] op_sel_hi:[1,0] neg_lo:[0,1] neg_hi:[0,1]
    v_pk_fma_f32 v[104:105], v[110:111], v[110:111], v[104:105]
    v_pk_add_f32 v[92:93], v[92:93], v[104:105]
    v_add_f32 v98, v92, v93
    s_nop 1
    v_add_f32_dpp v98, v98, v98 row_ror:8 row_mask:0xf bank_mask:0xf
    s_nop 1
    v_add_f32_dpp v98, v98, v98 row_ror:4 row_mask:0xf bank_mask:0xf
    s_nop 1
    v_add_f32_dpp v98, v98, v98 row_ror:2 row_mask:0xf bank_mask:0xf
    s_nop 1
    v_add_f32_dpp v98, v98, v98 row_ror:1 row_mask:0xf bank_mask:0xf
    v_mul_f32 v98, s56, v98
    v_mov_b32 v108, v98
    v_mov_b32 v96, v94
    v_cvt_pk_bf16_f32 v95, v96, v96
    v_lshlrev_b32 v96, 16, v95
    v_cvt_pk_bf16_f32 v95, v98, v98
    v_lshlrev_b32 v98, 16, v95
    v_add_f32 v98, s57, v98
    v_cvt_pk_bf16_f32 v95, v98, v98
    v_lshlrev_b32 v98, 16, v95
    v_sqrt_f32 v98, v98
    s_nop 0
    v_cvt_pk_bf16_f32 v95, v98, v98
    v_lshlrev_b32 v98, 16, v95
    v_rcp_f32 v98, v98
    v_pk_add_f32 v[100:101], v[32:33], v[96:97] op_sel_hi:[1,0] neg_lo:[0,1] neg_hi:[0,1]
    v_pk_add_f32 v[110:111], v[34:35], v[96:97] op_sel_hi:[1,0] neg_lo:[0,1] neg_hi:[0,1]
    v_cvt_pk_bf16_f32 v95, v100, v101
    v_cvt_pk_bf16_f32 v109, v110, v111
    v_lshlrev_b32 v100, 16, v95
    v_and_b32 v101, 0xffff0000, v95
    v_lshlrev_b32 v110, 16, v109
    v_and_b32 v111, 0xffff0000, v109
    v_pk_mul_f32 v[100:101], v[100:101], v[98:99] op_sel_hi:[1,0]
    v_pk_mul_f32 v[110:111], v[110:111], v[98:99] op_sel_hi:[1,0]
    v_cvt_pk_bf16_f32 v72, v100, v101
    v_cvt_pk_bf16_f32 v73, v110, v111
    v_pk_add_f32 v[100:101], v[36:37], v[96:97] op_sel_hi:[1,0] neg_lo:[0,1] neg_hi:[0,1]
    v_pk_add_f32 v[110:111], v[38:39], v[96:97] op_sel_hi:[1,0] neg_lo:[0,1] neg_hi:[0,1]
    v_cvt_pk_bf16_f32 v95, v100, v101
    v_cvt_pk_bf16_f32 v109, v110, v111
    v_lshlrev_b32 v100, 16, v95
    v_and_b32 v101, 0xffff0000, v95
    v_lshlrev_b32 v110, 16, v109
    v_and_b32 v111, 0xffff0000, v109
    v_pk_mul_f32 v[100:101], v[100:101], v[98:99] op_sel_hi:[1,0]
    v_pk_mul_f32 v[110:111], v[110:111], v[98:99] op_sel_hi:[1,0]
    v_cvt_pk_bf16_f32 v74, v100, v101
    v_cvt_pk_bf16_f32 v75, v110, v111
    buffer_store_dwordx4 v[72:75], v103, s[20:23], 0 offen sc1
    v_pk_add_f32 v[100:101], v[40:41], v[96:97] op_sel_hi:[1,0] neg_lo:[0,1] neg_hi:[0,1]
    v_pk_add_f32 v[110:111], v[42:43], v[96:97] op_sel_hi:[1,0] neg_lo:[0,1] neg_hi:[0,1]
    v_cvt_pk_bf16_f32 v95, v100, v101
    v_cvt_pk_bf16_f32 v109, v110, v111
    v_lshlrev_b32 v100, 16, v95
    v_and_b32 v101, 0xffff0000, v95
    v_lshlrev_b32 v110, 16, v109
    v_and_b32 v111, 0xffff0000, v109
    v_pk_mul_f32 v[100:101], v[100:101], v[98:99] op_sel_hi:[1,0]
    v_pk_mul_f32 v[110:111], v[110:111], v[98:99] op_sel_hi:[1,0]
    v_cvt_pk_bf16_f32 v76, v100, v101
    v_cvt_pk_bf16_f32 v77, v110, v111
    v_pk_add_f32 v[100:101], v[44:45], v[96:97] op_sel_hi:[1,0] neg_lo:[0,1] neg_hi:[0,1]
    v_pk_add_f32 v[110:111], v[46:47], v[96:97] op_sel_hi:[1,0] neg_lo:[0,1] neg_hi:[0,1]
    v_cvt_pk_bf16_f32 v95, v100, v101
    v_cvt_pk_bf16_f32 v109, v110, v111
    v_lshlrev_b32 v100, 16, v95
    v_and_b32 v101, 0xffff0000, v95
    v_lshlrev_b32 v110, 16, v109
    v_and_b32 v111, 0xffff0000, v109
    v_pk_mul_f32 v[100:101], v[100:101], v[98:99] op_sel_hi:[1,0]
    v_pk_mul_f32 v[110:111], v[110:111], v[98:99] op_sel_hi:[1,0]
    v_cvt_pk_bf16_f32 v78, v100, v101
    v_cvt_pk_bf16_f32 v79, v110, v111
    buffer_store_dwordx4 v[76:79], v103, s[20:23], s58 offen sc1
    v_pk_add_f32 v[100:101], v[48:49], v[96:97] op_sel_hi:[1,0] neg_lo:[0,1] neg_hi:[0,1]
    v_pk_add_f32 v[110:111], v[50:51], v[96:97] op_sel_hi:[1,0] neg_lo:[0,1] neg_hi:[0,1]
    v_cvt_pk_bf16_f32 v95, v100, v101
    v_cvt_pk_bf16_f32 v109, v110, v111
    v_lshlrev_b32 v100, 16, v95
    v_and_b32 v101, 0xffff0000, v95
    v_lshlrev_b32 v110, 16, v109
    v_and_b32 v111, 0xffff0000, v109
    v_pk_mul_f32 v[100:101], v[100:101], v[98:99] op_sel_hi:[1,0]
    v_pk_mul_f32 v[110:111], v[110:111], v[98:99] op_sel_hi:[1,0]
    v_cvt_pk_bf16_f32 v80, v100, v101
    v_cvt_pk_bf16_f32 v81, v110, v111
    v_pk_add_f32 v[100:101], v[52:53], v[96:97] op_sel_hi:[1,0] neg_lo:[0,1] neg_hi:[0,1]
    v_pk_add_f32 v[110:111], v[54:55], v[96:97] op_sel_hi:[1,0] neg_lo:[0,1] neg_hi:[0,1]
    v_cvt_pk_bf16_f32 v95, v100, v101
    v_cvt_pk_bf16_f32 v109, v110, v111
    v_lshlrev_b32 v100, 16, v95
    v_and_b32 v101, 0xffff0000, v95
    v_lshlrev_b32 v110, 16, v109
    v_and_b32 v111, 0xffff0000, v109
    v_pk_mul_f32 v[100:101], v[100:101], v[98:99] op_sel_hi:[1,0]
    v_pk_mul_f32 v[110:111], v[110:111], v[98:99] op_sel_hi:[1,0]
    v_cvt_pk_bf16_f32 v82, v100, v101
    v_cvt_pk_bf16_f32 v83, v110, v111
    buffer_store_dwordx4 v[80:83], v103, s[20:23], s59 offen sc1
    v_pk_add_f32 v[100:101], v[56:57], v[96:97] op_sel_hi:[1,0] neg_lo:[0,1] neg_hi:[0,1]
    v_pk_add_f32 v[110:111], v[58:59], v[96:97] op_sel_hi:[1,0] neg_lo:[0,1] neg_hi:[0,1]
    v_cvt_pk_bf16_f32 v95, v100, v101
    v_cvt_pk_bf16_f32 v109, v110, v111
    v_lshlrev_b32 v100, 16, v95
    v_and_b32 v101, 0xffff0000, v95
    v_lshlrev_b32 v110, 16, v109
    v_and_b32 v111, 0xffff0000, v109
    v_pk_mul_f32 v[100:101], v[100:101], v[98:99] op_sel_hi:[1,0]
    v_pk_mul_f32 v[110:111], v[110:111], v[98:99] op_sel_hi:[1,0]
    v_cvt_pk_bf16_f32 v84, v100, v101
    v_cvt_pk_bf16_f32 v85, v110, v111
    v_pk_add_f32 v[100:101], v[60:61], v[96:97] op_sel_hi:[1,0] neg_lo:[0,1] neg_hi:[0,1]
    v_pk_add_f32 v[110:111], v[62:63], v[96:97] op_sel_hi:[1,0] neg_lo:[0,1] neg_hi:[0,1]
    v_cvt_pk_bf16_f32 v95, v100, v101
    v_cvt_pk_bf16_f32 v109, v110, v111
    v_lshlrev_b32 v100, 16, v95
    v_and_b32 v101, 0xffff0000, v95
    v_lshlrev_b32 v110, 16, v109
    v_and_b32 v111, 0xffff0000, v109
    v_pk_mul_f32 v[100:101], v[100:101], v[98:99] op_sel_hi:[1,0]
    v_pk_mul_f32 v[110:111], v[110:111], v[98:99] op_sel_hi:[1,0]
    v_cvt_pk_bf16_f32 v86, v100, v101
    v_cvt_pk_bf16_f32 v87, v110, v111
    buffer_store_dwordx4 v[84:87], v103, s[20:23], s60 offen sc1
    v_pk_add_f32 v[100:101], v[64:65], v[96:97] op_sel_hi:[1,0] neg_lo:[0,1] neg_hi:[0,1]
    v_pk_add_f32 v[110:111], v[66:67], v[96:97] op_sel_hi:[1,0] neg_lo:[0,1] neg_hi:[0,1]
    v_cvt_pk_bf16_f32 v95, v100, v101
    v_cvt_pk_bf16_f32 v109, v110, v111
    v_lshlrev_b32 v100, 16, v95
    v_and_b32 v101, 0xffff0000, v95
    v_lshlrev_b32 v110, 16, v109
    v_and_b32 v111, 0xffff0000, v109
    v_pk_mul_f32 v[100:101], v[100:101], v[98:99] op_sel_hi:[1,0]
    v_pk_mul_f32 v[110:111], v[110:111], v[98:99] op_sel_hi:[1,0]
    v_cvt_pk_bf16_f32 v88, v100, v101
    v_cvt_pk_bf16_f32 v89, v110, v111
    v_pk_add_f32 v[100:101], v[68:69], v[96:97] op_sel_hi:[1,0] neg_lo:[0,1] neg_hi:[0,1]
    v_pk_add_f32 v[110:111], v[70:71], v[96:97] op_sel_hi:[1,0] neg_lo:[0,1] neg_hi:[0,1]
    v_cvt_pk_bf16_f32 v95, v100, v101
    v_cvt_pk_bf16_f32 v109, v110, v111
    v_lshlrev_b32 v100, 16, v95
    v_and_b32 v101, 0xffff0000, v95
    v_lshlrev_b32 v110, 16, v109
    v_and_b32 v111, 0xffff0000, v109
    v_pk_mul_f32 v[100:101], v[100:101], v[98:99] op_sel_hi:[1,0]
    v_pk_mul_f32 v[110:111], v[110:111], v[98:99] op_sel_hi:[1,0]
    v_cvt_pk_bf16_f32 v90, v100, v101
    v_cvt_pk_bf16_f32 v91, v110, v111
    buffer_store_dwordx4 v[88:91], v103, s[20:23], s61 offen sc1
    v_mul_f32 v108, v108, v98
    v_mul_f32 v108, v108, v98
    v_cvt_pk_bf16_f32 v95, v108, v108
    v_lshlrev_b32 v108, 16, v95
    v_add_f32 v108, s57, v108
    v_cvt_pk_bf16_f32 v95, v108, v108
    v_lshlrev_b32 v108, 16, v95
    v_sqrt_f32 v108, v108
    s_nop 0
    v_cvt_pk_bf16_f32 v95, v108, v108
    v_lshlrev_b32 v108, 16, v95
    v_rcp_f32 v108, v108
    s_add_u32 s32, s64, 0x280000
    s_addc_u32 s33, s65, 0
    s_mov_b32 s34, 0x2000
    s_mov_b32 s35, 0x20000
    v_cmp_eq_u32 vcc, 0, v107
    v_lshlrev_b32 v106, 2, v106
    v_mov_b32 v95, 0x40000000
    v_cndmask_b32 v106, v95, v106, vcc
    buffer_store_dword v108, v106, s[32:35], 0 offen sc1
FZ_noln:
    s_mov_b32 s32, s62
    s_mov_b32 s33, s63
    s_mov_b32 s34, 0x100
    s_mov_b32 s35, 0x20000
    s_lshl_b32 s54, s40, 5
    v_mov_b32 v36, s54
    buffer_load_dword v37, v36, s[32:35], 0 offen sc1
    v_cmp_eq_u32 vcc, 0, v0
    s_lshl_b32 s3, s2, 7
    v_mov_b32 v38, s3
    v_mov_b32 v34, 0x40000000
    v_cndmask_b32 v34, v34, v38, vcc
    s_lshl_b32 s3, s40, 12
    v_and_b32 v38, 31, v0
    v_lshlrev_b32 v38, 7, v38
    v_add_u32 v35, s3, v38
    v_mov_b32 v48, 0
    v_mov_b32 v49, 0
    v_mov_b32 v50, 0
    v_mov_b32 v51, 0
    v_mov_b32 v52, 0
    v_mov_b32 v53, 0
    v_mov_b32 v54, 0
    v_mov_b32 v55, 0
    v_mov_b32 v56, 0
    v_mov_b32 v57, 0
    v_mov_b32 v58, 0
    v_mov_b32 v59, 0
    v_mov_b32 v60, 0
    v_mov_b32 v61, 0
    v_mov_b32 v62, 0
    v_mov_b32 v63, 0
    v_mov_b32 v64, 0
    v_mov_b32 v65, 0
    v_mov_b32 v66, 0
    v_mov_b32 v67, 0
    v_mov_b32 v68, 0
    v_mov_b32 v69, 0
    v_mov_b32 v70, 0
    v_mov_b32 v71, 0
    v_mov_b32 v72, 0
    v_mov_b32 v73, 0
    v_mov_b32 v74, 0
    v_mov_b32 v75, 0
    v_mov_b32 v76, 0
    v_mov_b32 v77, 0
    v_mov_b32 v78, 0
    v_mov_b32 v79, 0
    v_mov_b32 v80, 0
    v_mov_b32 v81, 0
    v_mov_b32 v82, 0
    v_mov_b32 v83, 0
    v_mov_b32 v84, 0
    v_mov_b32 v85, 0
    v_mov_b32 v86, 0
    v_mov_b32 v87, 0
    v_mov_b32 v88, 0
    v_mov_b32 v89, 0
    v_mov_b32 v90, 0
    v_mov_b32 v91, 0
    v_mov_b32 v92, 0
    v_mov_b32 v93, 0
    v_mov_b32 v94, 0
    v_mov_b32 v95, 0
    v_mov_b32 v96, 0
    v_mov_b32 v97, 0
    v_mov_b32 v98, 0
    v_mov_b32 v99, 0
    v_mov_b32 v100, 0
    v_mov_b32 v101, 0
    v_mov_b32 v102, 0
    v_mov_b32 v103, 0
    v_mov_b32 v104, 0
    v_mov_b32 v105, 0
    v_mov_b32 v106, 0
    v_mov_b32 v107, 0
    v_mov_b32 v108, 0
    v_mov_b32 v109, 0
    v_mov_b32 v110, 0
    v_mov_b32 v111, 0
    v_mov_b32 v112, 0
    v_mov_b32 v113, 0
    v_mov_b32 v114, 0
    v_mov_b32 v115, 0
    v_mov_b32 v116, 0
    v_mov_b32 v117, 0
    v_mov_b32 v118, 0
    v_mov_b32 v119, 0
    v_mov_b32 v120, 0
    v_mov_b32 v121, 0
    v_mov_b32 v122, 0
    v_mov_b32 v123, 0
    v_mov_b32 v124, 0
    v_mov_b32 v125, 0
    v_mov_b32 v126, 0
    v_mov_b32 v127, 0
    v_mov_b32 v128, 0
    v_mov_b32 v129, 0
    v_mov_b32 v130, 0
    v_mov_b32 v131, 0
    v_mov_b32 v132, 0
    v_mov_b32 v133, 0
    v_mov_b32 v134, 0
    v_mov_b32 v135, 0
    v_mov_b32 v136, 0
    v_mov_b32 v137, 0
    v_mov_b32 v138, 0
    v_mov_b32 v139, 0
    v_mov_b32 v140, 0
    v_mov_b32 v141, 0
    v_mov_b32 v142, 0
    v_mov_b32 v143, 0
    v_mov_b32 v144, 0
    v_mov_b32 v145, 0
    v_mov_b32 v146, 0
    v_mov_b32 v147, 0
    v_mov_b32 v148, 0
    v_mov_b32 v149, 0
    v_mov_b32 v150, 0
    v_mov_b32 v151, 0
    v_mov_b32 v152, 0
    v_mov_b32 v153, 0
    v_mov_b32 v154, 0
    v_mov_b32 v155, 0
    v_mov_b32 v156, 0
    v_mov_b32 v157, 0
    v_mov_b32 v158, 0
    v_mov_b32 v159, 0
    v_mov_b32 v160, 0
    v_mov_b32 v161, 0
    v_mov_b32 v162, 0
    v_mov_b32 v163, 0
    v_mov_b32 v164, 0
    v_mov_b32 v165, 0
    v_mov_b32 v166, 0
    v_mov_b32 v167, 0
    v_mov_b32 v168, 0
    v_mov_b32 v169, 0
    v_mov_b32 v170, 0
    v_mov_b32 v171, 0
    v_mov_b32 v172, 0
    v_mov_b32 v173, 0
    v_mov_b32 v174, 0
    v_mov_b32 v175, 0
    v_mov_b32 v176, 0
    v_mov_b32 v177, 0
    v_mov_b32 v178, 0
    v_mov_b32 v179, 0
    v_mov_b32 v180, 0
    v_mov_b32 v181, 0
    v_mov_b32 v182, 0
    v_mov_b32 v183, 0
    v_mov_b32 v184, 0
    v_mov_b32 v185, 0
    v_mov_b32 v186, 0
    v_mov_b32 v187, 0
    v_mov_b32 v188, 0
    v_mov_b32 v189, 0
    v_mov_b32 v190, 0
    v_mov_b32 v191, 0
    v_mov_b32 v192, 0
    v_mov_b32 v193, 0
    v_mov_b32 v194, 0
    v_mov_b32 v195, 0
    v_mov_b32 v196, 0
    v_mov_b32 v197, 0
    v_mov_b32 v198, 0
    v_mov_b32 v199, 0
    v_mov_b32 v200, 0
    v_mov_b32 v201, 0
    v_mov_b32 v202, 0
    v_mov_b32 v203, 0
    v_mov_b32 v204, 0
    v_mov_b32 v205, 0
    v_mov_b32 v206, 0
    v_mov_b32 v207, 0
    v_mov_b32 v208, 0
    v_mov_b32 v209, 0
    v_mov_b32 v210, 0
    v_mov_b32 v211, 0
    v_mov_b32 v212, 0
    v_mov_b32 v213, 0
    v_mov_b32 v214, 0
    v_mov_b32 v215, 0
    v_mov_b32 v216, 0
    v_mov_b32 v217, 0
    v_mov_b32 v218, 0
    v_mov_b32 v219, 0
    v_mov_b32 v220, 0
    v_mov_b32 v221, 0
    v_mov_b32 v222, 0
    v_mov_b32 v223, 0
    v_mov_b32 v224, 0
    v_mov_b32 v225, 0
    v_mov_b32 v226, 0
    v_mov_b32 v227, 0
    v_mov_b32 v228, 0
    v_mov_b32 v229, 0
    v_mov_b32 v230, 0
    v_mov_b32 v231, 0
    v_mov_b32 v232, 0
    v_mov_b32 v233, 0
    v_mov_b32 v234, 0
    v_mov_b32 v235, 0
    v_mov_b32 v236, 0
    v_mov_b32 v237, 0
    v_mov_b32 v238, 0
    v_mov_b32 v239, 0
    v_accvgpr_write_b32 a0, 0
    v_accvgpr_write_b32 a1, 0
    v_accvgpr_write_b32 a2, 0
    v_accvgpr_write_b32 a3, 0
    v_accvgpr_write_b32 a4, 0
    v_accvgpr_write_b32 a5, 0
    v_accvgpr_write_b32 a6, 0
    v_accvgpr_write_b32 a7, 0
    v_accvgpr_write_b32 a8, 0
    v_accvgpr_write_b32 a9, 0
    v_accvgpr_write_b32 a10, 0
    v_accvgpr_write_b32 a11, 0
    v_accvgpr_write_b32 a12, 0
    v_accvgpr_write_b32 a13, 0
    v_accvgpr_write_b32 a14, 0
    v_accvgpr_write_b32 a15, 0
    v_accvgpr_write_b32 a16, 0
    v_accvgpr_write_b32 a17, 0
    v_accvgpr_write_b32 a18, 0
    v_accvgpr_write_b32 a19, 0
    v_accvgpr_write_b32 a20, 0
    v_accvgpr_write_b32 a21, 0
    v_accvgpr_write_b32 a22, 0
    v_accvgpr_write_b32 a23, 0
    v_accvgpr_write_b32 a24, 0
    v_accvgpr_write_b32 a25, 0
    v_accvgpr_write_b32 a26, 0
    v_accvgpr_write_b32 a27, 0
    v_accvgpr_write_b32 a28, 0
    v_accvgpr_write_b32 a29, 0
    v_accvgpr_write_b32 a30, 0
    v_accvgpr_write_b32 a31, 0
    v_accvgpr_write_b32 a32, 0
    v_accvgpr_write_b32 a33, 0
    v_accvgpr_write_b32 a34, 0
    v_accvgpr_write_b32 a35, 0
    v_accvgpr_write_b32 a36, 0
    v_accvgpr_write_b32 a37, 0
    v_accvgpr_write_b32 a38, 0
    v_accvgpr_write_b32 a39, 0
    v_accvgpr_write_b32 a40, 0
    v_accvgpr_write_b32 a41, 0
    v_accvgpr_write_b32 a42, 0
    v_accvgpr_write_b32 a43, 0
    v_accvgpr_write_b32 a44, 0
    v_accvgpr_write_b32 a45, 0
    v_accvgpr_write_b32 a46, 0
    v_accvgpr_write_b32 a47, 0
    v_accvgpr_write_b32 a48, 0
    v_accvgpr_write_b32 a49, 0
    v_accvgpr_write_b32 a50, 0
    v_accvgpr_write_b32 a51, 0
    v_accvgpr_write_b32 a52, 0
    v_accvgpr_write_b32 a53, 0
    v_accvgpr_write_b32 a54, 0
    v_accvgpr_write_b32 a55, 0
    v_accvgpr_write_b32 a56, 0
    v_accvgpr_write_b32 a57, 0
    v_accvgpr_write_b32 a58, 0
    v_accvgpr_write_b32 a59, 0
    v_accvgpr_write_b32 a60, 0
    v_accvgpr_write_b32 a61, 0
    v_accvgpr_write_b32 a62, 0
    v_accvgpr_write_b32 a63, 0
    v_accvgpr_write_b32 a64, 0
    v_accvgpr_write_b32 a65, 0
    v_accvgpr_write_b32 a66, 0
    v_accvgpr_write_b32 a67, 0
    v_accvgpr_write_b32 a68, 0
    v_accvgpr_write_b32 a69, 0
    v_accvgpr_write_b32 a70, 0
    v_accvgpr_write_b32 a71, 0
    v_accvgpr_write_b32 a72, 0
    v_accvgpr_write_b32 a73, 0
    v_accvgpr_write_b32 a74, 0
    v_accvgpr_write_b32 a75, 0
    v_accvgpr_write_b32 a76, 0
    v_accvgpr_write_b32 a77, 0
    v_accvgpr_write_b32 a78, 0
    v_accvgpr_write_b32 a79, 0
    v_accvgpr_write_b32 a80, 0
    v_accvgpr_write_b32 a81, 0
    v_accvgpr_write_b32 a82, 0
    v_accvgpr_write_b32 a83, 0
    v_accvgpr_write_b32 a84, 0
    v_accvgpr_write_b32 a85, 0
    v_accvgpr_write_b32 a86, 0
    v_accvgpr_write_b32 a87, 0
    v_accvgpr_write_b32 a88, 0
    v_accvgpr_write_b32 a89, 0
    v_accvgpr_write_b32 a90, 0
    v_accvgpr_write_b32 a91, 0
    v_accvgpr_write_b32 a92, 0
    v_accvgpr_write_b32 a93, 0
    v_accvgpr_write_b32 a94, 0
    v_accvgpr_write_b32 a95, 0
    v_accvgpr_write_b32 a96, 0
    v_accvgpr_write_b32 a97, 0
    v_accvgpr_write_b32 a98, 0
    v_accvgpr_write_b32 a99, 0
    v_accvgpr_write_b32 a100, 0
    v_accvgpr_write_b32 a101, 0
    v_accvgpr_write_b32 a102, 0
    v_accvgpr_write_b32 a103, 0
    v_accvgpr_write_b32 a104, 0
    v_accvgpr_write_b32 a105, 0
    v_accvgpr_write_b32 a106, 0
    v_accvgpr_write_b32 a107, 0
    v_accvgpr_write_b32 a108, 0
    v_accvgpr_write_b32 a109, 0
    v_accvgpr_write_b32 a110, 0
    v_accvgpr_write_b32 a111, 0
    v_accvgpr_write_b32 a112, 0
    v_accvgpr_write_b32 a113, 0
    v_accvgpr_write_b32 a114, 0
    v_accvgpr_write_b32 a115, 0
    v_accvgpr_write_b32 a116, 0
    v_accvgpr_write_b32 a117, 0
    v_accvgpr_write_b32 a118, 0
    v_accvgpr_write_b32 a119, 0
    v_accvgpr_write_b32 a120, 0
    v_accvgpr_write_b32 a121, 0
    v_accvgpr_write_b32 a122, 0
    v_accvgpr_write_b32 a123, 0
    v_accvgpr_write_b32 a124, 0
    v_accvgpr_write_b32 a125, 0
    v_accvgpr_write_b32 a126, 0
    v_accvgpr_write_b32 a127, 0
    s_mov_b32 s79, 0x10000
FZ_nonce:
    s_waitcnt vmcnt(0)
    v_readfirstlane_b32 s78, v37
    s_sub_u32 s79, s79, 1
    s_cmp_eq_u32 s79, 0
    s_cbranch_scc1 FZ_nonce_ok
    s_cmp_lg_u32 s78, 0
    s_cbranch_scc1 FZ_nonce_ok
    buffer_load_dword v37, v36, s[32:35], 0 offen sc1
    s_branch FZ_nonce
FZ_nonce_ok:
    s_add_u32 s3, s78, 1
    v_mov_b32 v32, s3
    s_barrier
    buffer_store_dword v32, v34, s[96:99], 0 offen sc1
    s_mov_b32 s100, -1
    s_mov_b32 s101, 0
    s_mov_b64 s[76:77], s[100:101]
    s_cmp_lg_u32 s41, 0
    s_cbranch_scc1 FZ_f1_ok
    s_mov_b32 s79, 0x10000
FZ_f1:
    s_mov_b64 exec, s[76:77]
    buffer_load_dword v33, v35, s[96:99], 0 offen sc1
    s_mov_b64 exec, -1
    s_waitcnt vmcnt(0)
    v_subrev_u32 v33, s78, v33
    v_subrev_u32 v33, 1, v33
    v_cmp_ge_u32 vcc, 6, v33
    s_nop 3
    s_and_b64 s[100:101], vcc, s[76:77]
    s_cmp_eq_u64 s[100:101], s[76:77]
    s_cbranch_scc1 FZ_f1_ok
    s_sub_u32 s79, s79, 1
    s_cmp_lg_u32 s79, 0
    s_cbranch_scc1 FZ_f1
FZ_f1_ok:
    s_barrier
    buffer_load_dwordx4 a[224:227], v20, s[20:23], s46 offen offset:0 sc1
    buffer_load_dwordx4 a[228:231], v20, s[20:23], s46 offen offset:1024 sc1
    buffer_load_dwordx4 a[232:235], v20, s[20:23], s46 offen offset:2048 sc1
    buffer_load_dwordx4 a[236:239], v20, s[20:23], s46 offen offset:3072 sc1
    s_add_u32 s46, s46, 0x20000
    buffer_load_dwordx4 a[240:243], v20, s[20:23], s46 offen offset:0 sc1
    buffer_load_dwordx4 a[244:247], v20, s[20:23], s46 offen offset:1024 sc1
    buffer_load_dwordx4 a[248:251], v20, s[20:23], s46 offen offset:2048 sc1
    buffer_load_dwordx4 a[252:255], v20, s[20:23], s46 offen offset:3072 sc1
    s_add_u32 s46, s46, 0x20000
    buffer_load_dword v29, v20, s[20:23], 0 offen
    s_add_u32 m0, s47, 0x9000
    s_nop 0
    buffer_load_dwordx4 v17, s[12:15], s44 offen offset:0 lds
    buffer_load_dwordx4 v18, s[12:15], s44 offen offset:1024 lds
    s_add_u32 m0, s48, 0x9000
    s_add_u32 s44, s44, 0x40000
    buffer_load_dwordx4 v19, s[16:19], s45 offen lds
    s_add_u32 s45, s45, 0x1b000
    buffer_load_dwordx4 v[240:243], v20, s[20:23], s46 offen offset:0 sc1
    buffer_load_dwordx4 v[244:247], v20, s[20:23], s46 offen offset:1024 sc1
    buffer_load_dwordx4 v[248:251], v20, s[20:23], s46 offen offset:2048 sc1
    buffer_load_dwordx4 v[252:255], v20, s[20:23], s46 offen offset:3072 sc1
    s_add_u32 s46, s46, 0x20000
    ds_read_b64_tr_b16 a[128:129], v21 offset:0
    ds_read_b64_tr_b16 a[130:131], v21 offset:1024
    ds_read_b64_tr_b16 a[132:133], v21 offset:8
    ds_read_b64_tr_b16 a[134:135], v21 offset:1032
    ds_read_b64_tr_b16 a[136:137], v22 offset:0
    ds_read_b64_tr_b16 a[138:139], v22 offset:1024
    ds_read_b64_tr_b16 a[140:141], v22 offset:8
    ds_read_b64_tr_b16 a[142:143], v22 offset:1032
    ds_read_b64_tr_b16 a[144:145], v23 offset:0
    ds_read_b64_tr_b16 a[146:147], v23 offset:1024
    ds_read_b64_tr_b16 a[148:149], v23 offset:8
    ds_read_b64_tr_b16 a[150:151], v23 offset:1032
    ds_read_b64_tr_b16 a[152:153], v24 offset:0
    ds_read_b64_tr_b16 a[154:155], v24 offset:1024
    ds_read_b64_tr_b16 a[156:157], v24 offset:8
    ds_read_b64_tr_b16 a[158:159], v24 offset:1032
    ds_read_b64_tr_b16 a[160:161], v25 offset:0
    ds_read_b64_tr_b16 a[162:163], v25 offset:512
    ds_read_b64_tr_b16 a[164:165], v26 offset:0
    ds_read_b64_tr_b16 a[166:167], v26 offset:512
    ds_read_b64_tr_b16 a[168:169], v27 offset:0
    ds_read_b64_tr_b16 a[170:171], v27 offset:512
    ds_read_b64_tr_b16 a[172:173], v28 offset:0
    ds_read_b64_tr_b16 a[174:175], v28 offset:512
    s_waitcnt vmcnt(12) lgkmcnt(0)
K1_pro:
    v_mfma_f32_16x16x32_bf16 v[48:51], a[128:131], a[224:227], v[48:51]
    s_barrier
    v_mfma_f32_16x16x32_bf16 v[80:83], a[128:131], a[228:231], v[80:83]
    ds_read_b64_tr_b16 a[176:177], v21 offset:12288
    v_mfma_f32_16x16x32_bf16 v[112:115], a[128:131], a[232:235], v[112:115]
    ds_read_b64_tr_b16 a[178:179], v21 offset:13312
    v_mfma_f32_16x16x32_bf16 v[144:147], a[128:131], a[236:239], v[144:147]
    ds_read_b64_tr_b16 a[180:181], v21 offset:12296
    v_mfma_f32_16x16x32_bf16 v[52:55], a[132:135], a[224:227], v[52:55]
    ds_read_b64_tr_b16 a[182:183], v21 offset:13320
    v_mfma_f32_16x16x32_bf16 v[84:87], a[132:135], a[228:231], v[84:87]
    ds_read_b64_tr_b16 a[184:185], v22 offset:12288
    v_mfma_f32_16x16x32_bf16 v[116:119], a[132:135], a[232:235], v[116:119]
    ds_read_b64_tr_b16 a[186:187], v22 offset:13312
    v_mfma_f32_16x16x32_bf16 v[148:151], a[132:135], a[236:239], v[148:151]
    ds_read_b64_tr_b16 a[188:189], v22 offset:12296
    v_mfma_f32_16x16x32_bf16 v[56:59], a[136:139], a[224:227], v[56:59]
    ds_read_b64_tr_b16 a[190:191], v22 offset:13320
    v_mfma_f32_16x16x32_bf16 v[88:91], a[136:139], a[228:231], v[88:91]
    ds_read_b64_tr_b16 a[192:193], v23 offset:12288
    v_mfma_f32_16x16x32_bf16 v[120:123], a[136:139], a[232:235], v[120:123]
    ds_read_b64_tr_b16 a[194:195], v23 offset:13312
    v_mfma_f32_16x16x32_bf16 v[152:155], a[136:139], a[236:239], v[152:155]
    ds_read_b64_tr_b16 a[196:197], v23 offset:12296
    v_mfma_f32_16x16x32_bf16 v[60:63], a[140:143], a[224:227], v[60:63]
    ds_read_b64_tr_b16 a[198:199], v23 offset:13320
    v_mfma_f32_16x16x32_bf16 v[92:95], a[140:143], a[228:231], v[92:95]
    ds_read_b64_tr_b16 a[200:201], v24 offset:12288
    v_mfma_f32_16x16x32_bf16 v[124:127], a[140:143], a[232:235], v[124:127]
    ds_read_b64_tr_b16 a[202:203], v24 offset:13312
    v_mfma_f32_16x16x32_bf16 v[156:159], a[140:143], a[236:239], v[156:159]
    ds_read_b64_tr_b16 a[204:205], v24 offset:12296
    v_mfma_f32_16x16x32_bf16 v[64:67], a[144:147], a[224:227], v[64:67]
    ds_read_b64_tr_b16 a[206:207], v24 offset:13320
    v_mfma_f32_16x16x32_bf16 v[96:99], a[144:147], a[228:231], v[96:99]
    ds_read_b64_tr_b16 a[208:209], v25 offset:12288
    v_mfma_f32_16x16x32_bf16 v[128:131], a[144:147], a[232:235], v[128:131]
    ds_read_b64_tr_b16 a[210:211], v25 offset:12800
    v_mfma_f32_16x16x32_bf16 v[160:163], a[144:147], a[236:239], v[160:163]
    ds_read_b64_tr_b16 a[212:213], v26 offset:12288
    v_mfma_f32_16x16x32_bf16 v[68:71], a[148:151], a[224:227], v[68:71]
    ds_read_b64_tr_b16 a[214:215], v26 offset:12800
    v_mfma_f32_16x16x32_bf16 v[100:103], a[148:151], a[228:231], v[100:103]
    ds_read_b64_tr_b16 a[216:217], v27 offset:12288
    v_mfma_f32_16x16x32_bf16 v[132:135], a[148:151], a[232:235], v[132:135]
    ds_read_b64_tr_b16 a[218:219], v27 offset:12800
    v_mfma_f32_16x16x32_bf16 v[164:167], a[148:151], a[236:239], v[164:167]
    ds_read_b64_tr_b16 a[220:221], v28 offset:12288
    v_mfma_f32_16x16x32_bf16 v[72:75], a[152:155], a[224:227], v[72:75]
    ds_read_b64_tr_b16 a[222:223], v28 offset:12800
    v_mfma_f32_16x16x32_bf16 v[104:107], a[152:155], a[228:231], v[104:107]
    s_mov_b32 m0, s50
    v_mfma_f32_16x16x32_bf16 v[136:139], a[152:155], a[232:235], v[136:139]
    buffer_load_dwordx4 v1, s[4:7], s36 offen offset:0 lds
    v_mfma_f32_16x16x32_bf16 v[168:171], a[152:155], a[236:239], v[168:171]
    v_mfma_f32_16x16x32_bf16 v[76:79], a[156:159], a[224:227], v[76:79]
    s_add_u32 m0, s47, 0
    v_mfma_f32_16x16x32_bf16 v[108:111], a[156:159], a[228:231], v[108:111]
    buffer_load_dwordx4 v17, s[12:15], s44 offen offset:0 lds
    v_mfma_f32_16x16x32_bf16 v[140:143], a[156:159], a[232:235], v[140:143]
    v_mfma_f32_16x16x32_bf16 v[172:175], a[156:159], a[236:239], v[172:175]
    buffer_load_dwordx4 v18, s[12:15], s44 offen offset:1024 lds
    v_mfma_f32_16x16x32_bf16 v[176:179], a[160:163], a[224:227], v[176:179]
    v_mfma_f32_16x16x32_bf16 v[192:195], a[160:163], a[228:231], v[192:195]
    s_add_u32 m0, s48, 0
    v_mfma_f32_16x16x32_bf16 v[208:211], a[160:163], a[232:235], v[208:211]
    buffer_load_dwordx4 v19, s[16:19], s45 offen lds
    v_mfma_f32_16x16x32_bf16 v[224:227], a[160:163], a[236:239], v[224:227]
    v_mfma_f32_16x16x32_bf16 v[180:183], a[164:167], a[224:227], v[180:183]
    buffer_load_dwordx4 v[32:35], v20, s[20:23], s46 offen offset:0 sc1
    v_mfma_f32_16x16x32_bf16 v[196:199], a[164:167], a[228:231], v[196:199]
    v_mfma_f32_16x16x32_bf16 v[212:215], a[164:167], a[232:235], v[212:215]
    buffer_load_dwordx4 v[36:39], v20, s[20:23], s46 offen offset:1024 sc1
    v_mfma_f32_16x16x32_bf16 v[228:231], a[164:167], a[236:239], v[228:231]
    v_mfma_f32_16x16x32_bf16 v[184:187], a[168:171], a[224:227], v[184:187]
    buffer_load_dwordx4 v[40:43], v20, s[20:23], s46 offen offset:2048 sc1
    v_mfma_f32_16x16x32_bf16 v[200:203], a[168:171], a[228:231], v[200:203]
    v_mfma_f32_16x16x32_bf16 v[216:219], a[168:171], a[232:235], v[216:219]
    buffer_load_dwordx4 v[44:47], v20, s[20:23], s46 offen offset:3072 sc1
    v_mfma_f32_16x16x32_bf16 v[232:235], a[168:171], a[236:239], v[232:235]
    s_add_u32 s44, s44, 0x40000
    v_mfma_f32_16x16x32_bf16 v[188:191], a[172:175], a[224:227], v[188:191]
    s_add_u32 s45, s45, 0x1b000
    v_mfma_f32_16x16x32_bf16 v[204:207], a[172:175], a[228:231], v[204:207]
    s_add_u32 s46, s46, 0x20000
    v_mfma_f32_16x16x32_bf16 v[220:223], a[172:175], a[232:235], v[220:223]
    v_mfma_f32_16x16x32_bf16 v[236:239], a[172:175], a[236:239], v[236:239]
    s_waitcnt vmcnt(16) lgkmcnt(0)
    v_mfma_f32_16x16x32_bf16 v[48:51], a[176:179], a[240:243], v[48:51]
    s_barrier
    v_mfma_f32_16x16x32_bf16 v[80:83], a[176:179], a[244:247], v[80:83]
    ds_read_b64_tr_b16 a[128:129], v21 offset:24576
    v_mfma_f32_16x16x32_bf16 v[112:115], a[176:179], a[248:251], v[112:115]
    ds_read_b64_tr_b16 a[130:131], v21 offset:25600
    v_mfma_f32_16x16x32_bf16 v[144:147], a[176:179], a[252:255], v[144:147]
    ds_read_b64_tr_b16 a[132:133], v21 offset:24584
    v_mfma_f32_16x16x32_bf16 v[52:55], a[180:183], a[240:243], v[52:55]
    ds_read_b64_tr_b16 a[134:135], v21 offset:25608
    v_mfma_f32_16x16x32_bf16 v[84:87], a[180:183], a[244:247], v[84:87]
    ds_read_b64_tr_b16 a[136:137], v22 offset:24576
    v_mfma_f32_16x16x32_bf16 v[116:119], a[180:183], a[248:251], v[116:119]
    ds_read_b64_tr_b16 a[138:139], v22 offset:25600
    v_mfma_f32_16x16x32_bf16 v[148:151], a[180:183], a[252:255], v[148:151]
    ds_read_b64_tr_b16 a[140:141], v22 offset:24584
    v_mfma_f32_16x16x32_bf16 v[56:59], a[184:187], a[240:243], v[56:59]
    ds_read_b64_tr_b16 a[142:143], v22 offset:25608
    v_mfma_f32_16x16x32_bf16 v[88:91], a[184:187], a[244:247], v[88:91]
    ds_read_b64_tr_b16 a[144:145], v23 offset:24576
    v_mfma_f32_16x16x32_bf16 v[120:123], a[184:187], a[248:251], v[120:123]
    ds_read_b64_tr_b16 a[146:147], v23 offset:25600
    v_mfma_f32_16x16x32_bf16 v[152:155], a[184:187], a[252:255], v[152:155]
    ds_read_b64_tr_b16 a[148:149], v23 offset:24584
    v_mfma_f32_16x16x32_bf16 v[60:63], a[188:191], a[240:243], v[60:63]
    ds_read_b64_tr_b16 a[150:151], v23 offset:25608
    v_mfma_f32_16x16x32_bf16 v[92:95], a[188:191], a[244:247], v[92:95]
    ds_read_b64_tr_b16 a[152:153], v24 offset:24576
    v_mfma_f32_16x16x32_bf16 v[124:127], a[188:191], a[248:251], v[124:127]
    ds_read_b64_tr_b16 a[154:155], v24 offset:25600
    v_mfma_f32_16x16x32_bf16 v[156:159], a[188:191], a[252:255], v[156:159]
    ds_read_b64_tr_b16 a[156:157], v24 offset:24584
    v_mfma_f32_16x16x32_bf16 v[64:67], a[192:195], a[240:243], v[64:67]
    ds_read_b64_tr_b16 a[158:159], v24 offset:25608
    v_mfma_f32_16x16x32_bf16 v[96:99], a[192:195], a[244:247], v[96:99]
    ds_read_b64_tr_b16 a[160:161], v25 offset:24576
    v_mfma_f32_16x16x32_bf16 v[128:131], a[192:195], a[248:251], v[128:131]
    ds_read_b64_tr_b16 a[162:163], v25 offset:25088
    v_mfma_f32_16x16x32_bf16 v[160:163], a[192:195], a[252:255], v[160:163]
    ds_read_b64_tr_b16 a[164:165], v26 offset:24576
    v_mfma_f32_16x16x32_bf16 v[68:71], a[196:199], a[240:243], v[68:71]
    ds_read_b64_tr_b16 a[166:167], v26 offset:25088
    v_mfma_f32_16x16x32_bf16 v[100:103], a[196:199], a[244:247], v[100:103]
    ds_read_b64_tr_b16 a[168:169], v27 offset:24576
    v_mfma_f32_16x16x32_bf16 v[132:135], a[196:199], a[248:251], v[132:135]
    ds_read_b64_tr_b16 a[170:171], v27 offset:25088
    v_mfma_f32_16x16x32_bf16 v[164:167], a[196:199], a[252:255], v[164:167]
    ds_read_b64_tr_b16 a[172:173], v28 offset:24576
    v_mfma_f32_16x16x32_bf16 v[72:75], a[200:203], a[240:243], v[72:75]
    ds_read_b64_tr_b16 a[174:175], v28 offset:25088
    v_mfma_f32_16x16x32_bf16 v[104:107], a[200:203], a[244:247], v[104:107]
    s_mov_b32 m0, s50
    v_mfma_f32_16x16x32_bf16 v[136:139], a[200:203], a[248:251], v[136:139]
    buffer_load_dwordx4 v2, s[4:7], s36 offen offset:1024 lds
    v_mfma_f32_16x16x32_bf16 v[168:171], a[200:203], a[252:255], v[168:171]
    v_mfma_f32_16x16x32_bf16 v[76:79], a[204:207], a[240:243], v[76:79]
    s_add_u32 m0, s47, 0x3000
    v_mfma_f32_16x16x32_bf16 v[108:111], a[204:207], a[244:247], v[108:111]
    buffer_load_dwordx4 v17, s[12:15], s44 offen offset:0 lds
    v_mfma_f32_16x16x32_bf16 v[140:143], a[204:207], a[248:251], v[140:143]
    v_mfma_f32_16x16x32_bf16 v[172:175], a[204:207], a[252:255], v[172:175]
    buffer_load_dwordx4 v18, s[12:15], s44 offen offset:1024 lds
    v_mfma_f32_16x16x32_bf16 v[176:179], a[208:211], a[240:243], v[176:179]
    v_mfma_f32_16x16x32_bf16 v[192:195], a[208:211], a[244:247], v[192:195]
    s_add_u32 m0, s48, 0x3000
    v_mfma_f32_16x16x32_bf16 v[208:211], a[208:211], a[248:251], v[208:211]
    buffer_load_dwordx4 v19, s[16:19], s45 offen lds
    v_mfma_f32_16x16x32_bf16 v[224:227], a[208:211], a[252:255], v[224:227]
    v_mfma_f32_16x16x32_bf16 v[180:183], a[212:215], a[240:243], v[180:183]
    buffer_load_dwordx4 a[224:227], v20, s[20:23], s46 offen offset:0 sc1
    v_mfma_f32_16x16x32_bf16 v[196:199], a[212:215], a[244:247], v[196:199]
    v_mfma_f32_16x16x32_bf16 v[212:215], a[212:215], a[248:251], v[212:215]
    buffer_load_dwordx4 a[228:231], v20, s[20:23], s46 offen offset:1024 sc1
    v_mfma_f32_16x16x32_bf16 v[228:231], a[212:215], a[252:255], v[228:231]
    v_mfma_f32_16x16x32_bf16 v[184:187], a[216:219], a[240:243], v[184:187]
    buffer_load_dwordx4 a[232:235], v20, s[20:23], s46 offen offset:2048 sc1
    v_mfma_f32_16x16x32_bf16 v[200:203], a[216:219], a[244:247], v[200:203]
    v_mfma_f32_16x16x32_bf16 v[216:219], a[216:219], a[248:251], v[216:219]
    buffer_load_dwordx4 a[236:239], v20, s[20:23], s46 offen offset:3072 sc1
    v_mfma_f32_16x16x32_bf16 v[232:235], a[216:219], a[252:255], v[232:235]
    s_add_u32 s44, s44, 0x40000
    v_mfma_f32_16x16x32_bf16 v[188:191], a[220:223], a[240:243], v[188:191]
    s_add_u32 s45, s45, 0x1b000
    v_mfma_f32_16x16x32_bf16 v[204:207], a[220:223], a[244:247], v[204:207]
    s_add_u32 s46, s46, 0x20000
    v_mfma_f32_16x16x32_bf16 v[220:223], a[220:223], a[248:251], v[220:223]
    v_mfma_f32_16x16x32_bf16 v[236:239], a[220:223], a[252:255], v[236:239]
    s_waitcnt vmcnt(16) lgkmcnt(0)
    v_mfma_f32_16x16x32_bf16 v[48:51], a[128:131], v[240:243], v[48:51]
    s_barrier
    v_mfma_f32_16x16x32_bf16 v[80:83], a[128:131], v[244:247], v[80:83]
    ds_read_b64_tr_b16 a[176:177], v21 offset:36864
    v_mfma_f32_16x16x32_bf16 v[112:115], a[128:131], v[248:251], v[112:115]
    ds_read_b64_tr_b16 a[178:179], v21 offset:37888
    v_mfma_f32_16x16x32_bf16 v[144:147], a[128:131], v[252:255], v[144:147]
    ds_read_b64_tr_b16 a[180:181], v21 offset:36872
    v_mfma_f32_16x16x32_bf16 v[52:55], a[132:135], v[240:243], v[52:55]
    ds_read_b64_tr_b16 a[182:183], v21 offset:37896
    v_mfma_f32_16x16x32_bf16 v[84:87], a[132:135], v[244:247], v[84:87]
    ds_read_b64_tr_b16 a[184:185], v22 offset:36864
    v_mfma_f32_16x16x32_bf16 v[116:119], a[132:135], v[248:251], v[116:119]
    ds_read_b64_tr_b16 a[186:187], v22 offset:37888
    v_mfma_f32_16x16x32_bf16 v[148:151], a[132:135], v[252:255], v[148:151]
    ds_read_b64_tr_b16 a[188:189], v22 offset:36872
    v_mfma_f32_16x16x32_bf16 v[56:59], a[136:139], v[240:243], v[56:59]
    ds_read_b64_tr_b16 a[190:191], v22 offset:37896
    v_mfma_f32_16x16x32_bf16 v[88:91], a[136:139], v[244:247], v[88:91]
    ds_read_b64_tr_b16 a[192:193], v23 offset:36864
    v_mfma_f32_16x16x32_bf16 v[120:123], a[136:139], v[248:251], v[120:123]
    ds_read_b64_tr_b16 a[194:195], v23 offset:37888
    v_mfma_f32_16x16x32_bf16 v[152:155], a[136:139], v[252:255], v[152:155]
    ds_read_b64_tr_b16 a[196:197], v23 offset:36872
    v_mfma_f32_16x16x32_bf16 v[60:63], a[140:143], v[240:243], v[60:63]
    ds_read_b64_tr_b16 a[198:199], v23 offset:37896
    v_mfma_f32_16x16x32_bf16 v[92:95], a[140:143], v[244:247], v[92:95]
    ds_read_b64_tr_b16 a[200:201], v24 offset:36864
    v_mfma_f32_16x16x32_bf16 v[124:127], a[140:143], v[248:251], v[124:127]
    ds_read_b64_tr_b16 a[202:203], v24 offset:37888
    v_mfma_f32_16x16x32_bf16 v[156:159], a[140:143], v[252:255], v[156:159]
    ds_read_b64_tr_b16 a[204:205], v24 offset:36872
    v_mfma_f32_16x16x32_bf16 v[64:67], a[144:147], v[240:243], v[64:67]
    ds_read_b64_tr_b16 a[206:207], v24 offset:37896
    v_mfma_f32_16x16x32_bf16 v[96:99], a[144:147], v[244:247], v[96:99]
    ds_read_b64_tr_b16 a[208:209], v25 offset:36864
    v_mfma_f32_16x16x32_bf16 v[128:131], a[144:147], v[248:251], v[128:131]
    ds_read_b64_tr_b16 a[210:211], v25 offset:37376
    v_mfma_f32_16x16x32_bf16 v[160:163], a[144:147], v[252:255], v[160:163]
    ds_read_b64_tr_b16 a[212:213], v26 offset:36864
    v_mfma_f32_16x16x32_bf16 v[68:71], a[148:151], v[240:243], v[68:71]
    ds_read_b64_tr_b16 a[214:215], v26 offset:37376
    v_mfma_f32_16x16x32_bf16 v[100:103], a[148:151], v[244:247], v[100:103]
    ds_read_b64_tr_b16 a[216:217], v27 offset:36864
    v_mfma_f32_16x16x32_bf16 v[132:135], a[148:151], v[248:251], v[132:135]
    ds_read_b64_tr_b16 a[218:219], v27 offset:37376
    v_mfma_f32_16x16x32_bf16 v[164:167], a[148:151], v[252:255], v[164:167]
    ds_read_b64_tr_b16 a[220:221], v28 offset:36864
    v_mfma_f32_16x16x32_bf16 v[72:75], a[152:155], v[240:243], v[72:75]
    ds_read_b64_tr_b16 a[222:223], v28 offset:37376
    v_mfma_f32_16x16x32_bf16 v[104:107], a[152:155], v[244:247], v[104:107]
    s_mov_b32 m0, s51
    v_mfma_f32_16x16x32_bf16 v[136:139], a[152:155], v[248:251], v[136:139]
    buffer_load_dwordx4 v3, s[8:11], s36 offen offset:0 lds
    v_mfma_f32_16x16x32_bf16 v[168:171], a[152:155], v[252:255], v[168:171]
    v_mfma_f32_16x16x32_bf16 v[76:79], a[156:159], v[240:243], v[76:79]
    s_add_u32 m0, s47, 0x6000
    v_mfma_f32_16x16x32_bf16 v[108:111], a[156:159], v[244:247], v[108:111]
    buffer_load_dwordx4 v17, s[12:15], s44 offen offset:0 lds
    v_mfma_f32_16x16x32_bf16 v[140:143], a[156:159], v[248:251], v[140:143]
    v_mfma_f32_16x16x32_bf16 v[172:175], a[156:159], v[252:255], v[172:175]
    buffer_load_dwordx4 v18, s[12:15], s44 offen offset:1024 lds
    v_mfma_f32_16x16x32_bf16 v[176:179], a[160:163], v[240:243], v[176:179]
    v_mfma_f32_16x16x32_bf16 v[192:195], a[160:163], v[244:247], v[192:195]
    s_add_u32 m0, s48, 0x6000
    v_mfma_f32_16x16x32_bf16 v[208:211], a[160:163], v[248:251], v[208:211]
    buffer_load_dwordx4 v19, s[16:19], s45 offen lds
    v_mfma_f32_16x16x32_bf16 v[224:227], a[160:163], v[252:255], v[224:227]
    v_mfma_f32_16x16x32_bf16 v[180:183], a[164:167], v[240:243], v[180:183]
    buffer_load_dwordx4 a[240:243], v20, s[20:23], s46 offen offset:0 sc1
    v_mfma_f32_16x16x32_bf16 v[196:199], a[164:167], v[244:247], v[196:199]
    v_mfma_f32_16x16x32_bf16 v[212:215], a[164:167], v[248:251], v[212:215]
    buffer_load_dwordx4 a[244:247], v20, s[20:23], s46 offen offset:1024 sc1
    v_mfma_f32_16x16x32_bf16 v[228:231], a[164:167], v[252:255], v[228:231]
    v_mfma_f32_16x16x32_bf16 v[184:187], a[168:171], v[240:243], v[184:187]
    buffer_load_dwordx4 a[248:251], v20, s[20:23], s46 offen offset:2048 sc1
    v_mfma_f32_16x16x32_bf16 v[200:203], a[168:171], v[244:247], v[200:203]
    v_mfma_f32_16x16x32_bf16 v[216:219], a[168:171], v[248:251], v[216:219]
    buffer_load_dwordx4 a[252:255], v20, s[20:23], s46 offen offset:3072 sc1
    v_mfma_f32_16x16x32_bf16 v[232:235], a[168:171], v[252:255], v[232:235]
    s_add_u32 s44, s44, 0x40000
    v_mfma_f32_16x16x32_bf16 v[188:191], a[172:175], v[240:243], v[188:191]
    s_add_u32 s45, s45, 0x1b000
    v_mfma_f32_16x16x32_bf16 v[204:207], a[172:175], v[244:247], v[204:207]
    s_add_u32 s46, s46, 0x20000
    v_mfma_f32_16x16x32_bf16 v[220:223], a[172:175], v[248:251], v[220:223]
    v_mfma_f32_16x16x32_bf16 v[236:239], a[172:175], v[252:255], v[236:239]
    s_waitcnt vmcnt(16) lgkmcnt(0)
    v_mfma_f32_16x16x32_bf16 v[48:51], a[176:179], v[32:35], v[48:51]
    s_barrier
    v_mfma_f32_16x16x32_bf16 v[80:83], a[176:179], v[36:39], v[80:83]
    ds_read_b64_tr_b16 a[128:129], v21 offset:0
    v_mfma_f32_16x16x32_bf16 v[112:115], a[176:179], v[40:43], v[112:115]
    ds_read_b64_tr_b16 a[130:131], v21 offset:1024
    v_mfma_f32_16x16x32_bf16 v[144:147], a[176:179], v[44:47], v[144:147]
    ds_read_b64_tr_b16 a[132:133], v21 offset:8
    v_mfma_f32_16x16x32_bf16 v[52:55], a[180:183], v[32:35], v[52:55]
    ds_read_b64_tr_b16 a[134:135], v21 offset:1032
    v_mfma_f32_16x16x32_bf16 v[84:87], a[180:183], v[36:39], v[84:87]
    ds_read_b64_tr_b16 a[136:137], v22 offset:0
    v_mfma_f32_16x16x32_bf16 v[116:119], a[180:183], v[40:43], v[116:119]
    ds_read_b64_tr_b16 a[138:139], v22 offset:1024
    v_mfma_f32_16x16x32_bf16 v[148:151], a[180:183], v[44:47], v[148:151]
    ds_read_b64_tr_b16 a[140:141], v22 offset:8
    v_mfma_f32_16x16x32_bf16 v[56:59], a[184:187], v[32:35], v[56:59]
    ds_read_b64_tr_b16 a[142:143], v22 offset:1032
    v_mfma_f32_16x16x32_bf16 v[88:91], a[184:187], v[36:39], v[88:91]
    ds_read_b64_tr_b16 a[144:145], v23 offset:0
    v_mfma_f32_16x16x32_bf16 v[120:123], a[184:187], v[40:43], v[120:123]
    ds_read_b64_tr_b16 a[146:147], v23 offset:1024
    v_mfma_f32_16x16x32_bf16 v[152:155], a[184:187], v[44:47], v[152:155]
    ds_read_b64_tr_b16 a[148:149], v23 offset:8
    v_mfma_f32_16x16x32_bf16 v[60:63], a[188:191], v[32:35], v[60:63]
    ds_read_b64_tr_b16 a[150:151], v23 offset:1032
    v_mfma_f32_16x16x32_bf16 v[92:95], a[188:191], v[36:39], v[92:95]
    ds_read_b64_tr_b16 a[152:153], v24 offset:0
    v_mfma_f32_16x16x32_bf16 v[124:127], a[188:191], v[40:43], v[124:127]
    ds_read_b64_tr_b16 a[154:155], v24 offset:1024
    v_mfma_f32_16x16x32_bf16 v[156:159], a[188:191], v[44:47], v[156:159]
    ds_read_b64_tr_b16 a[156:157], v24 offset:8
    v_mfma_f32_16x16x32_bf16 v[64:67], a[192:195], v[32:35], v[64:67]
    ds_read_b64_tr_b16 a[158:159], v24 offset:1032
    v_mfma_f32_16x16x32_bf16 v[96:99], a[192:195], v[36:39], v[96:99]
    ds_read_b64_tr_b16 a[160:161], v25 offset:0
    v_mfma_f32_16x16x32_bf16 v[128:131], a[192:195], v[40:43], v[128:131]
    ds_read_b64_tr_b16 a[162:163], v25 offset:512
    v_mfma_f32_16x16x32_bf16 v[160:163], a[192:195], v[44:47], v[160:163]
    ds_read_b64_tr_b16 a[164:165], v26 offset:0
    v_mfma_f32_16x16x32_bf16 v[68:71], a[196:199], v[32:35], v[68:71]
    ds_read_b64_tr_b16 a[166:167], v26 offset:512
    v_mfma_f32_16x16x32_bf16 v[100:103], a[196:199], v[36:39], v[100:103]
    ds_read_b64_tr_b16 a[168:169], v27 offset:0
    v_mfma_f32_16x16x32_bf16 v[132:135], a[196:199], v[40:43], v[132:135]
    ds_read_b64_tr_b16 a[170:171], v27 offset:512
    v_mfma_f32_16x16x32_bf16 v[164:167], a[196:199], v[44:47], v[164:167]
    ds_read_b64_tr_b16 a[172:173], v28 offset:0
    v_mfma_f32_16x16x32_bf16 v[72:75], a[200:203], v[32:35], v[72:75]
    ds_read_b64_tr_b16 a[174:175], v28 offset:512
    v_mfma_f32_16x16x32_bf16 v[104:107], a[200:203], v[36:39], v[104:107]
    s_mov_b32 m0, s51
    v_mfma_f32_16x16x32_bf16 v[136:139], a[200:203], v[40:43], v[136:139]
    buffer_load_dwordx4 v4, s[8:11], s36 offen offset:1024 lds
    v_mfma_f32_16x16x32_bf16 v[168:171], a[200:203], v[44:47], v[168:171]
    v_mfma_f32_16x16x32_bf16 v[76:79], a[204:207], v[32:35], v[76:79]
    s_add_u32 m0, s47, 0x9000
    v_mfma_f32_16x16x32_bf16 v[108:111], a[204:207], v[36:39], v[108:111]
    buffer_load_dwordx4 v17, s[12:15], s44 offen offset:0 lds
    v_mfma_f32_16x16x32_bf16 v[140:143], a[204:207], v[40:43], v[140:143]
    v_mfma_f32_16x16x32_bf16 v[172:175], a[204:207], v[44:47], v[172:175]
    buffer_load_dwordx4 v18, s[12:15], s44 offen offset:1024 lds
    v_mfma_f32_16x16x32_bf16 v[176:179], a[208:211], v[32:35], v[176:179]
    v_mfma_f32_16x16x32_bf16 v[192:195], a[208:211], v[36:39], v[192:195]
    s_add_u32 m0, s48, 0x9000
    v_mfma_f32_16x16x32_bf16 v[208:211], a[208:211], v[40:43], v[208:211]
    buffer_load_dwordx4 v19, s[16:19], s45 offen lds
    v_mfma_f32_16x16x32_bf16 v[224:227], a[208:211], v[44:47], v[224:227]
    v_mfma_f32_16x16x32_bf16 v[180:183], a[212:215], v[32:35], v[180:183]
    buffer_load_dwordx4 v[240:243], v20, s[20:23], s46 offen offset:0 sc1
    v_mfma_f32_16x16x32_bf16 v[196:199], a[212:215], v[36:39], v[196:199]
    v_mfma_f32_16x16x32_bf16 v[212:215], a[212:215], v[40:43], v[212:215]
    s_add_u32 s50, s50, 0x2000
    buffer_load_dwordx4 v[244:247], v20, s[20:23], s46 offen offset:1024 sc1
    v_mfma_f32_16x16x32_bf16 v[228:231], a[212:215], v[44:47], v[228:231]
    s_add_u32 s51, s51, 0x2000
    v_mfma_f32_16x16x32_bf16 v[184:187], a[216:219], v[32:35], v[184:187]
    s_add_u32 s36, s36, 0x2000
    buffer_load_dwordx4 v[248:251], v20, s[20:23], s46 offen offset:2048 sc1
    v_mfma_f32_16x16x32_bf16 v[200:203], a[216:219], v[36:39], v[200:203]
    s_sub_u32 s49, s49, 1
    v_mfma_f32_16x16x32_bf16 v[216:219], a[216:219], v[40:43], v[216:219]
    buffer_load_dwordx4 v[252:255], v20, s[20:23], s46 offen offset:3072 sc1
    v_mfma_f32_16x16x32_bf16 v[232:235], a[216:219], v[44:47], v[232:235]
    s_add_u32 s44, s44, 0x40000
    v_mfma_f32_16x16x32_bf16 v[188:191], a[220:223], v[32:35], v[188:191]
    s_add_u32 s45, s45, 0x1b000
    v_mfma_f32_16x16x32_bf16 v[204:207], a[220:223], v[36:39], v[204:207]
    s_add_u32 s46, s46, 0x20000
    v_mfma_f32_16x16x32_bf16 v[220:223], a[220:223], v[40:43], v[220:223]
    s_cmp_lg_u32 s49, 0
    v_mfma_f32_16x16x32_bf16 v[236:239], a[220:223], v[44:47], v[236:239]
    s_waitcnt vmcnt(16) lgkmcnt(0)
    s_cbranch_scc1 K1_pro
    s_add_u32 s32, s64, 0x280000
    s_addc_u32 s33, s65, 0
    s_mov_b32 s34, 0x2000
    s_mov_b32 s35, 0x20000
    s_lshl_b32 s54, s42, 6
    v_and_b32 v21, 15, v0
    v_lshl_add_u32 v21, v21, 2, s54
    buffer_load_dword v240, v21, s[32:35], 0 offen offset:0 sc1
    buffer_load_dword v241, v21, s[32:35], 0 offen offset:64 sc1
    buffer_load_dword v242, v21, s[32:35], 0 offen offset:128 sc1
    buffer_load_dword v243, v21, s[32:35], 0 offen offset:192 sc1
    s_mov_b32 s16, s74
    s_mov_b32 s17, s75
    s_mov_b32 s18, 0xd80
    s_mov_b32 s19, 0x20000
    s_lshl_b32 s54, s39, 7
    v_bfe_u32 v22, v0, 4, 2
    v_lshl_add_u32 v22, v22, 3, s54
    buffer_load_dwordx2 v[244:245], v22, s[16:19], 0 offen offset:0
    buffer_load_dwordx2 v[246:247], v22, s[16:19], 0 offen offset:32
    buffer_load_dwordx2 v[248:249], v22, s[16:19], 0 offen offset:64
    buffer_load_dwordx2 v[250:251], v22, s[16:19], 0 offen offset:96
    s_add_u32 m0, s37, 0xa000
    s_nop 0
    buffer_load_dwordx4 v1, s[4:7], s36 offen offset:0 lds
    buffer_load_dwordx4 v2, s[4:7], s36 offen offset:1024 lds
    s_add_u32 m0, s38, 0xa000
    s_nop 0
    buffer_load_dwordx4 v3, s[8:11], s36 offen offset:0 lds
    buffer_load_dwordx4 v4, s[8:11], s36 offen offset:1024 lds
    s_add_u32 s36, s36, 0x2000
    s_add_u32 m0, s37, 0xc000
    s_nop 0
    buffer_load_dwordx4 v1, s[4:7], s36 offen offset:0 lds
    buffer_load_dwordx4 v2, s[4:7], s36 offen offset:1024 lds
    s_add_u32 m0, s38, 0xc000
    s_nop 0
    buffer_load_dwordx4 v3, s[8:11], s36 offen offset:0 lds
    buffer_load_dwordx4 v4, s[8:11], s36 offen offset:1024 lds
    s_add_u32 s36, s36, 0x2000
    ds_read_b128 a[128:131], v5 offset:0
    ds_read_b128 a[132:135], v6 offset:0
    ds_read_b128 a[136:139], v7 offset:0
    ds_read_b128 a[140:143], v8 offset:0
    ds_read_b128 a[144:147], v5 offset:4096
    ds_read_b128 a[148:151], v6 offset:4096
    ds_read_b128 a[152:155], v7 offset:4096
    ds_read_b128 a[156:159], v8 offset:4096
    v_pk_mul_f32 v[174:175], v[174:175], s[52:53]
    v_pk_mul_f32 v[172:173], v[172:173], s[52:53]
    v_cvt_pk_bf16_f32 v175, v174, v175
    v_pk_mul_f32 v[170:171], v[170:171], s[52:53]
    v_cvt_pk_bf16_f32 v174, v172, v173
    v_pk_mul_f32 v[168:169], v[168:169], s[52:53]
    v_cvt_pk_bf16_f32 v173, v170, v171
    v_pk_mul_f32 v[166:167], v[166:167], s[52:53]
    v_cvt_pk_bf16_f32 v172, v168, v169
    v_pk_mul_f32 v[164:165], v[164:165], s[52:53]
    v_cvt_pk_bf16_f32 v171, v166, v167
    v_pk_mul_f32 v[162:163], v[162:163], s[52:53]
    v_cvt_pk_bf16_f32 v170, v164, v165
    v_pk_mul_f32 v[160:161], v[160:161], s[52:53]
    v_cvt_pk_bf16_f32 v169, v162, v163
    v_pk_mul_f32 v[158:159], v[158:159], s[52:53]
    v_cvt_pk_bf16_f32 v168, v160, v161
    v_pk_mul_f32 v[156:157], v[156:157], s[52:53]
    v_cvt_pk_bf16_f32 v167, v158, v159
    v_pk_mul_f32 v[154:155], v[154:155], s[52:53]
    v_cvt_pk_bf16_f32 v166, v156, v157
    v_pk_mul_f32 v[152:153], v[152:153], s[52:53]
    v_cvt_pk_bf16_f32 v165, v154, v155
    v_pk_mul_f32 v[150:151], v[150:151], s[52:53]
    v_cvt_pk_bf16_f32 v164, v152, v153
    v_pk_mul_f32 v[148:149], v[148:149], s[52:53]
    v_cvt_pk_bf16_f32 v163, v150, v151
    v_pk_mul_f32 v[146:147], v[146:147], s[52:53]
    v_cvt_pk_bf16_f32 v162, v148, v149
    v_pk_mul_f32 v[144:145], v[144:145], s[52:53]
    v_cvt_pk_bf16_f32 v161, v146, v147
    v_pk_mul_f32 v[142:143], v[142:143], s[52:53]
    v_cvt_pk_bf16_f32 v160, v144, v145
    v_pk_mul_f32 v[140:141], v[140:141], s[52:53]
    v_cvt_pk_bf16_f32 v159, v142, v143
    v_pk_mul_f32 v[138:139], v[138:139], s[52:53]
    v_cvt_pk_bf16_f32 v158, v140, v141
    v_pk_mul_f32 v[136:137], v[136:137], s[52:53]
    v_cvt_pk_bf16_f32 v157, v138, v139
    v_pk_mul_f32 v[134:135], v[134:135], s[52:53]
    v_cvt_pk_bf16_f32 v156, v136, v137
    v_pk_mul_f32 v[132:133], v[132:133], s[52:53]
    v_cvt_pk_bf16_f32 v155, v134, v135
    v_pk_mul_f32 v[130:131], v[130:131], s[52:53]
    v_cvt_pk_bf16_f32 v154, v132, v133
    v_pk_mul_f32 v[128:129], v[128:129], s[52:53]
    v_cvt_pk_bf16_f32 v153, v130, v131
    v_pk_mul_f32 v[126:127], v[126:127], s[52:53]
    v_cvt_pk_bf16_f32 v152, v128, v129
    v_pk_mul_f32 v[124:125], v[124:125], s[52:53]
    v_cvt_pk_bf16_f32 v151, v126, v127
    v_pk_mul_f32 v[122:123], v[122:123], s[52:53]
    v_cvt_pk_bf16_f32 v150, v124, v125
    v_pk_mul_f32 v[120:121], v[120:121], s[52:53]
    v_cvt_pk_bf16_f32 v149, v122, v123
    v_pk_mul_f32 v[118:119], v[118:119], s[52:53]
    v_cvt_pk_bf16_f32 v148, v120, v121
    v_pk_mul_f32 v[116:117], v[116:117], s[52:53]
    v_cvt_pk_bf16_f32 v147, v118, v119
    v_pk_mul_f32 v[114:115], v[114:115], s[52:53]
    v_cvt_pk_bf16_f32 v146, v116, v117
    v_pk_mul_f32 v[112:113], v[112:113], s[52:53]
    v_cvt_pk_bf16_f32 v145, v114, v115
    v_pk_mul_f32 v[110:111], v[110:111], s[52:53]
    v_cvt_pk_bf16_f32 v144, v112, v113
    v_pk_mul_f32 v[108:109], v[108:109], s[52:53]
    v_cvt_pk_bf16_f32 v143, v110, v111
    v_pk_mul_f32 v[106:107], v[106:107], s[52:53]
    v_cvt_pk_bf16_f32 v142, v108, v109
    v_pk_mul_f32 v[104:105], v[104:105], s[52:53]
    v_cvt_pk_bf16_f32 v141, v106, v107
    v_pk_mul_f32 v[102:103], v[102:103], s[52:53]
    v_cvt_pk_bf16_f32 v140, v104, v105
    v_pk_mul_f32 v[100:101], v[100:101], s[52:53]
    v_cvt_pk_bf16_f32 v139, v102, v103
    v_pk_mul_f32 v[98:99], v[98:99], s[52:53]
    v_cvt_pk_bf16_f32 v138, v100, v101
    v_pk_mul_f32 v[96:97], v[96:97], s[52:53]
    v_cvt_pk_bf16_f32 v137, v98, v99
    v_pk_mul_f32 v[94:95], v[94:95], s[52:53]
    v_cvt_pk_bf16_f32 v136, v96, v97
    v_pk_mul_f32 v[92:93], v[92:93], s[52:53]
    v_cvt_pk_bf16_f32 v135, v94, v95
    v_pk_mul_f32 v[90:91], v[90:91], s[52:53]
    v_cvt_pk_bf16_f32 v134, v92, v93
    v_pk_mul_f32 v[88:89], v[88:89], s[52:53]
    v_cvt_pk_bf16_f32 v133, v90, v91
    v_pk_mul_f32 v[86:87], v[86:87], s[52:53]
    v_cvt_pk_bf16_f32 v132, v88, v89
    v_pk_mul_f32 v[84:85], v[84:85], s[52:53]
    v_cvt_pk_bf16_f32 v131, v86, v87
    v_pk_mul_f32 v[82:83], v[82:83], s[52:53]
    v_cvt_pk_bf16_f32 v130, v84, v85
    v_pk_mul_f32 v[80:81], v[80:81], s[52:53]
    v_cvt_pk_bf16_f32 v129, v82, v83
    v_pk_mul_f32 v[78:79], v[78:79], s[52:53]
    v_cvt_pk_bf16_f32 v128, v80, v81
    v_pk_mul_f32 v[76:77], v[76:77], s[52:53]
    v_cvt_pk_bf16_f32 v127, v78, v79
    v_pk_mul_f32 v[74:75], v[74:75], s[52:53]
    v_cvt_pk_bf16_f32 v126, v76, v77
    v_pk_mul_f32 v[72:73], v[72:73], s[52:53]
    v_cvt_pk_bf16_f32 v125, v74, v75
    v_pk_mul_f32 v[70:71], v[70:71], s[52:53]
    v_cvt_pk_bf16_f32 v124, v72, v73
    v_pk_mul_f32 v[68:69], v[68:69], s[52:53]
    v_cvt_pk_bf16_f32 v123, v70, v71
    v_pk_mul_f32 v[66:67], v[66:67], s[52:53]
    v_cvt_pk_bf16_f32 v122, v68, v69
    v_pk_mul_f32 v[64:65], v[64:65], s[52:53]
    v_cvt_pk_bf16_f32 v121, v66, v67
    v_pk_mul_f32 v[62:63], v[62:63], s[52:53]
    v_cvt_pk_bf16_f32 v120, v64, v65
    v_pk_mul_f32 v[60:61], v[60:61], s[52:53]
    v_cvt_pk_bf16_f32 v119, v62, v63
    v_pk_mul_f32 v[58:59], v[58:59], s[52:53]
    v_cvt_pk_bf16_f32 v118, v60, v61
    v_pk_mul_f32 v[56:57], v[56:57], s[52:53]
    v_cvt_pk_bf16_f32 v117, v58, v59
    v_pk_mul_f32 v[54:55], v[54:55], s[52:53]
    v_cvt_pk_bf16_f32 v116, v56, v57
    v_pk_mul_f32 v[52:53], v[52:53], s[52:53]
    v_cvt_pk_bf16_f32 v115, v54, v55
    v_pk_mul_f32 v[50:51], v[50:51], s[52:53]
    v_cvt_pk_bf16_f32 v114, v52, v53
    v_pk_mul_f32 v[48:49], v[48:49], s[52:53]
    v_cvt_pk_bf16_f32 v113, v50, v51
    v_cvt_pk_bf16_f32 v112, v48, v49
    s_waitcnt lgkmcnt(0)
    s_nop 1
    v_mfma_f32_16x16x32_bf16 v[40:43], a[128:131], v[112:115], 0
    v_mfma_f32_16x16x32_bf16 v[40:43], a[132:135], v[116:119], v[40:43]
    v_mfma_f32_16x16x32_bf16 v[40:43], a[136:139], v[120:123], v[40:43]
    v_mfma_f32_16x16x32_bf16 v[40:43], a[140:143], v[124:127], v[40:43]
    v_mfma_f32_16x16x32_bf16 v[44:47], a[144:147], v[112:115], 0
    v_mfma_f32_16x16x32_bf16 v[44:47], a[148:151], v[116:119], v[44:47]
    v_mfma_f32_16x16x32_bf16 v[44:47], a[152:155], v[120:123], v[44:47]
    v_mfma_f32_16x16x32_bf16 v[44:47], a[156:159], v[124:127], v[44:47]
    v_mfma_f32_16x16x32_bf16 v[48:51], a[128:131], v[128:131], 0
    v_mfma_f32_16x16x32_bf16 v[48:51], a[132:135], v[132:135], v[48:51]
    v_mfma_f32_16x16x32_bf16 v[48:51], a[136:139], v[136:139], v[48:51]
    v_mfma_f32_16x16x32_bf16 v[48:51], a[140:143], v[140:143], v[48:51]
    v_mfma_f32_16x16x32_bf16 v[52:55], a[144:147], v[128:131], 0
    v_mfma_f32_16x16x32_bf16 v[52:55], a[148:151], v[132:135], v[52:55]
    v_mfma_f32_16x16x32_bf16 v[52:55], a[152:155], v[136:139], v[52:55]
    v_mfma_f32_16x16x32_bf16 v[52:55], a[156:159], v[140:143], v[52:55]
    v_mfma_f32_16x16x32_bf16 v[56:59], a[128:131], v[144:147], 0
    v_mfma_f32_16x16x32_bf16 v[56:59], a[132:135], v[148:151], v[56:59]
    v_mfma_f32_16x16x32_bf16 v[56:59], a[136:139], v[152:155], v[56:59]
    v_mfma_f32_16x16x32_bf16 v[56:59], a[140:143], v[156:159], v[56:59]
    v_mfma_f32_16x16x32_bf16 v[60:63], a[144:147], v[144:147], 0
    v_mfma_f32_16x16x32_bf16 v[60:63], a[148:151], v[148:151], v[60:63]
    v_mfma_f32_16x16x32_bf16 v[60:63], a[152:155], v[152:155], v[60:63]
    v_mfma_f32_16x16x32_bf16 v[60:63], a[156:159], v[156:159], v[60:63]
    v_mfma_f32_16x16x32_bf16 v[64:67], a[128:131], v[160:163], 0
    v_mfma_f32_16x16x32_bf16 v[64:67], a[132:135], v[164:167], v[64:67]
    v_mfma_f32_16x16x32_bf16 v[64:67], a[136:139], v[168:171], v[64:67]
    v_mfma_f32_16x16x32_bf16 v[64:67], a[140:143], v[172:175], v[64:67]
    v_mfma_f32_16x16x32_bf16 v[68:71], a[144:147], v[160:163], 0
    v_mfma_f32_16x16x32_bf16 v[68:71], a[148:151], v[164:167], v[68:71]
    v_mfma_f32_16x16x32_bf16 v[68:71], a[152:155], v[168:171], v[68:71]
    v_mfma_f32_16x16x32_bf16 v[68:71], a[156:159], v[172:175], v[68:71]
    s_nop 7
    v_max3_f32 v92, v40, v41, v42
    v_max3_f32 v92, v92, v43, v44
    v_max3_f32 v92, v92, v45, v46
    v_max_f32 v92, v92, v47
    v_max3_f32 v93, v48, v49, v50
    v_max3_f32 v93, v93, v51, v52
    v_max3_f32 v93, v93, v53, v54
    v_max_f32 v93, v93, v55
    v_max3_f32 v94, v56, v57, v58
    v_max3_f32 v94, v94, v59, v60
    v_max3_f32 v94, v94, v61, v62
    v_max_f32 v94, v94, v63
    v_max3_f32 v95, v64, v65, v66
    v_max3_f32 v95, v95, v67, v68
    v_max3_f32 v95, v95, v69, v70
    v_max_f32 v95, v95, v71
    v_mov_b32 v88, v92
    v_mov_b32 v89, v93
    v_mov_b32 v90, v94
    v_mov_b32 v91, v95
    v_permlane32_swap_b32 v92, v88
    v_permlane32_swap_b32 v93, v89
    v_permlane32_swap_b32 v94, v90
    v_permlane32_swap_b32 v95, v91
    v_max_f32 v92, v92, v88
    v_max_f32 v93, v93, v89
    v_max_f32 v94, v94, v90
    v_max_f32 v95, v95, v91
    v_mov_b32 v88, v92
    v_mov_b32 v89, v93
    v_mov_b32 v90, v94
    v_mov_b32 v91, v95
    v_permlane16_swap_b32 v92, v88
    v_permlane16_swap_b32 v93, v89
    v_permlane16_swap_b32 v94, v90
    v_permlane16_swap_b32 v95, v91
    v_max_f32 v92, v92, v88
    v_max_f32 v93, v93, v89
    v_max_f32 v94, v94, v90
    v_max_f32 v95, v95, v91
    v_mul_f32 v24, -1.0, v92
    v_mul_f32 v25, -1.0, v92
    v_mul_f32 v26, -1.0, v92
    v_mul_f32 v27, -1.0, v92
    v_mov_b32 v17, 0
    v_mul_f32 v28, -1.0, v93
    v_mul_f32 v29, -1.0, v93
    v_mul_f32 v30, -1.0, v93
    v_mul_f32 v31, -1.0, v93
    v_mov_b32 v18, 0
    v_mul_f32 v32, -1.0, v94
    v_mul_f32 v33, -1.0, v94
    v_mul_f32 v34, -1.0, v94
    v_mul_f32 v35, -1.0, v94
    v_mov_b32 v19, 0
    v_mul_f32 v36, -1.0, v95
    v_mul_f32 v37, -1.0, v95
    v_mul_f32 v38, -1.0, v95
    v_mul_f32 v39, -1.0, v95
    v_mov_b32 v20, 0
    s_load_dwordx2 s[66:67], s[0:1], 32
    s_load_dwordx2 s[68:69], s[0:1], 64
    s_load_dwordx2 s[70:71], s[0:1], 0
    s_load_dwordx2 s[72:73], s[0:1], 0x50
    s_load_dwordx2 s[74:75], s[0:1], 0x48
    s_add_u32 s28, s64, 0x300000
    s_addc_u32 s29, s65, 0
    s_mov_b32 s30, 0x6c0000
    s_mov_b32 s31, 0x20000
    s_cmp_lt_u32 s39, 27
    s_cselect_b32 s30, 0x6c0000, 0
    s_lshl_b32 s54, s39, 18
    s_lshl_b32 s55, s42, 10
    s_add_u32 s54, s54, s55
    v_and_b32 v22, 63, v0
    v_lshlrev_b32 v22, 4, v22
    v_add_u32 v22, s54, v22
    s_mov_b32 s57, 0x20000
    s_mov_b32 s60, 0xc0135761
    s_mov_b32 s58, 0xbdd2d3e8
    s_mov_b32 s59, 0xbdd2d3e8
    s_waitcnt vmcnt(8)
    v_lshlrev_b32 v40, 16, v244
    v_and_b32 v41, 0xffff0000, v244
    v_lshlrev_b32 v42, 16, v245
    v_and_b32 v43, 0xffff0000, v245
    v_lshlrev_b32 v44, 16, v246
    v_and_b32 v45, 0xffff0000, v246
    v_lshlrev_b32 v46, 16, v247
    v_and_b32 v47, 0xffff0000, v247
    v_lshlrev_b32 v48, 16, v248
    v_and_b32 v49, 0xffff0000, v248
    v_lshlrev_b32 v50, 16, v249
    v_and_b32 v51, 0xffff0000, v249
    v_lshlrev_b32 v52, 16, v250
    v_and_b32 v53, 0xffff0000, v250
    v_lshlrev_b32 v54, 16, v251
    v_and_b32 v55, 0xffff0000, v251
    v_mov_b32 v88, v240
    v_mov_b32 v90, v241
    v_mov_b32 v92, v242
    v_mov_b32 v94, v243
    v_mov_b32 v104, s60
    v_mov_b32 v105, s60
    v_pk_fma_f32 v[56:57], v[176:177], v[88:89], v[40:41] op_sel_hi:[1,0,1]
    v_pk_fma_f32 v[58:59], v[178:179], v[88:89], v[42:43] op_sel_hi:[1,0,1]
    v_pk_fma_f32 v[60:61], v[180:181], v[88:89], v[44:45] op_sel_hi:[1,0,1]
    v_pk_fma_f32 v[62:63], v[182:183], v[88:89], v[46:47] op_sel_hi:[1,0,1]
    v_pk_mul_f32 v[64:65], v[56:57], v[56:57]
    v_pk_mul_f32 v[66:67], v[58:59], v[58:59]
    v_pk_mul_f32 v[68:69], v[60:61], v[60:61]
    v_pk_mul_f32 v[70:71], v[62:63], v[62:63]
    v_pk_fma_f32 v[64:65], v[64:65], s[58:59], v[104:105]
    v_pk_fma_f32 v[66:67], v[66:67], s[58:59], v[104:105]
    v_pk_fma_f32 v[68:69], v[68:69], s[58:59], v[104:105]
    v_pk_fma_f32 v[70:71], v[70:71], s[58:59], v[104:105]
    v_pk_mul_f32 v[64:65], v[64:65], v[56:57]
    v_pk_mul_f32 v[66:67], v[66:67], v[58:59]
    v_pk_mul_f32 v[68:69], v[68:69], v[60:61]
    v_pk_mul_f32 v[70:71], v[70:71], v[62:63]
    v_exp_f32 v64, v64
    v_exp_f32 v65, v65
    v_exp_f32 v66, v66
    v_exp_f32 v67, v67
    v_exp_f32 v68, v68
    v_exp_f32 v69, v69
    v_exp_f32 v70, v70
    v_exp_f32 v71, v71
    v_pk_add_f32 v[64:65], v[64:65], 1.0
    v_pk_add_f32 v[66:67], v[66:67], 1.0
    v_pk_add_f32 v[68:69], v[68:69], 1.0
    v_pk_add_f32 v[70:71], v[70:71], 1.0
    v_rcp_f32 v64, v64
    v_rcp_f32 v65, v65
    v_rcp_f32 v66, v66
    v_rcp_f32 v67, v67
    v_rcp_f32 v68, v68
    v_rcp_f32 v69, v69
    v_rcp_f32 v70, v70
    v_rcp_f32 v71, v71
    v_pk_mul_f32 v[56:57], v[56:57], v[64:65]
    v_pk_mul_f32 v[58:59], v[58:59], v[66:67]
    v_pk_mul_f32 v[60:61], v[60:61], v[68:69]
    v_pk_mul_f32 v[62:63], v[62:63], v[70:71]
    v_cvt_pk_bf16_f32 v72, v56, v57
    v_cvt_pk_bf16_f32 v73, v58, v59
    v_cvt_pk_bf16_f32 v74, v60, v61
    v_cvt_pk_bf16_f32 v75, v62, v63
    buffer_store_dwordx4 v[72:75], v22, s[28:31], 0 offen offset:0 sc1
    v_pk_fma_f32 v[56:57], v[192:193], v[90:91], v[40:41] op_sel_hi:[1,0,1]
    v_pk_fma_f32 v[58:59], v[194:195], v[90:91], v[42:43] op_sel_hi:[1,0,1]
    v_pk_fma_f32 v[60:61], v[196:197], v[90:91], v[44:45] op_sel_hi:[1,0,1]
    v_pk_fma_f32 v[62:63], v[198:199], v[90:91], v[46:47] op_sel_hi:[1,0,1]
    v_pk_mul_f32 v[64:65], v[56:57], v[56:57]
    v_pk_mul_f32 v[66:67], v[58:59], v[58:59]
    v_pk_mul_f32 v[68:69], v[60:61], v[60:61]
    v_pk_mul_f32 v[70:71], v[62:63], v[62:63]
    v_pk_fma_f32 v[64:65], v[64:65], s[58:59], v[104:105]
    v_pk_fma_f32 v[66:67], v[66:67], s[58:59], v[104:105]
    v_pk_fma_f32 v[68:69], v[68:69], s[58:59], v[104:105]
    v_pk_fma_f32 v[70:71], v[70:71], s[58:59], v[104:105]
    v_pk_mul_f32 v[64:65], v[64:65], v[56:57]
    v_pk_mul_f32 v[66:67], v[66:67], v[58:59]
    v_pk_mul_f32 v[68:69], v[68:69], v[60:61]
    v_pk_mul_f32 v[70:71], v[70:71], v[62:63]
    v_exp_f32 v64, v64
    v_exp_f32 v65, v65
    v_exp_f32 v66, v66
    v_exp_f32 v67, v67
    v_exp_f32 v68, v68
    v_exp_f32 v69, v69
    v_exp_f32 v70, v70
    v_exp_f32 v71, v71
    v_pk_add_f32 v[64:65], v[64:65], 1.0
    v_pk_add_f32 v[66:67], v[66:67], 1.0
    v_pk_add_f32 v[68:69], v[68:69], 1.0
    v_pk_add_f32 v[70:71], v[70:71], 1.0
    v_rcp_f32 v64, v64
    v_rcp_f32 v65, v65
    v_rcp_f32 v66, v66
    v_rcp_f32 v67, v67
    v_rcp_f32 v68, v68
    v_rcp_f32 v69, v69
    v_rcp_f32 v70, v70
    v_rcp_f32 v71, v71
    v_pk_mul_f32 v[56:57], v[56:57], v[64:65]
    v_pk_mul_f32 v[58:59], v[58:59], v[66:67]
    v_pk_mul_f32 v[60:61], v[60:61], v[68:69]
    v_pk_mul_f32 v[62:63], v[62:63], v[70:71]
    v_cvt_pk_bf16_f32 v76, v56, v57
    v_cvt_pk_bf16_f32 v77, v58, v59
    v_cvt_pk_bf16_f32 v78, v60, v61
    v_cvt_pk_bf16_f32 v79, v62, v63
    buffer_store_dwordx4 v[76:79], v22, s[28:31], 0 offen offset:1024 sc1
    v_pk_fma_f32 v[56:57], v[208:209], v[92:93], v[40:41] op_sel_hi:[1,0,1]
    v_pk_fma_f32 v[58:59], v[210:211], v[92:93], v[42:43] op_sel_hi:[1,0,1]
    v_pk_fma_f32 v[60:61], v[212:213], v[92:93], v[44:45] op_sel_hi:[1,0,1]
    v_pk_fma_f32 v[62:63], v[214:215], v[92:93], v[46:47] op_sel_hi:[1,0,1]
    v_pk_mul_f32 v[64:65], v[56:57], v[56:57]
    v_pk_mul_f32 v[66:67], v[58:59], v[58:59]
    v_pk_mul_f32 v[68:69], v[60:61], v[60:61]
    v_pk_mul_f32 v[70:71], v[62:63], v[62:63]
    v_pk_fma_f32 v[64:65], v[64:65], s[58:59], v[104:105]
    v_pk_fma_f32 v[66:67], v[66:67], s[58:59], v[104:105]
    v_pk_fma_f32 v[68:69], v[68:69], s[58:59], v[104:105]
    v_pk_fma_f32 v[70:71], v[70:71], s[58:59], v[104:105]
    v_pk_mul_f32 v[64:65], v[64:65], v[56:57]
    v_pk_mul_f32 v[66:67], v[66:67], v[58:59]
    v_pk_mul_f32 v[68:69], v[68:69], v[60:61]
    v_pk_mul_f32 v[70:71], v[70:71], v[62:63]
    v_exp_f32 v64, v64
    v_exp_f32 v65, v65
    v_exp_f32 v66, v66
    v_exp_f32 v67, v67
    v_exp_f32 v68, v68
    v_exp_f32 v69, v69
    v_exp_f32 v70, v70
    v_exp_f32 v71, v71
    v_pk_add_f32 v[64:65], v[64:65], 1.0
    v_pk_add_f32 v[66:67], v[66:67], 1.0
    v_pk_add_f32 v[68:69], v[68:69], 1.0
    v_pk_add_f32 v[70:71], v[70:71], 1.0
    v_rcp_f32 v64, v64
    v_rcp_f32 v65, v65
    v_rcp_f32 v66, v66
    v_rcp_f32 v67, v67
    v_rcp_f32 v68, v68
    v_rcp_f32 v69, v69
    v_rcp_f32 v70, v70
    v_rcp_f32 v71, v71
    v_pk_mul_f32 v[56:57], v[56:57], v[64:65]
    v_pk_mul_f32 v[58:59], v[58:59], v[66:67]
    v_pk_mul_f32 v[60:61], v[60:61], v[68:69]
    v_pk_mul_f32 v[62:63], v[62:63], v[70:71]
    v_cvt_pk_bf16_f32 v80, v56, v57
    v_cvt_pk_bf16_f32 v81, v58, v59
    v_cvt_pk_bf16_f32 v82, v60, v61
    v_cvt_pk_bf16_f32 v83, v62, v63
    buffer_store_dwordx4 v[80:83], v22, s[28:31], 0 offen offset:2048 sc1
    v_pk_fma_f32 v[56:57], v[224:225], v[94:95], v[40:41] op_sel_hi:[1,0,1]
    v_pk_fma_f32 v[58:59], v[226:227], v[94:95], v[42:43] op_sel_hi:[1,0,1]
    v_pk_fma_f32 v[60:61], v[228:229], v[94:95], v[44:45] op_sel_hi:[1,0,1]
    v_pk_fma_f32 v[62:63], v[230:231], v[94:95], v[46:47] op_sel_hi:[1,0,1]
    v_pk_mul_f32 v[64:65], v[56:57], v[56:57]
    v_pk_mul_f32 v[66:67], v[58:59], v[58:59]
    v_pk_mul_f32 v[68:69], v[60:61], v[60:61]
    v_pk_mul_f32 v[70:71], v[62:63], v[62:63]
    v_pk_fma_f32 v[64:65], v[64:65], s[58:59], v[104:105]
    v_pk_fma_f32 v[66:67], v[66:67], s[58:59], v[104:105]
    v_pk_fma_f32 v[68:69], v[68:69], s[58:59], v[104:105]
    v_pk_fma_f32 v[70:71], v[70:71], s[58:59], v[104:105]
    v_pk_mul_f32 v[64:65], v[64:65], v[56:57]
    v_pk_mul_f32 v[66:67], v[66:67], v[58:59]
    v_pk_mul_f32 v[68:69], v[68:69], v[60:61]
    v_pk_mul_f32 v[70:71], v[70:71], v[62:63]
    v_exp_f32 v64, v64
    v_exp_f32 v65, v65
    v_exp_f32 v66, v66
    v_exp_f32 v67, v67
    v_exp_f32 v68, v68
    v_exp_f32 v69, v69
    v_exp_f32 v70, v70
    v_exp_f32 v71, v71
    v_pk_add_f32 v[64:65], v[64:65], 1.0
    v_pk_add_f32 v[66:67], v[66:67], 1.0
    v_pk_add_f32 v[68:69], v[68:69], 1.0
    v_pk_add_f32 v[70:71], v[70:71], 1.0
    v_rcp_f32 v64, v64
    v_rcp_f32 v65, v65
    v_rcp_f32 v66, v66
    v_rcp_f32 v67, v67
    v_rcp_f32 v68, v68
    v_rcp_f32 v69, v69
    v_rcp_f32 v70, v70
    v_rcp_f32 v71, v71
    v_pk_mul_f32 v[56:57], v[56:57], v[64:65]
    v_pk_mul_f32 v[58:59], v[58:59], v[66:67]
    v_pk_mul_f32 v[60:61], v[60:61], v[68:69]
    v_pk_mul_f32 v[62:63], v[62:63], v[70:71]
    v_cvt_pk_bf16_f32 v84, v56, v57
    v_cvt_pk_bf16_f32 v85, v58, v59
    v_cvt_pk_bf16_f32 v86, v60, v61
    v_cvt_pk_bf16_f32 v87, v62, v63
    buffer_store_dwordx4 v[84:87], v22, s[28:31], 0 offen offset:3072 sc1
    v_pk_fma_f32 v[56:57], v[184:185], v[88:89], v[48:49] op_sel_hi:[1,0,1]
    v_pk_fma_f32 v[58:59], v[186:187], v[88:89], v[50:51] op_sel_hi:[1,0,1]
    v_pk_fma_f32 v[60:61], v[188:189], v[88:89], v[52:53] op_sel_hi:[1,0,1]
    v_pk_fma_f32 v[62:63], v[190:191], v[88:89], v[54:55] op_sel_hi:[1,0,1]
    v_pk_mul_f32 v[64:65], v[56:57], v[56:57]
    v_pk_mul_f32 v[66:67], v[58:59], v[58:59]
    v_pk_mul_f32 v[68:69], v[60:61], v[60:61]
    v_pk_mul_f32 v[70:71], v[62:63], v[62:63]
    v_pk_fma_f32 v[64:65], v[64:65], s[58:59], v[104:105]
    v_pk_fma_f32 v[66:67], v[66:67], s[58:59], v[104:105]
    v_pk_fma_f32 v[68:69], v[68:69], s[58:59], v[104:105]
    v_pk_fma_f32 v[70:71], v[70:71], s[58:59], v[104:105]
    v_pk_mul_f32 v[64:65], v[64:65], v[56:57]
    v_pk_mul_f32 v[66:67], v[66:67], v[58:59]
    v_pk_mul_f32 v[68:69], v[68:69], v[60:61]
    v_pk_mul_f32 v[70:71], v[70:71], v[62:63]
    v_exp_f32 v64, v64
    v_exp_f32 v65, v65
    v_exp_f32 v66, v66
    v_exp_f32 v67, v67
    v_exp_f32 v68, v68
    v_exp_f32 v69, v69
    v_exp_f32 v70, v70
    v_exp_f32 v71, v71
    v_pk_add_f32 v[64:65], v[64:65], 1.0
    v_pk_add_f32 v[66:67], v[66:67], 1.0
    v_pk_add_f32 v[68:69], v[68:69], 1.0
    v_pk_add_f32 v[70:71], v[70:71], 1.0
    v_rcp_f32 v64, v64
    v_rcp_f32 v65, v65
    v_rcp_f32 v66, v66
    v_rcp_f32 v67, v67
    v_rcp_f32 v68, v68
    v_rcp_f32 v69, v69
    v_rcp_f32 v70, v70
    v_rcp_f32 v71, v71
    v_pk_mul_f32 v[56:57], v[56:57], v[64:65]
    v_pk_mul_f32 v[58:59], v[58:59], v[66:67]
    v_pk_mul_f32 v[60:61], v[60:61], v[68:69]
    v_pk_mul_f32 v[62:63], v[62:63], v[70:71]
    v_cvt_pk_bf16_f32 v72, v56, v57
    v_cvt_pk_bf16_f32 v73, v58, v59
    v_cvt_pk_bf16_f32 v74, v60, v61
    v_cvt_pk_bf16_f32 v75, v62, v63
    buffer_store_dwordx4 v[72:75], v22, s[28:31], s57 offen offset:0 sc1
    v_pk_fma_f32 v[56:57], v[200:201], v[90:91], v[48:49] op_sel_hi:[1,0,1]
    v_pk_fma_f32 v[58:59], v[202:203], v[90:91], v[50:51] op_sel_hi:[1,0,1]
    v_pk_fma_f32 v[60:61], v[204:205], v[90:91], v[52:53] op_sel_hi:[1,0,1]
    v_pk_fma_f32 v[62:63], v[206:207], v[90:91], v[54:55] op_sel_hi:[1,0,1]
    v_pk_mul_f32 v[64:65], v[56:57], v[56:57]
    v_pk_mul_f32 v[66:67], v[58:59], v[58:59]
    v_pk_mul_f32 v[68:69], v[60:61], v[60:61]
    v_pk_mul_f32 v[70:71], v[62:63], v[62:63]
    v_pk_fma_f32 v[64:65], v[64:65], s[58:59], v[104:105]
    v_pk_fma_f32 v[66:67], v[66:67], s[58:59], v[104:105]
    v_pk_fma_f32 v[68:69], v[68:69], s[58:59], v[104:105]
    v_pk_fma_f32 v[70:71], v[70:71], s[58:59], v[104:105]
    v_pk_mul_f32 v[64:65], v[64:65], v[56:57]
    v_pk_mul_f32 v[66:67], v[66:67], v[58:59]
    v_pk_mul_f32 v[68:69], v[68:69], v[60:61]
    v_pk_mul_f32 v[70:71], v[70:71], v[62:63]
    v_exp_f32 v64, v64
    v_exp_f32 v65, v65
    v_exp_f32 v66, v66
    v_exp_f32 v67, v67
    v_exp_f32 v68, v68
    v_exp_f32 v69, v69
    v_exp_f32 v70, v70
    v_exp_f32 v71, v71
    v_pk_add_f32 v[64:65], v[64:65], 1.0
    v_pk_add_f32 v[66:67], v[66:67], 1.0
    v_pk_add_f32 v[68:69], v[68:69], 1.0
    v_pk_add_f32 v[70:71], v[70:71], 1.0
    v_rcp_f32 v64, v64
    v_rcp_f32 v65, v65
    v_rcp_f32 v66, v66
    v_rcp_f32 v67, v67
    v_rcp_f32 v68, v68
    v_rcp_f32 v69, v69
    v_rcp_f32 v70, v70
    v_rcp_f32 v71, v71
    v_pk_mul_f32 v[56:57], v[56:57], v[64:65]
    v_pk_mul_f32 v[58:59], v[58:59], v[66:67]
    v_pk_mul_f32 v[60:61], v[60:61], v[68:69]
    v_pk_mul_f32 v[62:63], v[62:63], v[70:71]
    v_cvt_pk_bf16_f32 v76, v56, v57
    v_cvt_pk_bf16_f32 v77, v58, v59
    v_cvt_pk_bf16_f32 v78, v60, v61
    v_cvt_pk_bf16_f32 v79, v62, v63
    buffer_store_dwordx4 v[76:79], v22, s[28:31], s57 offen offset:1024 sc1
    v_pk_fma_f32 v[56:57], v[216:217], v[92:93], v[48:49] op_sel_hi:[1,0,1]
    v_pk_fma_f32 v[58:59], v[218:219], v[92:93], v[50:51] op_sel_hi:[1,0,1]
    v_pk_fma_f32 v[60:61], v[220:221], v[92:93], v[52:53] op_sel_hi:[1,0,1]
    v_pk_fma_f32 v[62:63], v[222:223], v[92:93], v[54:55] op_sel_hi:[1,0,1]
    v_pk_mul_f32 v[64:65], v[56:57], v[56:57]
    v_pk_mul_f32 v[66:67], v[58:59], v[58:59]
    v_pk_mul_f32 v[68:69], v[60:61], v[60:61]
    v_pk_mul_f32 v[70:71], v[62:63], v[62:63]
    v_pk_fma_f32 v[64:65], v[64:65], s[58:59], v[104:105]
    v_pk_fma_f32 v[66:67], v[66:67], s[58:59], v[104:105]
    v_pk_fma_f32 v[68:69], v[68:69], s[58:59], v[104:105]
    v_pk_fma_f32 v[70:71], v[70:71], s[58:59], v[104:105]
    v_pk_mul_f32 v[64:65], v[64:65], v[56:57]
    v_pk_mul_f32 v[66:67], v[66:67], v[58:59]
    v_pk_mul_f32 v[68:69], v[68:69], v[60:61]
    v_pk_mul_f32 v[70:71], v[70:71], v[62:63]
    v_exp_f32 v64, v64
    v_exp_f32 v65, v65
    v_exp_f32 v66, v66
    v_exp_f32 v67, v67
    v_exp_f32 v68, v68
    v_exp_f32 v69, v69
    v_exp_f32 v70, v70
    v_exp_f32 v71, v71
    v_pk_add_f32 v[64:65], v[64:65], 1.0
    v_pk_add_f32 v[66:67], v[66:67], 1.0
    v_pk_add_f32 v[68:69], v[68:69], 1.0
    v_pk_add_f32 v[70:71], v[70:71], 1.0
    v_rcp_f32 v64, v64
    v_rcp_f32 v65, v65
    v_rcp_f32 v66, v66
    v_rcp_f32 v67, v67
    v_rcp_f32 v68, v68
    v_rcp_f32 v69, v69
    v_rcp_f32 v70, v70
    v_rcp_f32 v71, v71
    v_pk_mul_f32 v[56:57], v[56:57], v[64:65]
    v_pk_mul_f32 v[58:59], v[58:59], v[66:67]
    v_pk_mul_f32 v[60:61], v[60:61], v[68:69]
    v_pk_mul_f32 v[62:63], v[62:63], v[70:71]
    v_cvt_pk_bf16_f32 v80, v56, v57
    v_cvt_pk_bf16_f32 v81, v58, v59
    v_cvt_pk_bf16_f32 v82, v60, v61
    v_cvt_pk_bf16_f32 v83, v62, v63
    buffer_store_dwordx4 v[80:83], v22, s[28:31], s57 offen offset:2048 sc1
    v_pk_fma_f32 v[56:57], v[232:233], v[94:95], v[48:49] op_sel_hi:[1,0,1]
    v_pk_fma_f32 v[58:59], v[234:235], v[94:95], v[50:51] op_sel_hi:[1,0,1]
    v_pk_fma_f32 v[60:61], v[236:237], v[94:95], v[52:53] op_sel_hi:[1,0,1]
    v_pk_fma_f32 v[62:63], v[238:239], v[94:95], v[54:55] op_sel_hi:[1,0,1]
    v_pk_mul_f32 v[64:65], v[56:57], v[56:57]
    v_pk_mul_f32 v[66:67], v[58:59], v[58:59]
    v_pk_mul_f32 v[68:69], v[60:61], v[60:61]
    v_pk_mul_f32 v[70:71], v[62:63], v[62:63]
    v_pk_fma_f32 v[64:65], v[64:65], s[58:59], v[104:105]
    v_pk_fma_f32 v[66:67], v[66:67], s[58:59], v[104:105]
    v_pk_fma_f32 v[68:69], v[68:69], s[58:59], v[104:105]
    v_pk_fma_f32 v[70:71], v[70:71], s[58:59], v[104:105]
    v_pk_mul_f32 v[64:65], v[64:65], v[56:57]
    v_pk_mul_f32 v[66:67], v[66:67], v[58:59]
    v_pk_mul_f32 v[68:69], v[68:69], v[60:61]
    v_pk_mul_f32 v[70:71], v[70:71], v[62:63]
    v_exp_f32 v64, v64
    v_exp_f32 v65, v65
    v_exp_f32 v66, v66
    v_exp_f32 v67, v67
    v_exp_f32 v68, v68
    v_exp_f32 v69, v69
    v_exp_f32 v70, v70
    v_exp_f32 v71, v71
    v_pk_add_f32 v[64:65], v[64:65], 1.0
    v_pk_add_f32 v[66:67], v[66:67], 1.0
    v_pk_add_f32 v[68:69], v[68:69], 1.0
    v_pk_add_f32 v[70:71], v[70:71], 1.0
    v_rcp_f32 v64, v64
    v_rcp_f32 v65, v65
    v_rcp_f32 v66, v66
    v_rcp_f32 v67, v67
    v_rcp_f32 v68, v68
    v_rcp_f32 v69, v69
    v_rcp_f32 v70, v70
    v_rcp_f32 v71, v71
    v_pk_mul_f32 v[56:57], v[56:57], v[64:65]
    v_pk_mul_f32 v[58:59], v[58:59], v[66:67]
    v_pk_mul_f32 v[60:61], v[60:61], v[68:69]
    v_pk_mul_f32 v[62:63], v[62:63], v[70:71]
    v_cvt_pk_bf16_f32 v84, v56, v57
    v_cvt_pk_bf16_f32 v85, v58, v59
    v_cvt_pk_bf16_f32 v86, v60, v61
    v_cvt_pk_bf16_f32 v87, v62, v63
    buffer_store_dwordx4 v[84:87], v22, s[28:31], s57 offen offset:3072 sc1
    s_waitcnt lgkmcnt(0)
    s_and_b32 s46, s2, 3
    s_bfe_u32 s54, s2, 0x10002
    s_bfe_u32 s47, s2, 0x20003
    s_lshl_b32 s55, s40, 1
    s_add_u32 s54, s54, s55
    s_lshl_b32 s48, s54, 3
    v_and_b32 v240, 63, v0
    v_lshrrev_b32 v241, 6, v0
    s_mul_i32 s55, s47, 0x140
    v_mul_u32_u24 v242, 0x140, v241
    v_add_u32 v242, v242, v240
    v_add_u32 v243, 0, v242
    v_mul_u32_u24 v244, 0xcccd, v243
    v_lshrrev_b32 v244, 20, v244
    v_mul_u32_u24 v245, 20, v244
    v_sub_u32 v243, v243, v245
    v_bfe_u32 v245, v244, 2, 1
    v_lshlrev_b32 v245, 1, v245
    v_xor_b32 v243, v243, v245
    v_mul_u32_u24 v244, 0x500, v244
    v_lshl_add_u32 v244, v243, 4, v244
    v_add_u32 v192, s55, v244
    v_add_u32 v243, 64, v242
    v_mul_u32_u24 v244, 0xcccd, v243
    v_lshrrev_b32 v244, 20, v244
    v_mul_u32_u24 v245, 20, v244
    v_sub_u32 v243, v243, v245
    v_bfe_u32 v245, v244, 2, 1
    v_lshlrev_b32 v245, 1, v245
    v_xor_b32 v243, v243, v245
    v_mul_u32_u24 v244, 0x500, v244
    v_lshl_add_u32 v244, v243, 4, v244
    v_add_u32 v244, s55, v244
    v_subrev_u32 v193, 0x400, v244
    v_add_u32 v243, 0x80, v242
    v_mul_u32_u24 v244, 0xcccd, v243
    v_lshrrev_b32 v244, 20, v244
    v_mul_u32_u24 v245, 20, v244
    v_sub_u32 v243, v243, v245
    v_bfe_u32 v245, v244, 2, 1
    v_lshlrev_b32 v245, 1, v245
    v_xor_b32 v243, v243, v245
    v_mul_u32_u24 v244, 0x500, v244
    v_lshl_add_u32 v244, v243, 4, v244
    v_add_u32 v244, s55, v244
    v_subrev_u32 v194, 0x800, v244
    v_add_u32 v243, 0xc0, v242
    v_mul_u32_u24 v244, 0xcccd, v243
    v_lshrrev_b32 v244, 20, v244
    v_mul_u32_u24 v245, 20, v244
    v_sub_u32 v243, v243, v245
    v_bfe_u32 v245, v244, 2, 1
    v_lshlrev_b32 v245, 1, v245
    v_xor_b32 v243, v243, v245
    v_mul_u32_u24 v244, 0x500, v244
    v_lshl_add_u32 v244, v243, 4, v244
    v_add_u32 v244, s55, v244
    v_subrev_u32 v195, 0xc00, v244
    v_add_u32 v243, 0x100, v242
    v_mul_u32_u24 v244, 0xcccd, v243
    v_lshrrev_b32 v244, 20, v244
    v_mul_u32_u24 v245, 20, v244
    v_sub_u32 v243, v243, v245
    v_bfe_u32 v245, v244, 2, 1
    v_lshlrev_b32 v245, 1, v245
    v_xor_b32 v243, v243, v245
    v_mul_u32_u24 v244, 0x500, v244
    v_lshl_add_u32 v244, v243, 4, v244
    v_add_u32 v196, s55, v244
    s_lshl_b32 s54, s41, 1
    s_add_u32 s54, s54, s48
    s_lshl_b32 s54, s54, 10
    v_lshlrev_b32 v197, 4, v240
    v_add_u32 v197, s54, v197
    v_add_u32 v198, 0x20000, v197
    v_lshrrev_b32 v242, 4, v240
    v_bfe_u32 v243, v240, 2, 2
    v_lshl_add_u32 v243, v242, 2, v243
    v_mul_u32_u24 v243, 0x140, v243
    v_and_b32 v244, 3, v240
    v_lshl_add_u32 v243, v244, 3, v243
    v_and_b32 v242, 1, v242
    v_lshlrev_b32 v242, 5, v242
    v_add_u32 v199, v243, v242
    v_sub_u32 v200, v243, v242
    v_add_u32 v201, 0x10000, v199
    v_add_u32 v202, 0x10000, v200
    v_add_u32 v213, 0x20000, v199
    v_add_u32 v214, 0x20000, v200
    v_lshlrev_b32 v203, 4, v240
    s_mov_b32 s16, s68
    s_mov_b32 s17, s69
    s_mov_b32 s18, 0x21c000
    s_mov_b32 s19, 0x20000
    s_add_u32 s20, s64, 0x300000
    s_addc_u32 s21, s65, 0
    s_mov_b32 s22, 0x6c0000
    s_mov_b32 s23, 0x20000
    s_mul_i32 s32, s46, 0x8c000
    s_mul_i32 s33, s46, 0x1c0000
    s_mul_i32 s34, s41, 0x1400
    s_mul_i32 s54, s46, 0x1c0000
    s_lshl_b32 s55, s47, 2
    s_add_u32 s55, s55, s41
    s_mul_i32 s55, s55, 56
    v_and_b32 v240, 63, v0
    v_add_u32 v241, s55, v240
    v_lshrrev_b32 v242, 6, v241
    v_and_b32 v241, 63, v241
    v_lshlrev_b32 v241, 7, v241
    v_lshl_add_u32 v241, v242, 17, v241
    s_lshl_b32 s3, s48, 10
    s_add_u32 s3, s3, s54
    v_add_u32 v241, s3, v241
    v_cmp_gt_u32 vcc, 56, v240
    v_mov_b32 v242, 0x40000000
    s_nop 0
    v_cndmask_b32 v241, v242, v241, vcc
    v_mov_b32 v215, v241
    s_and_b32 s54, s2, 3
    s_lshr_b32 s55, s2, 3
    s_lshl_b32 s55, s55, 2
    s_add_u32 s55, s55, s41
    v_and_b32 v240, 63, v0
    v_mov_b32 v241, 0x40000000
    s_mul_i32 s3, s54, 0x8c000
    s_mul_i32 s49, s55, 0x1180
    s_add_u32 s3, s3, s49
    v_cmp_gt_u32 vcc, 35, v240
    v_lshl_add_u32 v93, v240, 7, s3
    s_mov_b32 s28, s68
    s_mov_b32 s29, s69
    s_mov_b32 s30, 0
    s_mov_b32 s31, 0x20000
    v_cndmask_b32 v93, v241, v93, vcc
    s_mul_i32 s3, s54, 0x140000
    s_mul_i32 s49, s55, 0x2800
    s_add_u32 s3, s3, s49
    v_cmp_gt_u32 vcc, 16, v240
    v_lshl_add_u32 v94, v240, 7, s3
    s_mov_b32 s24, s66
    s_mov_b32 s25, s67
    s_mov_b32 s26, 0
    s_mov_b32 s27, 0x20000
    v_add_u32 v95, 0x2000, v94
    v_cndmask_b32 v95, v241, v95, vcc
    v_cmp_eq_u32 vcc, 0, v0
    s_lshl_b32 s3, s2, 7
    v_mov_b32 v240, s3
    v_mov_b32 v108, 0x40000000
    v_cndmask_b32 v108, v108, v240, vcc
    s_lshl_b32 s3, s40, 12
    v_and_b32 v240, 31, v0
    v_lshlrev_b32 v240, 7, v240
    v_add_u32 v110, s3, v240
    s_add_u32 s3, s78, 2
    v_mov_b32 v109, s3
    s_mov_b32 s50, -1
    s_mov_b32 s51, 0
    s_nop 1
    v_mfma_f32_16x16x32_bf16 v[40:43], a[128:131], v[112:115], v[24:27]
    s_barrier
    v_mfma_f32_16x16x32_bf16 v[40:43], a[132:135], v[116:119], v[40:43]
    s_add_u32 m0, s37, 0xe000
    v_mfma_f32_16x16x32_bf16 v[40:43], a[136:139], v[120:123], v[40:43]
    buffer_load_dwordx4 v1, s[4:7], s36 offen offset:0 lds
    v_mfma_f32_16x16x32_bf16 v[40:43], a[140:143], v[124:127], v[40:43]
    s_waitcnt lgkmcnt(0)
    v_mfma_f32_16x16x32_bf16 v[44:47], a[144:147], v[112:115], v[24:27]
    v_mfma_f32_16x16x32_bf16 v[44:47], a[148:151], v[116:119], v[44:47]
    v_mfma_f32_16x16x32_bf16 v[44:47], a[152:155], v[120:123], v[44:47]
    buffer_load_dwordx4 v2, s[4:7], s36 offen offset:1024 lds
    v_mfma_f32_16x16x32_bf16 v[44:47], a[156:159], v[124:127], v[44:47]
    v_mfma_f32_16x16x32_bf16 v[48:51], a[128:131], v[128:131], v[28:31]
    v_mfma_f32_16x16x32_bf16 v[48:51], a[132:135], v[132:135], v[48:51]
    s_add_u32 m0, s38, 0xe000
    v_exp_f32 v40, v40
    v_mfma_f32_16x16x32_bf16 v[48:51], a[136:139], v[136:139], v[48:51]
    buffer_load_dwordx4 v3, s[8:11], s36 offen offset:0 lds
    v_add_f32 v17, v17, v40
    v_mfma_f32_16x16x32_bf16 v[48:51], a[140:143], v[140:143], v[48:51]
    v_exp_f32 v41, v41
    v_mfma_f32_16x16x32_bf16 v[52:55], a[144:147], v[128:131], v[28:31]
    v_add_f32 v17, v17, v41
    v_cvt_pk_bf16_f32 v72, v40, v41
    v_mfma_f32_16x16x32_bf16 v[52:55], a[148:151], v[132:135], v[52:55]
    v_exp_f32 v42, v42
    v_mfma_f32_16x16x32_bf16 v[52:55], a[152:155], v[136:139], v[52:55]
    buffer_load_dwordx4 v4, s[8:11], s36 offen offset:1024 lds
    v_add_f32 v17, v17, v42
    v_mfma_f32_16x16x32_bf16 v[52:55], a[156:159], v[140:143], v[52:55]
    s_add_u32 s36, s36, 0x2000
    v_exp_f32 v43, v43
    s_nop 0
    v_add_f32 v17, v17, v43
    v_cvt_pk_bf16_f32 v73, v42, v43
    s_nop 0
    v_exp_f32 v44, v44
    s_nop 0
    ds_read_b64_tr_b16 a[160:161], v9 offset:0
    v_add_f32 v17, v17, v44
    s_nop 0
    v_exp_f32 v45, v45
    s_nop 0
    ds_read_b64_tr_b16 a[162:163], v9 offset:4096
    v_add_f32 v17, v17, v45
    v_cvt_pk_bf16_f32 v74, v44, v45
    s_nop 0
    v_exp_f32 v46, v46
    s_nop 0
    ds_read_b64_tr_b16 a[164:165], v10 offset:0
    v_add_f32 v17, v17, v46
    s_nop 0
    v_exp_f32 v47, v47
    s_nop 0
    ds_read_b64_tr_b16 a[166:167], v10 offset:4096
    v_add_f32 v17, v17, v47
    v_cvt_pk_bf16_f32 v75, v46, v47
    s_nop 0
    v_exp_f32 v48, v48
    s_nop 0
    ds_read_b64_tr_b16 a[168:169], v11 offset:0
    v_add_f32 v18, v18, v48
    s_nop 0
    v_exp_f32 v49, v49
    s_nop 0
    ds_read_b64_tr_b16 a[170:171], v11 offset:4096
    v_add_f32 v18, v18, v49
    v_cvt_pk_bf16_f32 v76, v48, v49
    s_nop 0
    v_exp_f32 v50, v50
    s_nop 0
    ds_read_b64_tr_b16 a[172:173], v12 offset:0
    v_add_f32 v18, v18, v50
    s_nop 0
    v_exp_f32 v51, v51
    v_mfma_f32_16x16x32_bf16 v[56:59], a[128:131], v[144:147], v[32:35]
    ds_read_b64_tr_b16 a[174:175], v12 offset:4096
    v_add_f32 v18, v18, v51
    v_cvt_pk_bf16_f32 v77, v50, v51
    v_mfma_f32_16x16x32_bf16 v[56:59], a[132:135], v[148:151], v[56:59]
    v_exp_f32 v52, v52
    v_mfma_f32_16x16x32_bf16 v[56:59], a[136:139], v[152:155], v[56:59]
    ds_read_b64_tr_b16 a[176:177], v13 offset:0
    v_add_f32 v18, v18, v52
    v_mfma_f32_16x16x32_bf16 v[56:59], a[140:143], v[156:159], v[56:59]
    v_exp_f32 v53, v53
    v_mfma_f32_16x16x32_bf16 v[60:63], a[144:147], v[144:147], v[32:35]
    ds_read_b64_tr_b16 a[178:179], v13 offset:4096
    v_add_f32 v18, v18, v53
    v_cvt_pk_bf16_f32 v78, v52, v53
    v_mfma_f32_16x16x32_bf16 v[60:63], a[148:151], v[148:151], v[60:63]
    v_exp_f32 v54, v54
    v_mfma_f32_16x16x32_bf16 v[60:63], a[152:155], v[152:155], v[60:63]
    ds_read_b64_tr_b16 a[180:181], v14 offset:0
    v_add_f32 v18, v18, v54
    v_mfma_f32_16x16x32_bf16 v[60:63], a[156:159], v[156:159], v[60:63]
    v_exp_f32 v55, v55
    v_mfma_f32_16x16x32_bf16 v[64:67], a[128:131], v[160:163], v[36:39]
    ds_read_b64_tr_b16 a[182:183], v14 offset:4096
    v_add_f32 v18, v18, v55
    v_cvt_pk_bf16_f32 v79, v54, v55
    v_mfma_f32_16x16x32_bf16 v[64:67], a[132:135], v[164:167], v[64:67]
    v_exp_f32 v56, v56
    v_mfma_f32_16x16x32_bf16 v[64:67], a[136:139], v[168:171], v[64:67]
    ds_read_b64_tr_b16 a[184:185], v15 offset:0
    v_add_f32 v19, v19, v56
    v_mfma_f32_16x16x32_bf16 v[64:67], a[140:143], v[172:175], v[64:67]
    v_exp_f32 v57, v57
    v_mfma_f32_16x16x32_bf16 v[68:71], a[144:147], v[160:163], v[36:39]
    ds_read_b64_tr_b16 a[186:187], v15 offset:4096
    v_add_f32 v19, v19, v57
    v_cvt_pk_bf16_f32 v80, v56, v57
    v_mfma_f32_16x16x32_bf16 v[68:71], a[148:151], v[164:167], v[68:71]
    v_exp_f32 v58, v58
    v_mfma_f32_16x16x32_bf16 v[68:71], a[152:155], v[168:171], v[68:71]
    ds_read_b64_tr_b16 a[188:189], v16 offset:0
    v_add_f32 v19, v19, v58
    v_mfma_f32_16x16x32_bf16 v[68:71], a[156:159], v[172:175], v[68:71]
    s_waitcnt lgkmcnt(7)
    v_exp_f32 v59, v59
    v_mfma_f32_16x16x32_bf16 a[0:3], a[160:163], v[72:75], a[0:3]
    ds_read_b64_tr_b16 a[190:191], v16 offset:4096
    v_add_f32 v19, v19, v59
    v_cvt_pk_bf16_f32 v81, v58, v59
    v_mfma_f32_16x16x32_bf16 a[4:7], a[160:163], v[76:79], a[4:7]
    ds_read_b128 a[128:131], v5 offset:8192
    v_exp_f32 v60, v60
    v_mfma_f32_16x16x32_bf16 a[16:19], a[164:167], v[72:75], a[16:19]
    ds_read_b128 a[132:135], v6 offset:8192
    v_add_f32 v19, v19, v60
    v_mfma_f32_16x16x32_bf16 a[20:23], a[164:167], v[76:79], a[20:23]
    v_exp_f32 v61, v61
    v_mfma_f32_16x16x32_bf16 a[32:35], a[168:171], v[72:75], a[32:35]
    ds_read_b128 a[136:139], v7 offset:8192
    v_add_f32 v19, v19, v61
    v_cvt_pk_bf16_f32 v82, v60, v61
    v_mfma_f32_16x16x32_bf16 a[36:39], a[168:171], v[76:79], a[36:39]
    v_exp_f32 v62, v62
    v_mfma_f32_16x16x32_bf16 a[48:51], a[172:175], v[72:75], a[48:51]
    ds_read_b128 a[140:143], v8 offset:8192
    v_add_f32 v19, v19, v62
    v_mfma_f32_16x16x32_bf16 a[52:55], a[172:175], v[76:79], a[52:55]
    s_waitcnt lgkmcnt(4)
    v_exp_f32 v63, v63
    v_mfma_f32_16x16x32_bf16 a[64:67], a[176:179], v[72:75], a[64:67]
    ds_read_b128 a[144:147], v5 offset:12288
    v_add_f32 v19, v19, v63
    v_cvt_pk_bf16_f32 v83, v62, v63
    v_mfma_f32_16x16x32_bf16 a[68:71], a[176:179], v[76:79], a[68:71]
    v_exp_f32 v64, v64
    v_mfma_f32_16x16x32_bf16 a[80:83], a[180:183], v[72:75], a[80:83]
    ds_read_b128 a[148:151], v6 offset:12288
    v_add_f32 v20, v20, v64
    v_mfma_f32_16x16x32_bf16 a[84:87], a[180:183], v[76:79], a[84:87]
    v_exp_f32 v65, v65
    v_mfma_f32_16x16x32_bf16 a[96:99], a[184:187], v[72:75], a[96:99]
    ds_read_b128 a[152:155], v7 offset:12288
    v_add_f32 v20, v20, v65
    v_cvt_pk_bf16_f32 v84, v64, v65
    v_mfma_f32_16x16x32_bf16 a[100:103], a[184:187], v[76:79], a[100:103]
    v_exp_f32 v66, v66
    v_mfma_f32_16x16x32_bf16 a[112:115], a[188:191], v[72:75], a[112:115]
    ds_read_b128 a[156:159], v8 offset:12288
    v_add_f32 v20, v20, v66
    v_mfma_f32_16x16x32_bf16 a[116:119], a[188:191], v[76:79], a[116:119]
    s_waitcnt vmcnt(20) lgkmcnt(4)
    v_exp_f32 v67, v67
    s_mov_b32 s49, 7
    s_branch K1_u1
.p2align 6
K1_loop:
    v_mfma_f32_16x16x32_bf16 v[40:43], a[128:131], v[112:115], v[24:27]
    s_barrier
    v_add_f32 v20, v20, v67
    v_cvt_pk_bf16_f32 v85, v66, v67
    v_mfma_f32_16x16x32_bf16 v[40:43], a[132:135], v[116:119], v[40:43]
    s_add_u32 m0, s37, 0xe000
    v_exp_f32 v68, v68
    v_mfma_f32_16x16x32_bf16 v[40:43], a[136:139], v[120:123], v[40:43]
    buffer_load_dwordx4 v1, s[4:7], s36 offen offset:0 lds
    v_add_f32 v20, v20, v68
    v_mfma_f32_16x16x32_bf16 v[40:43], a[140:143], v[124:127], v[40:43]
    s_waitcnt lgkmcnt(0)
    v_exp_f32 v69, v69
    v_mfma_f32_16x16x32_bf16 v[44:47], a[144:147], v[112:115], v[24:27]
    v_add_f32 v20, v20, v69
    v_cvt_pk_bf16_f32 v86, v68, v69
    v_mfma_f32_16x16x32_bf16 v[44:47], a[148:151], v[116:119], v[44:47]
    v_exp_f32 v70, v70
    v_mfma_f32_16x16x32_bf16 v[44:47], a[152:155], v[120:123], v[44:47]
    buffer_load_dwordx4 v2, s[4:7], s36 offen offset:1024 lds
    v_add_f32 v20, v20, v70
    v_mfma_f32_16x16x32_bf16 v[44:47], a[156:159], v[124:127], v[44:47]
    v_exp_f32 v71, v71
    v_mfma_f32_16x16x32_bf16 v[48:51], a[128:131], v[128:131], v[28:31]
    v_add_f32 v20, v20, v71
    v_cvt_pk_bf16_f32 v87, v70, v71
    v_mfma_f32_16x16x32_bf16 v[48:51], a[132:135], v[132:135], v[48:51]
    s_add_u32 m0, s38, 0xe000
    v_exp_f32 v40, v40
    v_mfma_f32_16x16x32_bf16 v[48:51], a[136:139], v[136:139], v[48:51]
    buffer_load_dwordx4 v3, s[8:11], s36 offen offset:0 lds
    v_add_f32 v17, v17, v40
    v_mfma_f32_16x16x32_bf16 v[48:51], a[140:143], v[140:143], v[48:51]
    v_exp_f32 v41, v41
    v_mfma_f32_16x16x32_bf16 v[52:55], a[144:147], v[128:131], v[28:31]
    v_add_f32 v17, v17, v41
    v_cvt_pk_bf16_f32 v72, v40, v41
    v_mfma_f32_16x16x32_bf16 v[52:55], a[148:151], v[132:135], v[52:55]
    v_exp_f32 v42, v42
    v_mfma_f32_16x16x32_bf16 v[52:55], a[152:155], v[136:139], v[52:55]
    buffer_load_dwordx4 v4, s[8:11], s36 offen offset:1024 lds
    v_add_f32 v17, v17, v42
    v_mfma_f32_16x16x32_bf16 v[52:55], a[156:159], v[140:143], v[52:55]
    s_add_u32 s36, s36, 0x2000
    v_exp_f32 v43, v43
    v_mfma_f32_16x16x32_bf16 a[8:11], a[160:163], v[80:83], a[8:11]
    v_add_f32 v17, v17, v43
    v_cvt_pk_bf16_f32 v73, v42, v43
    v_mfma_f32_16x16x32_bf16 a[12:15], a[160:163], v[84:87], a[12:15]
    v_exp_f32 v44, v44
    v_mfma_f32_16x16x32_bf16 a[24:27], a[164:167], v[80:83], a[24:27]
    ds_read_b64_tr_b16 a[160:161], v9 offset:0
    v_add_f32 v17, v17, v44
    v_mfma_f32_16x16x32_bf16 a[28:31], a[164:167], v[84:87], a[28:31]
    v_exp_f32 v45, v45
    v_mfma_f32_16x16x32_bf16 a[40:43], a[168:171], v[80:83], a[40:43]
    s_cmp_eq_u32 s49, 1
    ds_read_b64_tr_b16 a[162:163], v9 offset:4096
    v_add_f32 v17, v17, v45
    v_cvt_pk_bf16_f32 v74, v44, v45
    v_mfma_f32_16x16x32_bf16 a[44:47], a[168:171], v[84:87], a[44:47]
    s_cselect_b32 s30, 0x21c000, 0
    v_exp_f32 v46, v46
    v_mfma_f32_16x16x32_bf16 a[56:59], a[172:175], v[80:83], a[56:59]
    s_cselect_b32 s26, 0x500000, 0
    ds_read_b64_tr_b16 a[164:165], v10 offset:0
    v_add_f32 v17, v17, v46
    v_mfma_f32_16x16x32_bf16 a[60:63], a[172:175], v[84:87], a[60:63]
    v_exp_f32 v47, v47
    v_mfma_f32_16x16x32_bf16 a[72:75], a[176:179], v[80:83], a[72:75]
    ds_read_b64_tr_b16 a[166:167], v10 offset:4096
    v_add_f32 v17, v17, v47
    v_cvt_pk_bf16_f32 v75, v46, v47
    v_mfma_f32_16x16x32_bf16 a[76:79], a[176:179], v[84:87], a[76:79]
    v_exp_f32 v48, v48
    v_mfma_f32_16x16x32_bf16 a[88:91], a[180:183], v[80:83], a[88:91]
    ds_read_b64_tr_b16 a[168:169], v11 offset:0
    v_add_f32 v18, v18, v48
    v_mfma_f32_16x16x32_bf16 a[92:95], a[180:183], v[84:87], a[92:95]
    v_exp_f32 v49, v49
    v_mfma_f32_16x16x32_bf16 a[104:107], a[184:187], v[80:83], a[104:107]
    ds_read_b64_tr_b16 a[170:171], v11 offset:4096
    v_add_f32 v18, v18, v49
    v_cvt_pk_bf16_f32 v76, v48, v49
    v_mfma_f32_16x16x32_bf16 a[108:111], a[184:187], v[84:87], a[108:111]
    v_exp_f32 v50, v50
    v_mfma_f32_16x16x32_bf16 a[120:123], a[188:191], v[80:83], a[120:123]
    ds_read_b64_tr_b16 a[172:173], v12 offset:0
    v_add_f32 v18, v18, v50
    v_mfma_f32_16x16x32_bf16 a[124:127], a[188:191], v[84:87], a[124:127]
    v_exp_f32 v51, v51
    v_mfma_f32_16x16x32_bf16 v[56:59], a[128:131], v[144:147], v[32:35]
    ds_read_b64_tr_b16 a[174:175], v12 offset:4096
    v_add_f32 v18, v18, v51
    v_cvt_pk_bf16_f32 v77, v50, v51
    v_mfma_f32_16x16x32_bf16 v[56:59], a[132:135], v[148:151], v[56:59]
    v_exp_f32 v52, v52
    v_mfma_f32_16x16x32_bf16 v[56:59], a[136:139], v[152:155], v[56:59]
    ds_read_b64_tr_b16 a[176:177], v13 offset:0
    v_add_f32 v18, v18, v52
    v_mfma_f32_16x16x32_bf16 v[56:59], a[140:143], v[156:159], v[56:59]
    v_exp_f32 v53, v53
    v_mfma_f32_16x16x32_bf16 v[60:63], a[144:147], v[144:147], v[32:35]
    ds_read_b64_tr_b16 a[178:179], v13 offset:4096
    v_add_f32 v18, v18, v53
    v_cvt_pk_bf16_f32 v78, v52, v53
    v_mfma_f32_16x16x32_bf16 v[60:63], a[148:151], v[148:151], v[60:63]
    v_exp_f32 v54, v54
    v_mfma_f32_16x16x32_bf16 v[60:63], a[152:155], v[152:155], v[60:63]
    ds_read_b64_tr_b16 a[180:181], v14 offset:0
    v_add_f32 v18, v18, v54
    v_mfma_f32_16x16x32_bf16 v[60:63], a[156:159], v[156:159], v[60:63]
    v_exp_f32 v55, v55
    v_mfma_f32_16x16x32_bf16 v[64:67], a[128:131], v[160:163], v[36:39]
    ds_read_b64_tr_b16 a[182:183], v14 offset:4096
    v_add_f32 v18, v18, v55
    v_cvt_pk_bf16_f32 v79, v54, v55
    v_mfma_f32_16x16x32_bf16 v[64:67], a[132:135], v[164:167], v[64:67]
    v_exp_f32 v56, v56
    v_mfma_f32_16x16x32_bf16 v[64:67], a[136:139], v[168:171], v[64:67]
    ds_read_b64_tr_b16 a[184:185], v15 offset:0
    v_add_f32 v19, v19, v56
    v_mfma_f32_16x16x32_bf16 v[64:67], a[140:143], v[172:175], v[64:67]
    v_exp_f32 v57, v57
    v_mfma_f32_16x16x32_bf16 v[68:71], a[144:147], v[160:163], v[36:39]
    ds_read_b64_tr_b16 a[186:187], v15 offset:4096
    v_add_f32 v19, v19, v57
    v_cvt_pk_bf16_f32 v80, v56, v57
    v_mfma_f32_16x16x32_bf16 v[68:71], a[148:151], v[164:167], v[68:71]
    v_exp_f32 v58, v58
    v_mfma_f32_16x16x32_bf16 v[68:71], a[152:155], v[168:171], v[68:71]
    ds_read_b64_tr_b16 a[188:189], v16 offset:0
    v_add_f32 v19, v19, v58
    v_mfma_f32_16x16x32_bf16 v[68:71], a[156:159], v[172:175], v[68:71]
    s_waitcnt lgkmcnt(7)
    v_exp_f32 v59, v59
    v_mfma_f32_16x16x32_bf16 a[0:3], a[160:163], v[72:75], a[0:3]
    ds_read_b64_tr_b16 a[190:191], v16 offset:4096
    v_add_f32 v19, v19, v59
    v_cvt_pk_bf16_f32 v81, v58, v59
    v_mfma_f32_16x16x32_bf16 a[4:7], a[160:163], v[76:79], a[4:7]
    ds_read_b128 a[128:131], v5 offset:8192
    v_exp_f32 v60, v60
    v_mfma_f32_16x16x32_bf16 a[16:19], a[164:167], v[72:75], a[16:19]
    ds_read_b128 a[132:135], v6 offset:8192
    v_add_f32 v19, v19, v60
    v_mfma_f32_16x16x32_bf16 a[20:23], a[164:167], v[76:79], a[20:23]
    v_exp_f32 v61, v61
    v_mfma_f32_16x16x32_bf16 a[32:35], a[168:171], v[72:75], a[32:35]
    ds_read_b128 a[136:139], v7 offset:8192
    v_add_f32 v19, v19, v61
    v_cvt_pk_bf16_f32 v82, v60, v61
    v_mfma_f32_16x16x32_bf16 a[36:39], a[168:171], v[76:79], a[36:39]
    v_exp_f32 v62, v62
    v_mfma_f32_16x16x32_bf16 a[48:51], a[172:175], v[72:75], a[48:51]
    ds_read_b128 a[140:143], v8 offset:8192
    v_add_f32 v19, v19, v62
    v_mfma_f32_16x16x32_bf16 a[52:55], a[172:175], v[76:79], a[52:55]
    s_waitcnt lgkmcnt(4)
    v_exp_f32 v63, v63
    v_mfma_f32_16x16x32_bf16 a[64:67], a[176:179], v[72:75], a[64:67]
    ds_read_b128 a[144:147], v5 offset:12288
    v_add_f32 v19, v19, v63
    v_cvt_pk_bf16_f32 v83, v62, v63
    v_mfma_f32_16x16x32_bf16 a[68:71], a[176:179], v[76:79], a[68:71]
    v_exp_f32 v64, v64
    v_mfma_f32_16x16x32_bf16 a[80:83], a[180:183], v[72:75], a[80:83]
    ds_read_b128 a[148:151], v6 offset:12288
    v_add_f32 v20, v20, v64
    v_mfma_f32_16x16x32_bf16 a[84:87], a[180:183], v[76:79], a[84:87]
    v_exp_f32 v65, v65
    v_mfma_f32_16x16x32_bf16 a[96:99], a[184:187], v[72:75], a[96:99]
    ds_read_b128 a[152:155], v7 offset:12288
    v_add_f32 v20, v20, v65
    v_cvt_pk_bf16_f32 v84, v64, v65
    v_mfma_f32_16x16x32_bf16 a[100:103], a[184:187], v[76:79], a[100:103]
    v_exp_f32 v66, v66
    v_mfma_f32_16x16x32_bf16 a[112:115], a[188:191], v[72:75], a[112:115]
    ds_read_b128 a[156:159], v8 offset:12288
    v_add_f32 v20, v20, v66
    v_mfma_f32_16x16x32_bf16 a[116:119], a[188:191], v[76:79], a[116:119]
    s_waitcnt vmcnt(20) lgkmcnt(4)
    v_exp_f32 v67, v67
K1_u1:
    v_mfma_f32_16x16x32_bf16 v[40:43], a[128:131], v[112:115], v[24:27]
    s_barrier
    v_add_f32 v20, v20, v67
    v_cvt_pk_bf16_f32 v85, v66, v67
    v_mfma_f32_16x16x32_bf16 v[40:43], a[132:135], v[116:119], v[40:43]
    s_add_u32 m0, s37, 0
    v_exp_f32 v68, v68
    v_mfma_f32_16x16x32_bf16 v[40:43], a[136:139], v[120:123], v[40:43]
    buffer_load_dwordx4 v1, s[4:7], s36 offen offset:0 lds
    v_add_f32 v20, v20, v68
    v_mfma_f32_16x16x32_bf16 v[40:43], a[140:143], v[124:127], v[40:43]
    s_waitcnt lgkmcnt(0)
    v_exp_f32 v69, v69
    v_mfma_f32_16x16x32_bf16 v[44:47], a[144:147], v[112:115], v[24:27]
    v_add_f32 v20, v20, v69
    v_cvt_pk_bf16_f32 v86, v68, v69
    v_mfma_f32_16x16x32_bf16 v[44:47], a[148:151], v[116:119], v[44:47]
    v_exp_f32 v70, v70
    v_mfma_f32_16x16x32_bf16 v[44:47], a[152:155], v[120:123], v[44:47]
    buffer_load_dwordx4 v2, s[4:7], s36 offen offset:1024 lds
    v_add_f32 v20, v20, v70
    v_mfma_f32_16x16x32_bf16 v[44:47], a[156:159], v[124:127], v[44:47]
    v_exp_f32 v71, v71
    v_mfma_f32_16x16x32_bf16 v[48:51], a[128:131], v[128:131], v[28:31]
    v_add_f32 v20, v20, v71
    v_cvt_pk_bf16_f32 v87, v70, v71
    v_mfma_f32_16x16x32_bf16 v[48:51], a[132:135], v[132:135], v[48:51]
    s_add_u32 m0, s38, 0
    v_exp_f32 v40, v40
    v_mfma_f32_16x16x32_bf16 v[48:51], a[136:139], v[136:139], v[48:51]
    buffer_load_dwordx4 v3, s[8:11], s36 offen offset:0 lds
    v_add_f32 v17, v17, v40
    v_mfma_f32_16x16x32_bf16 v[48:51], a[140:143], v[140:143], v[48:51]
    v_exp_f32 v41, v41
    v_mfma_f32_16x16x32_bf16 v[52:55], a[144:147], v[128:131], v[28:31]
    v_add_f32 v17, v17, v41
    v_cvt_pk_bf16_f32 v72, v40, v41
    v_mfma_f32_16x16x32_bf16 v[52:55], a[148:151], v[132:135], v[52:55]
    v_exp_f32 v42, v42
    v_mfma_f32_16x16x32_bf16 v[52:55], a[152:155], v[136:139], v[52:55]
    buffer_load_dwordx4 v4, s[8:11], s36 offen offset:1024 lds
    v_add_f32 v17, v17, v42
    v_mfma_f32_16x16x32_bf16 v[52:55], a[156:159], v[140:143], v[52:55]
    s_add_u32 s36, s36, 0x2000
    v_exp_f32 v43, v43
    v_mfma_f32_16x16x32_bf16 a[8:11], a[160:163], v[80:83], a[8:11]
    v_add_f32 v17, v17, v43
    v_cvt_pk_bf16_f32 v73, v42, v43
    v_mfma_f32_16x16x32_bf16 a[12:15], a[160:163], v[84:87], a[12:15]
    v_exp_f32 v44, v44
    v_mfma_f32_16x16x32_bf16 a[24:27], a[164:167], v[80:83], a[24:27]
    ds_read_b64_tr_b16 a[160:161], v9 offset:8192
    v_add_f32 v17, v17, v44
    v_mfma_f32_16x16x32_bf16 a[28:31], a[164:167], v[84:87], a[28:31]
    buffer_load_dword v92, v93, s[28:31], 0 offen
    v_exp_f32 v45, v45
    v_mfma_f32_16x16x32_bf16 a[40:43], a[168:171], v[80:83], a[40:43]
    ds_read_b64_tr_b16 a[162:163], v9 offset:12288
    v_add_f32 v17, v17, v45
    v_cvt_pk_bf16_f32 v74, v44, v45
    v_mfma_f32_16x16x32_bf16 a[44:47], a[168:171], v[84:87], a[44:47]
    v_exp_f32 v46, v46
    v_mfma_f32_16x16x32_bf16 a[56:59], a[172:175], v[80:83], a[56:59]
    ds_read_b64_tr_b16 a[164:165], v10 offset:8192
    v_add_f32 v17, v17, v46
    v_mfma_f32_16x16x32_bf16 a[60:63], a[172:175], v[84:87], a[60:63]
    buffer_load_dword v92, v94, s[24:27], 0 offen
    v_exp_f32 v47, v47
    v_mfma_f32_16x16x32_bf16 a[72:75], a[176:179], v[80:83], a[72:75]
    ds_read_b64_tr_b16 a[166:167], v10 offset:12288
    v_add_f32 v17, v17, v47
    v_cvt_pk_bf16_f32 v75, v46, v47
    v_mfma_f32_16x16x32_bf16 a[76:79], a[176:179], v[84:87], a[76:79]
    v_exp_f32 v48, v48
    v_mfma_f32_16x16x32_bf16 a[88:91], a[180:183], v[80:83], a[88:91]
    ds_read_b64_tr_b16 a[168:169], v11 offset:8192
    v_add_f32 v18, v18, v48
    v_mfma_f32_16x16x32_bf16 a[92:95], a[180:183], v[84:87], a[92:95]
    buffer_load_dword v92, v95, s[24:27], 0 offen
    v_exp_f32 v49, v49
    v_mfma_f32_16x16x32_bf16 a[104:107], a[184:187], v[80:83], a[104:107]
    ds_read_b64_tr_b16 a[170:171], v11 offset:12288
    v_add_f32 v18, v18, v49
    v_cvt_pk_bf16_f32 v76, v48, v49
    v_mfma_f32_16x16x32_bf16 a[108:111], a[184:187], v[84:87], a[108:111]
    v_exp_f32 v50, v50
    v_mfma_f32_16x16x32_bf16 a[120:123], a[188:191], v[80:83], a[120:123]
    ds_read_b64_tr_b16 a[172:173], v12 offset:8192
    v_add_f32 v18, v18, v50
    v_mfma_f32_16x16x32_bf16 a[124:127], a[188:191], v[84:87], a[124:127]
    v_exp_f32 v51, v51
    v_mfma_f32_16x16x32_bf16 v[56:59], a[128:131], v[144:147], v[32:35]
    ds_read_b64_tr_b16 a[174:175], v12 offset:12288
    v_add_f32 v18, v18, v51
    v_cvt_pk_bf16_f32 v77, v50, v51
    v_mfma_f32_16x16x32_bf16 v[56:59], a[132:135], v[148:151], v[56:59]
    v_exp_f32 v52, v52
    v_mfma_f32_16x16x32_bf16 v[56:59], a[136:139], v[152:155], v[56:59]
    ds_read_b64_tr_b16 a[176:177], v13 offset:8192
    v_add_f32 v18, v18, v52
    v_mfma_f32_16x16x32_bf16 v[56:59], a[140:143], v[156:159], v[56:59]
    v_exp_f32 v53, v53
    v_mfma_f32_16x16x32_bf16 v[60:63], a[144:147], v[144:147], v[32:35]
    ds_read_b64_tr_b16 a[178:179], v13 offset:12288
    v_add_f32 v18, v18, v53
    v_cvt_pk_bf16_f32 v78, v52, v53
    v_mfma_f32_16x16x32_bf16 v[60:63], a[148:151], v[148:151], v[60:63]
    v_exp_f32 v54, v54
    v_mfma_f32_16x16x32_bf16 v[60:63], a[152:155], v[152:155], v[60:63]
    ds_read_b64_tr_b16 a[180:181], v14 offset:8192
    v_add_f32 v18, v18, v54
    v_mfma_f32_16x16x32_bf16 v[60:63], a[156:159], v[156:159], v[60:63]
    v_exp_f32 v55, v55
    v_mfma_f32_16x16x32_bf16 v[64:67], a[128:131], v[160:163], v[36:39]
    ds_read_b64_tr_b16 a[182:183], v14 offset:12288
    v_add_f32 v18, v18, v55
    v_cvt_pk_bf16_f32 v79, v54, v55
    v_mfma_f32_16x16x32_bf16 v[64:67], a[132:135], v[164:167], v[64:67]
    v_exp_f32 v56, v56
    v_mfma_f32_16x16x32_bf16 v[64:67], a[136:139], v[168:171], v[64:67]
    ds_read_b64_tr_b16 a[184:185], v15 offset:8192
    v_add_f32 v19, v19, v56
    v_mfma_f32_16x16x32_bf16 v[64:67], a[140:143], v[172:175], v[64:67]
    v_exp_f32 v57, v57
    v_mfma_f32_16x16x32_bf16 v[68:71], a[144:147], v[160:163], v[36:39]
    ds_read_b64_tr_b16 a[186:187], v15 offset:12288
    v_add_f32 v19, v19, v57
    v_cvt_pk_bf16_f32 v80, v56, v57
    v_mfma_f32_16x16x32_bf16 v[68:71], a[148:151], v[164:167], v[68:71]
    v_exp_f32 v58, v58
    v_mfma_f32_16x16x32_bf16 v[68:71], a[152:155], v[168:171], v[68:71]
    ds_read_b64_tr_b16 a[188:189], v16 offset:8192
    v_add_f32 v19, v19, v58
    v_mfma_f32_16x16x32_bf16 v[68:71], a[156:159], v[172:175], v[68:71]
    s_waitcnt lgkmcnt(7)
    v_exp_f32 v59, v59
    v_mfma_f32_16x16x32_bf16 a[0:3], a[160:163], v[72:75], a[0:3]
    ds_read_b64_tr_b16 a[190:191], v16 offset:12288
    v_add_f32 v19, v19, v59
    v_cvt_pk_bf16_f32 v81, v58, v59
    v_mfma_f32_16x16x32_bf16 a[4:7], a[160:163], v[76:79], a[4:7]
    ds_read_b128 a[128:131], v5 offset:16384
    v_exp_f32 v60, v60
    v_mfma_f32_16x16x32_bf16 a[16:19], a[164:167], v[72:75], a[16:19]
    ds_read_b128 a[132:135], v6 offset:16384
    v_add_f32 v19, v19, v60
    v_mfma_f32_16x16x32_bf16 a[20:23], a[164:167], v[76:79], a[20:23]
    v_exp_f32 v61, v61
    v_mfma_f32_16x16x32_bf16 a[32:35], a[168:171], v[72:75], a[32:35]
    ds_read_b128 a[136:139], v7 offset:16384
    v_add_f32 v19, v19, v61
    v_cvt_pk_bf16_f32 v82, v60, v61
    v_mfma_f32_16x16x32_bf16 a[36:39], a[168:171], v[76:79], a[36:39]
    v_exp_f32 v62, v62
    v_mfma_f32_16x16x32_bf16 a[48:51], a[172:175], v[72:75], a[48:51]
    ds_read_b128 a[140:143], v8 offset:16384
    v_add_f32 v19, v19, v62
    v_mfma_f32_16x16x32_bf16 a[52:55], a[172:175], v[76:79], a[52:55]
    s_waitcnt lgkmcnt(4)
    v_exp_f32 v63, v63
    v_mfma_f32_16x16x32_bf16 a[64:67], a[176:179], v[72:75], a[64:67]
    ds_read_b128 a[144:147], v5 offset:20480
    v_add_f32 v19, v19, v63
    v_cvt_pk_bf16_f32 v83, v62, v63
    v_mfma_f32_16x16x32_bf16 a[68:71], a[176:179], v[76:79], a[68:71]
    v_exp_f32 v64, v64
    v_mfma_f32_16x16x32_bf16 a[80:83], a[180:183], v[72:75], a[80:83]
    ds_read_b128 a[148:151], v6 offset:20480
    v_add_f32 v20, v20, v64
    v_mfma_f32_16x16x32_bf16 a[84:87], a[180:183], v[76:79], a[84:87]
    v_exp_f32 v65, v65
    v_mfma_f32_16x16x32_bf16 a[96:99], a[184:187], v[72:75], a[96:99]
    ds_read_b128 a[152:155], v7 offset:20480
    v_add_f32 v20, v20, v65
    v_cvt_pk_bf16_f32 v84, v64, v65
    v_mfma_f32_16x16x32_bf16 a[100:103], a[184:187], v[76:79], a[100:103]
    v_exp_f32 v66, v66
    v_mfma_f32_16x16x32_bf16 a[112:115], a[188:191], v[72:75], a[112:115]
    ds_read_b128 a[156:159], v8 offset:20480
    v_add_f32 v20, v20, v66
    v_mfma_f32_16x16x32_bf16 a[116:119], a[188:191], v[76:79], a[116:119]
    s_waitcnt vmcnt(20) lgkmcnt(4)
    v_exp_f32 v67, v67
    v_mfma_f32_16x16x32_bf16 v[40:43], a[128:131], v[112:115], v[24:27]
    s_barrier
    v_add_f32 v20, v20, v67
    v_cvt_pk_bf16_f32 v85, v66, v67
    v_mfma_f32_16x16x32_bf16 v[40:43], a[132:135], v[116:119], v[40:43]
    s_add_u32 m0, s37, 0x2000
    v_exp_f32 v68, v68
    v_mfma_f32_16x16x32_bf16 v[40:43], a[136:139], v[120:123], v[40:43]
    buffer_load_dwordx4 v1, s[4:7], s36 offen offset:0 lds
    buffer_load_dword v111, v110, s[96:99], 0 offen sc1
    v_add_f32 v20, v20, v68
    v_mfma_f32_16x16x32_bf16 v[40:43], a[140:143], v[124:127], v[40:43]
    s_waitcnt lgkmcnt(0)
    v_exp_f32 v69, v69
    v_mfma_f32_16x16x32_bf16 v[44:47], a[144:147], v[112:115], v[24:27]
    v_add_f32 v20, v20, v69
    v_cvt_pk_bf16_f32 v86, v68, v69
    v_mfma_f32_16x16x32_bf16 v[44:47], a[148:151], v[116:119], v[44:47]
    v_exp_f32 v70, v70
    v_mfma_f32_16x16x32_bf16 v[44:47], a[152:155], v[120:123], v[44:47]
    buffer_load_dwordx4 v2, s[4:7], s36 offen offset:1024 lds
    v_add_f32 v20, v20, v70
    v_mfma_f32_16x16x32_bf16 v[44:47], a[156:159], v[124:127], v[44:47]
    v_exp_f32 v71, v71
    v_mfma_f32_16x16x32_bf16 v[48:51], a[128:131], v[128:131], v[28:31]
    v_add_f32 v20, v20, v71
    v_cvt_pk_bf16_f32 v87, v70, v71
    v_mfma_f32_16x16x32_bf16 v[48:51], a[132:135], v[132:135], v[48:51]
    s_add_u32 m0, s38, 0x2000
    v_exp_f32 v40, v40
    v_mfma_f32_16x16x32_bf16 v[48:51], a[136:139], v[136:139], v[48:51]
    buffer_load_dwordx4 v3, s[8:11], s36 offen offset:0 lds
    v_add_f32 v17, v17, v40
    v_mfma_f32_16x16x32_bf16 v[48:51], a[140:143], v[140:143], v[48:51]
    v_exp_f32 v41, v41
    v_mfma_f32_16x16x32_bf16 v[52:55], a[144:147], v[128:131], v[28:31]
    v_add_f32 v17, v17, v41
    v_cvt_pk_bf16_f32 v72, v40, v41
    v_mfma_f32_16x16x32_bf16 v[52:55], a[148:151], v[132:135], v[52:55]
    v_exp_f32 v42, v42
    v_mfma_f32_16x16x32_bf16 v[52:55], a[152:155], v[136:139], v[52:55]
    buffer_load_dwordx4 v4, s[8:11], s36 offen offset:1024 lds
    v_add_f32 v17, v17, v42
    v_mfma_f32_16x16x32_bf16 v[52:55], a[156:159], v[140:143], v[52:55]
    s_add_u32 s36, s36, 0x2000
    v_exp_f32 v43, v43
    v_mfma_f32_16x16x32_bf16 a[8:11], a[160:163], v[80:83], a[8:11]
    v_add_f32 v17, v17, v43
    v_cvt_pk_bf16_f32 v73, v42, v43
    v_mfma_f32_16x16x32_bf16 a[12:15], a[160:163], v[84:87], a[12:15]
    v_exp_f32 v44, v44
    v_mfma_f32_16x16x32_bf16 a[24:27], a[164:167], v[80:83], a[24:27]
    ds_read_b64_tr_b16 a[160:161], v9 offset:16384
    v_add_f32 v17, v17, v44
    v_mfma_f32_16x16x32_bf16 a[28:31], a[164:167], v[84:87], a[28:31]
    v_exp_f32 v45, v45
    v_mfma_f32_16x16x32_bf16 a[40:43], a[168:171], v[80:83], a[40:43]
    ds_read_b64_tr_b16 a[162:163], v9 offset:20480
    v_add_f32 v17, v17, v45
    v_cvt_pk_bf16_f32 v74, v44, v45
    v_mfma_f32_16x16x32_bf16 a[44:47], a[168:171], v[84:87], a[44:47]
    v_exp_f32 v46, v46
    v_mfma_f32_16x16x32_bf16 a[56:59], a[172:175], v[80:83], a[56:59]
    ds_read_b64_tr_b16 a[164:165], v10 offset:16384
    v_add_f32 v17, v17, v46
    v_mfma_f32_16x16x32_bf16 a[60:63], a[172:175], v[84:87], a[60:63]
    v_exp_f32 v47, v47
    v_mfma_f32_16x16x32_bf16 a[72:75], a[176:179], v[80:83], a[72:75]
    ds_read_b64_tr_b16 a[166:167], v10 offset:20480
    v_add_f32 v17, v17, v47
    v_cvt_pk_bf16_f32 v75, v46, v47
    v_mfma_f32_16x16x32_bf16 a[76:79], a[176:179], v[84:87], a[76:79]
    v_exp_f32 v48, v48
    v_mfma_f32_16x16x32_bf16 a[88:91], a[180:183], v[80:83], a[88:91]
    ds_read_b64_tr_b16 a[168:169], v11 offset:16384
    v_add_f32 v18, v18, v48
    v_mfma_f32_16x16x32_bf16 a[92:95], a[180:183], v[84:87], a[92:95]
    v_exp_f32 v49, v49
    v_mfma_f32_16x16x32_bf16 a[104:107], a[184:187], v[80:83], a[104:107]
    ds_read_b64_tr_b16 a[170:171], v11 offset:20480
    v_add_f32 v18, v18, v49
    v_cvt_pk_bf16_f32 v76, v48, v49
    v_mfma_f32_16x16x32_bf16 a[108:111], a[184:187], v[84:87], a[108:111]
    v_exp_f32 v50, v50
    v_mfma_f32_16x16x32_bf16 a[120:123], a[188:191], v[80:83], a[120:123]
    ds_read_b64_tr_b16 a[172:173], v12 offset:16384
    v_add_f32 v18, v18, v50
    v_mfma_f32_16x16x32_bf16 a[124:127], a[188:191], v[84:87], a[124:127]
    v_exp_f32 v51, v51
    v_mfma_f32_16x16x32_bf16 v[56:59], a[128:131], v[144:147], v[32:35]
    ds_read_b64_tr_b16 a[174:175], v12 offset:20480
    v_add_f32 v18, v18, v51
    v_cvt_pk_bf16_f32 v77, v50, v51
    v_mfma_f32_16x16x32_bf16 v[56:59], a[132:135], v[148:151], v[56:59]
    v_exp_f32 v52, v52
    v_mfma_f32_16x16x32_bf16 v[56:59], a[136:139], v[152:155], v[56:59]
    ds_read_b64_tr_b16 a[176:177], v13 offset:16384
    v_add_f32 v18, v18, v52
    v_mfma_f32_16x16x32_bf16 v[56:59], a[140:143], v[156:159], v[56:59]
    v_exp_f32 v53, v53
    v_mfma_f32_16x16x32_bf16 v[60:63], a[144:147], v[144:147], v[32:35]
    ds_read_b64_tr_b16 a[178:179], v13 offset:20480
    v_add_f32 v18, v18, v53
    v_cvt_pk_bf16_f32 v78, v52, v53
    v_mfma_f32_16x16x32_bf16 v[60:63], a[148:151], v[148:151], v[60:63]
    v_exp_f32 v54, v54
    v_mfma_f32_16x16x32_bf16 v[60:63], a[152:155], v[152:155], v[60:63]
    ds_read_b64_tr_b16 a[180:181], v14 offset:16384
    v_add_f32 v18, v18, v54
    v_mfma_f32_16x16x32_bf16 v[60:63], a[156:159], v[156:159], v[60:63]
    v_exp_f32 v55, v55
    v_mfma_f32_16x16x32_bf16 v[64:67], a[128:131], v[160:163], v[36:39]
    ds_read_b64_tr_b16 a[182:183], v14 offset:20480
    v_add_f32 v18, v18, v55
    v_cvt_pk_bf16_f32 v79, v54, v55
    v_mfma_f32_16x16x32_bf16 v[64:67], a[132:135], v[164:167], v[64:67]
    v_exp_f32 v56, v56
    v_mfma_f32_16x16x32_bf16 v[64:67], a[136:139], v[168:171], v[64:67]
    ds_read_b64_tr_b16 a[184:185], v15 offset:16384
    v_add_f32 v19, v19, v56
    v_mfma_f32_16x16x32_bf16 v[64:67], a[140:143], v[172:175], v[64:67]
    v_exp_f32 v57, v57
    v_mfma_f32_16x16x32_bf16 v[68:71], a[144:147], v[160:163], v[36:39]
    ds_read_b64_tr_b16 a[186:187], v15 offset:20480
    v_add_f32 v19, v19, v57
    v_cvt_pk_bf16_f32 v80, v56, v57
    v_mfma_f32_16x16x32_bf16 v[68:71], a[148:151], v[164:167], v[68:71]
    v_exp_f32 v58, v58
    v_mfma_f32_16x16x32_bf16 v[68:71], a[152:155], v[168:171], v[68:71]
    ds_read_b64_tr_b16 a[188:189], v16 offset:16384
    v_add_f32 v19, v19, v58
    v_mfma_f32_16x16x32_bf16 v[68:71], a[156:159], v[172:175], v[68:71]
    s_waitcnt lgkmcnt(7)
    v_exp_f32 v59, v59
    v_mfma_f32_16x16x32_bf16 a[0:3], a[160:163], v[72:75], a[0:3]
    ds_read_b64_tr_b16 a[190:191], v16 offset:20480
    v_add_f32 v19, v19, v59
    v_cvt_pk_bf16_f32 v81, v58, v59
    v_mfma_f32_16x16x32_bf16 a[4:7], a[160:163], v[76:79], a[4:7]
    ds_read_b128 a[128:131], v5 offset:24576
    v_exp_f32 v60, v60
    v_mfma_f32_16x16x32_bf16 a[16:19], a[164:167], v[72:75], a[16:19]
    ds_read_b128 a[132:135], v6 offset:24576
    v_add_f32 v19, v19, v60
    v_mfma_f32_16x16x32_bf16 a[20:23], a[164:167], v[76:79], a[20:23]
    v_exp_f32 v61, v61
    v_mfma_f32_16x16x32_bf16 a[32:35], a[168:171], v[72:75], a[32:35]
    ds_read_b128 a[136:139], v7 offset:24576
    v_add_f32 v19, v19, v61
    v_cvt_pk_bf16_f32 v82, v60, v61
    v_mfma_f32_16x16x32_bf16 a[36:39], a[168:171], v[76:79], a[36:39]
    v_exp_f32 v62, v62
    v_mfma_f32_16x16x32_bf16 a[48:51], a[172:175], v[72:75], a[48:51]
    ds_read_b128 a[140:143], v8 offset:24576
    v_add_f32 v19, v19, v62
    v_mfma_f32_16x16x32_bf16 a[52:55], a[172:175], v[76:79], a[52:55]
    s_waitcnt lgkmcnt(4)
    v_exp_f32 v63, v63
    v_mfma_f32_16x16x32_bf16 a[64:67], a[176:179], v[72:75], a[64:67]
    ds_read_b128 a[144:147], v5 offset:28672
    v_add_f32 v19, v19, v63
    v_cvt_pk_bf16_f32 v83, v62, v63
    v_mfma_f32_16x16x32_bf16 a[68:71], a[176:179], v[76:79], a[68:71]
    v_exp_f32 v64, v64
    v_mfma_f32_16x16x32_bf16 a[80:83], a[180:183], v[72:75], a[80:83]
    ds_read_b128 a[148:151], v6 offset:28672
    v_add_f32 v20, v20, v64
    v_mfma_f32_16x16x32_bf16 a[84:87], a[180:183], v[76:79], a[84:87]
    v_exp_f32 v65, v65
    v_mfma_f32_16x16x32_bf16 a[96:99], a[184:187], v[72:75], a[96:99]
    ds_read_b128 a[152:155], v7 offset:28672
    v_add_f32 v20, v20, v65
    v_cvt_pk_bf16_f32 v84, v64, v65
    v_mfma_f32_16x16x32_bf16 a[100:103], a[184:187], v[76:79], a[100:103]
    v_exp_f32 v66, v66
    v_mfma_f32_16x16x32_bf16 a[112:115], a[188:191], v[72:75], a[112:115]
    ds_read_b128 a[156:159], v8 offset:28672
    v_add_f32 v20, v20, v66
    v_mfma_f32_16x16x32_bf16 a[116:119], a[188:191], v[76:79], a[116:119]
    s_waitcnt vmcnt(20) lgkmcnt(4)
    v_exp_f32 v67, v67
    v_mfma_f32_16x16x32_bf16 v[40:43], a[128:131], v[112:115], v[24:27]
    s_barrier
    v_add_f32 v20, v20, v67
    v_cvt_pk_bf16_f32 v85, v66, v67
    v_mfma_f32_16x16x32_bf16 v[40:43], a[132:135], v[116:119], v[40:43]
    s_add_u32 m0, s37, 0x4000
    v_exp_f32 v68, v68
    v_mfma_f32_16x16x32_bf16 v[40:43], a[136:139], v[120:123], v[40:43]
    buffer_load_dwordx4 v1, s[4:7], s36 offen offset:0 lds
    v_add_f32 v20, v20, v68
    v_mfma_f32_16x16x32_bf16 v[40:43], a[140:143], v[124:127], v[40:43]
    s_waitcnt lgkmcnt(0)
    v_exp_f32 v69, v69
    v_mfma_f32_16x16x32_bf16 v[44:47], a[144:147], v[112:115], v[24:27]
    v_add_f32 v20, v20, v69
    v_cvt_pk_bf16_f32 v86, v68, v69
    v_mfma_f32_16x16x32_bf16 v[44:47], a[148:151], v[116:119], v[44:47]
    v_exp_f32 v70, v70
    v_mfma_f32_16x16x32_bf16 v[44:47], a[152:155], v[120:123], v[44:47]
    buffer_load_dwordx4 v2, s[4:7], s36 offen offset:1024 lds
    v_add_f32 v20, v20, v70
    v_mfma_f32_16x16x32_bf16 v[44:47], a[156:159], v[124:127], v[44:47]
    v_exp_f32 v71, v71
    v_mfma_f32_16x16x32_bf16 v[48:51], a[128:131], v[128:131], v[28:31]
    v_add_f32 v20, v20, v71
    v_cvt_pk_bf16_f32 v87, v70, v71
    v_mfma_f32_16x16x32_bf16 v[48:51], a[132:135], v[132:135], v[48:51]
    s_add_u32 m0, s38, 0x4000
    v_exp_f32 v40, v40
    v_mfma_f32_16x16x32_bf16 v[48:51], a[136:139], v[136:139], v[48:51]
    buffer_load_dwordx4 v3, s[8:11], s36 offen offset:0 lds
    v_add_f32 v17, v17, v40
    v_mfma_f32_16x16x32_bf16 v[48:51], a[140:143], v[140:143], v[48:51]
    v_exp_f32 v41, v41
    v_mfma_f32_16x16x32_bf16 v[52:55], a[144:147], v[128:131], v[28:31]
    v_add_f32 v17, v17, v41
    v_cvt_pk_bf16_f32 v72, v40, v41
    v_mfma_f32_16x16x32_bf16 v[52:55], a[148:151], v[132:135], v[52:55]
    v_exp_f32 v42, v42
    v_mfma_f32_16x16x32_bf16 v[52:55], a[152:155], v[136:139], v[52:55]
    buffer_load_dwordx4 v4, s[8:11], s36 offen offset:1024 lds
    v_add_f32 v17, v17, v42
    v_mfma_f32_16x16x32_bf16 v[52:55], a[156:159], v[140:143], v[52:55]
    s_add_u32 s36, s36, 0x2000
    v_exp_f32 v43, v43
    v_mfma_f32_16x16x32_bf16 a[8:11], a[160:163], v[80:83], a[8:11]
    v_add_f32 v17, v17, v43
    v_cvt_pk_bf16_f32 v73, v42, v43
    v_mfma_f32_16x16x32_bf16 a[12:15], a[160:163], v[84:87], a[12:15]
    v_exp_f32 v44, v44
    v_mfma_f32_16x16x32_bf16 a[24:27], a[164:167], v[80:83], a[24:27]
    ds_read_b64_tr_b16 a[160:161], v9 offset:24576
    v_add_f32 v17, v17, v44
    v_mfma_f32_16x16x32_bf16 a[28:31], a[164:167], v[84:87], a[28:31]
    v_exp_f32 v45, v45
    v_mfma_f32_16x16x32_bf16 a[40:43], a[168:171], v[80:83], a[40:43]
    ds_read_b64_tr_b16 a[162:163], v9 offset:28672
    v_add_f32 v17, v17, v45
    v_cvt_pk_bf16_f32 v74, v44, v45
    v_mfma_f32_16x16x32_bf16 a[44:47], a[168:171], v[84:87], a[44:47]
    v_exp_f32 v46, v46
    v_mfma_f32_16x16x32_bf16 a[56:59], a[172:175], v[80:83], a[56:59]
    ds_read_b64_tr_b16 a[164:165], v10 offset:24576
    v_add_f32 v17, v17, v46
    v_mfma_f32_16x16x32_bf16 a[60:63], a[172:175], v[84:87], a[60:63]
    v_exp_f32 v47, v47
    v_mfma_f32_16x16x32_bf16 a[72:75], a[176:179], v[80:83], a[72:75]
    ds_read_b64_tr_b16 a[166:167], v10 offset:28672
    v_add_f32 v17, v17, v47
    v_cvt_pk_bf16_f32 v75, v46, v47
    v_mfma_f32_16x16x32_bf16 a[76:79], a[176:179], v[84:87], a[76:79]
    v_exp_f32 v48, v48
    v_mfma_f32_16x16x32_bf16 a[88:91], a[180:183], v[80:83], a[88:91]
    ds_read_b64_tr_b16 a[168:169], v11 offset:24576
    v_add_f32 v18, v18, v48
    v_mfma_f32_16x16x32_bf16 a[92:95], a[180:183], v[84:87], a[92:95]
    v_exp_f32 v49, v49
    v_mfma_f32_16x16x32_bf16 a[104:107], a[184:187], v[80:83], a[104:107]
    ds_read_b64_tr_b16 a[170:171], v11 offset:28672
    v_add_f32 v18, v18, v49
    v_cvt_pk_bf16_f32 v76, v48, v49
    v_mfma_f32_16x16x32_bf16 a[108:111], a[184:187], v[84:87], a[108:111]
    v_exp_f32 v50, v50
    v_mfma_f32_16x16x32_bf16 a[120:123], a[188:191], v[80:83], a[120:123]
    ds_read_b64_tr_b16 a[172:173], v12 offset:24576
    v_add_f32 v18, v18, v50
    v_mfma_f32_16x16x32_bf16 a[124:127], a[188:191], v[84:87], a[124:127]
    v_exp_f32 v51, v51
    v_mfma_f32_16x16x32_bf16 v[56:59], a[128:131], v[144:147], v[32:35]
    ds_read_b64_tr_b16 a[174:175], v12 offset:28672
    v_add_f32 v18, v18, v51
    v_cvt_pk_bf16_f32 v77, v50, v51
    v_mfma_f32_16x16x32_bf16 v[56:59], a[132:135], v[148:151], v[56:59]
    v_exp_f32 v52, v52
    v_mfma_f32_16x16x32_bf16 v[56:59], a[136:139], v[152:155], v[56:59]
    ds_read_b64_tr_b16 a[176:177], v13 offset:24576
    v_add_f32 v18, v18, v52
    v_mfma_f32_16x16x32_bf16 v[56:59], a[140:143], v[156:159], v[56:59]
    v_exp_f32 v53, v53
    v_mfma_f32_16x16x32_bf16 v[60:63], a[144:147], v[144:147], v[32:35]
    ds_read_b64_tr_b16 a[178:179], v13 offset:28672
    v_add_f32 v18, v18, v53
    v_cvt_pk_bf16_f32 v78, v52, v53
    v_mfma_f32_16x16x32_bf16 v[60:63], a[148:151], v[148:151], v[60:63]
    v_exp_f32 v54, v54
    v_mfma_f32_16x16x32_bf16 v[60:63], a[152:155], v[152:155], v[60:63]
    ds_read_b64_tr_b16 a[180:181], v14 offset:24576
    v_add_f32 v18, v18, v54
    v_mfma_f32_16x16x32_bf16 v[60:63], a[156:159], v[156:159], v[60:63]
    v_exp_f32 v55, v55
    v_mfma_f32_16x16x32_bf16 v[64:67], a[128:131], v[160:163], v[36:39]
    ds_read_b64_tr_b16 a[182:183], v14 offset:28672
    v_add_f32 v18, v18, v55
    v_cvt_pk_bf16_f32 v79, v54, v55
    v_mfma_f32_16x16x32_bf16 v[64:67], a[132:135], v[164:167], v[64:67]
    v_exp_f32 v56, v56
    v_mfma_f32_16x16x32_bf16 v[64:67], a[136:139], v[168:171], v[64:67]
    ds_read_b64_tr_b16 a[184:185], v15 offset:24576
    v_add_f32 v19, v19, v56
    v_mfma_f32_16x16x32_bf16 v[64:67], a[140:143], v[172:175], v[64:67]
    v_exp_f32 v57, v57
    v_mfma_f32_16x16x32_bf16 v[68:71], a[144:147], v[160:163], v[36:39]
    ds_read_b64_tr_b16 a[186:187], v15 offset:28672
    v_add_f32 v19, v19, v57
    v_cvt_pk_bf16_f32 v80, v56, v57
    v_mfma_f32_16x16x32_bf16 v[68:71], a[148:151], v[164:167], v[68:71]
    v_exp_f32 v58, v58
    v_mfma_f32_16x16x32_bf16 v[68:71], a[152:155], v[168:171], v[68:71]
    ds_read_b64_tr_b16 a[188:189], v16 offset:24576
    v_add_f32 v19, v19, v58
    v_mfma_f32_16x16x32_bf16 v[68:71], a[156:159], v[172:175], v[68:71]
    s_waitcnt lgkmcnt(7)
    v_exp_f32 v59, v59
    v_mfma_f32_16x16x32_bf16 a[0:3], a[160:163], v[72:75], a[0:3]
    ds_read_b64_tr_b16 a[190:191], v16 offset:28672
    v_add_f32 v19, v19, v59
    v_cvt_pk_bf16_f32 v81, v58, v59
    v_mfma_f32_16x16x32_bf16 a[4:7], a[160:163], v[76:79], a[4:7]
    ds_read_b128 a[128:131], v5 offset:32768
    v_exp_f32 v60, v60
    v_mfma_f32_16x16x32_bf16 a[16:19], a[164:167], v[72:75], a[16:19]
    ds_read_b128 a[132:135], v6 offset:32768
    v_add_f32 v19, v19, v60
    v_mfma_f32_16x16x32_bf16 a[20:23], a[164:167], v[76:79], a[20:23]
    v_exp_f32 v61, v61
    v_mfma_f32_16x16x32_bf16 a[32:35], a[168:171], v[72:75], a[32:35]
    ds_read_b128 a[136:139], v7 offset:32768
    v_add_f32 v19, v19, v61
    v_cvt_pk_bf16_f32 v82, v60, v61
    v_mfma_f32_16x16x32_bf16 a[36:39], a[168:171], v[76:79], a[36:39]
    v_exp_f32 v62, v62
    v_mfma_f32_16x16x32_bf16 a[48:51], a[172:175], v[72:75], a[48:51]
    ds_read_b128 a[140:143], v8 offset:32768
    v_add_f32 v19, v19, v62
    v_mfma_f32_16x16x32_bf16 a[52:55], a[172:175], v[76:79], a[52:55]
    s_waitcnt lgkmcnt(4)
    v_exp_f32 v63, v63
    v_mfma_f32_16x16x32_bf16 a[64:67], a[176:179], v[72:75], a[64:67]
    ds_read_b128 a[144:147], v5 offset:36864
    v_add_f32 v19, v19, v63
    v_cvt_pk_bf16_f32 v83, v62, v63
    v_mfma_f32_16x16x32_bf16 a[68:71], a[176:179], v[76:79], a[68:71]
    v_exp_f32 v64, v64
    v_mfma_f32_16x16x32_bf16 a[80:83], a[180:183], v[72:75], a[80:83]
    ds_read_b128 a[148:151], v6 offset:36864
    v_add_f32 v20, v20, v64
    v_mfma_f32_16x16x32_bf16 a[84:87], a[180:183], v[76:79], a[84:87]
    v_exp_f32 v65, v65
    v_mfma_f32_16x16x32_bf16 a[96:99], a[184:187], v[72:75], a[96:99]
    ds_read_b128 a[152:155], v7 offset:36864
    v_add_f32 v20, v20, v65
    v_cvt_pk_bf16_f32 v84, v64, v65
    v_mfma_f32_16x16x32_bf16 a[100:103], a[184:187], v[76:79], a[100:103]
    v_exp_f32 v66, v66
    v_mfma_f32_16x16x32_bf16 a[112:115], a[188:191], v[72:75], a[112:115]
    ds_read_b128 a[156:159], v8 offset:36864
    v_add_f32 v20, v20, v66
    v_mfma_f32_16x16x32_bf16 a[116:119], a[188:191], v[76:79], a[116:119]
    s_waitcnt vmcnt(20) lgkmcnt(4)
    v_exp_f32 v67, v67
    v_mfma_f32_16x16x32_bf16 v[40:43], a[128:131], v[112:115], v[24:27]
    s_barrier
    v_add_f32 v20, v20, v67
    v_cvt_pk_bf16_f32 v85, v66, v67
    v_mfma_f32_16x16x32_bf16 v[40:43], a[132:135], v[116:119], v[40:43]
    s_add_u32 m0, s37, 0x6000
    v_exp_f32 v68, v68
    v_mfma_f32_16x16x32_bf16 v[40:43], a[136:139], v[120:123], v[40:43]
    buffer_load_dwordx4 v1, s[4:7], s36 offen offset:0 lds
    v_add_f32 v20, v20, v68
    v_mfma_f32_16x16x32_bf16 v[40:43], a[140:143], v[124:127], v[40:43]
    s_waitcnt lgkmcnt(0)
    v_exp_f32 v69, v69
    v_mfma_f32_16x16x32_bf16 v[44:47], a[144:147], v[112:115], v[24:27]
    v_add_f32 v20, v20, v69
    v_cvt_pk_bf16_f32 v86, v68, v69
    v_mfma_f32_16x16x32_bf16 v[44:47], a[148:151], v[116:119], v[44:47]
    v_exp_f32 v70, v70
    v_mfma_f32_16x16x32_bf16 v[44:47], a[152:155], v[120:123], v[44:47]
    buffer_load_dwordx4 v2, s[4:7], s36 offen offset:1024 lds
    v_add_f32 v20, v20, v70
    v_mfma_f32_16x16x32_bf16 v[44:47], a[156:159], v[124:127], v[44:47]
    v_exp_f32 v71, v71
    v_mfma_f32_16x16x32_bf16 v[48:51], a[128:131], v[128:131], v[28:31]
    v_add_f32 v20, v20, v71
    v_cvt_pk_bf16_f32 v87, v70, v71
    v_mfma_f32_16x16x32_bf16 v[48:51], a[132:135], v[132:135], v[48:51]
    s_add_u32 m0, s38, 0x6000
    v_exp_f32 v40, v40
    v_mfma_f32_16x16x32_bf16 v[48:51], a[136:139], v[136:139], v[48:51]
    buffer_load_dwordx4 v3, s[8:11], s36 offen offset:0 lds
    v_add_f32 v17, v17, v40
    v_mfma_f32_16x16x32_bf16 v[48:51], a[140:143], v[140:143], v[48:51]
    v_exp_f32 v41, v41
    v_mfma_f32_16x16x32_bf16 v[52:55], a[144:147], v[128:131], v[28:31]
    v_add_f32 v17, v17, v41
    v_cvt_pk_bf16_f32 v72, v40, v41
    v_mfma_f32_16x16x32_bf16 v[52:55], a[148:151], v[132:135], v[52:55]
    v_exp_f32 v42, v42
    v_mfma_f32_16x16x32_bf16 v[52:55], a[152:155], v[136:139], v[52:55]
    buffer_load_dwordx4 v4, s[8:11], s36 offen offset:1024 lds
    v_add_f32 v17, v17, v42
    v_mfma_f32_16x16x32_bf16 v[52:55], a[156:159], v[140:143], v[52:55]
    s_add_u32 s36, s36, 0x2000
    v_exp_f32 v43, v43
    v_mfma_f32_16x16x32_bf16 a[8:11], a[160:163], v[80:83], a[8:11]
    v_add_f32 v17, v17, v43
    v_cvt_pk_bf16_f32 v73, v42, v43
    v_mfma_f32_16x16x32_bf16 a[12:15], a[160:163], v[84:87], a[12:15]
    v_exp_f32 v44, v44
    v_mfma_f32_16x16x32_bf16 a[24:27], a[164:167], v[80:83], a[24:27]
    ds_read_b64_tr_b16 a[160:161], v9 offset:32768
    v_add_f32 v17, v17, v44
    v_mfma_f32_16x16x32_bf16 a[28:31], a[164:167], v[84:87], a[28:31]
    v_exp_f32 v45, v45
    v_mfma_f32_16x16x32_bf16 a[40:43], a[168:171], v[80:83], a[40:43]
    ds_read_b64_tr_b16 a[162:163], v9 offset:36864
    v_add_f32 v17, v17, v45
    v_cvt_pk_bf16_f32 v74, v44, v45
    v_mfma_f32_16x16x32_bf16 a[44:47], a[168:171], v[84:87], a[44:47]
    v_exp_f32 v46, v46
    v_mfma_f32_16x16x32_bf16 a[56:59], a[172:175], v[80:83], a[56:59]
    ds_read_b64_tr_b16 a[164:165], v10 offset:32768
    v_add_f32 v17, v17, v46
    v_mfma_f32_16x16x32_bf16 a[60:63], a[172:175], v[84:87], a[60:63]
    v_exp_f32 v47, v47
    v_mfma_f32_16x16x32_bf16 a[72:75], a[176:179], v[80:83], a[72:75]
    ds_read_b64_tr_b16 a[166:167], v10 offset:36864
    v_add_f32 v17, v17, v47
    v_cvt_pk_bf16_f32 v75, v46, v47
    v_mfma_f32_16x16x32_bf16 a[76:79], a[176:179], v[84:87], a[76:79]
    v_exp_f32 v48, v48
    v_mfma_f32_16x16x32_bf16 a[88:91], a[180:183], v[80:83], a[88:91]
    ds_read_b64_tr_b16 a[168:169], v11 offset:32768
    v_add_f32 v18, v18, v48
    v_mfma_f32_16x16x32_bf16 a[92:95], a[180:183], v[84:87], a[92:95]
    v_exp_f32 v49, v49
    v_mfma_f32_16x16x32_bf16 a[104:107], a[184:187], v[80:83], a[104:107]
    ds_read_b64_tr_b16 a[170:171], v11 offset:36864
    v_add_f32 v18, v18, v49
    v_cvt_pk_bf16_f32 v76, v48, v49
    v_mfma_f32_16x16x32_bf16 a[108:111], a[184:187], v[84:87], a[108:111]
    v_exp_f32 v50, v50
    v_mfma_f32_16x16x32_bf16 a[120:123], a[188:191], v[80:83], a[120:123]
    ds_read_b64_tr_b16 a[172:173], v12 offset:32768
    v_add_f32 v18, v18, v50
    v_mfma_f32_16x16x32_bf16 a[124:127], a[188:191], v[84:87], a[124:127]
    v_exp_f32 v51, v51
    v_mfma_f32_16x16x32_bf16 v[56:59], a[128:131], v[144:147], v[32:35]
    ds_read_b64_tr_b16 a[174:175], v12 offset:36864
    v_add_f32 v18, v18, v51
    v_cvt_pk_bf16_f32 v77, v50, v51
    v_mfma_f32_16x16x32_bf16 v[56:59], a[132:135], v[148:151], v[56:59]
    v_exp_f32 v52, v52
    v_mfma_f32_16x16x32_bf16 v[56:59], a[136:139], v[152:155], v[56:59]
    ds_read_b64_tr_b16 a[176:177], v13 offset:32768
    v_add_f32 v18, v18, v52
    v_mfma_f32_16x16x32_bf16 v[56:59], a[140:143], v[156:159], v[56:59]
    v_exp_f32 v53, v53
    v_mfma_f32_16x16x32_bf16 v[60:63], a[144:147], v[144:147], v[32:35]
    ds_read_b64_tr_b16 a[178:179], v13 offset:36864
    v_add_f32 v18, v18, v53
    v_cvt_pk_bf16_f32 v78, v52, v53
    v_mfma_f32_16x16x32_bf16 v[60:63], a[148:151], v[148:151], v[60:63]
    v_exp_f32 v54, v54
    v_mfma_f32_16x16x32_bf16 v[60:63], a[152:155], v[152:155], v[60:63]
    ds_read_b64_tr_b16 a[180:181], v14 offset:32768
    v_add_f32 v18, v18, v54
    v_mfma_f32_16x16x32_bf16 v[60:63], a[156:159], v[156:159], v[60:63]
    v_exp_f32 v55, v55
    v_mfma_f32_16x16x32_bf16 v[64:67], a[128:131], v[160:163], v[36:39]
    ds_read_b64_tr_b16 a[182:183], v14 offset:36864
    v_add_f32 v18, v18, v55
    v_cvt_pk_bf16_f32 v79, v54, v55
    v_mfma_f32_16x16x32_bf16 v[64:67], a[132:135], v[164:167], v[64:67]
    v_exp_f32 v56, v56
    v_mfma_f32_16x16x32_bf16 v[64:67], a[136:139], v[168:171], v[64:67]
    ds_read_b64_tr_b16 a[184:185], v15 offset:32768
    v_add_f32 v19, v19, v56
    v_mfma_f32_16x16x32_bf16 v[64:67], a[140:143], v[172:175], v[64:67]
    v_exp_f32 v57, v57
    v_mfma_f32_16x16x32_bf16 v[68:71], a[144:147], v[160:163], v[36:39]
    ds_read_b64_tr_b16 a[186:187], v15 offset:36864
    v_add_f32 v19, v19, v57
    v_cvt_pk_bf16_f32 v80, v56, v57
    v_mfma_f32_16x16x32_bf16 v[68:71], a[148:151], v[164:167], v[68:71]
    v_exp_f32 v58, v58
    v_mfma_f32_16x16x32_bf16 v[68:71], a[152:155], v[168:171], v[68:71]
    ds_read_b64_tr_b16 a[188:189], v16 offset:32768
    v_add_f32 v19, v19, v58
    v_mfma_f32_16x16x32_bf16 v[68:71], a[156:159], v[172:175], v[68:71]
    s_waitcnt lgkmcnt(7)
    v_exp_f32 v59, v59
    v_mfma_f32_16x16x32_bf16 a[0:3], a[160:163], v[72:75], a[0:3]
    ds_read_b64_tr_b16 a[190:191], v16 offset:36864
    v_add_f32 v19, v19, v59
    v_cvt_pk_bf16_f32 v81, v58, v59
    v_mfma_f32_16x16x32_bf16 a[4:7], a[160:163], v[76:79], a[4:7]
    ds_read_b128 a[128:131], v5 offset:40960
    v_exp_f32 v60, v60
    v_mfma_f32_16x16x32_bf16 a[16:19], a[164:167], v[72:75], a[16:19]
    ds_read_b128 a[132:135], v6 offset:40960
    v_add_f32 v19, v19, v60
    v_mfma_f32_16x16x32_bf16 a[20:23], a[164:167], v[76:79], a[20:23]
    v_exp_f32 v61, v61
    v_mfma_f32_16x16x32_bf16 a[32:35], a[168:171], v[72:75], a[32:35]
    ds_read_b128 a[136:139], v7 offset:40960
    v_add_f32 v19, v19, v61
    v_cvt_pk_bf16_f32 v82, v60, v61
    v_mfma_f32_16x16x32_bf16 a[36:39], a[168:171], v[76:79], a[36:39]
    v_exp_f32 v62, v62
    v_mfma_f32_16x16x32_bf16 a[48:51], a[172:175], v[72:75], a[48:51]
    ds_read_b128 a[140:143], v8 offset:40960
    v_add_f32 v19, v19, v62
    v_mfma_f32_16x16x32_bf16 a[52:55], a[172:175], v[76:79], a[52:55]
    s_waitcnt lgkmcnt(4)
    v_exp_f32 v63, v63
    v_mfma_f32_16x16x32_bf16 a[64:67], a[176:179], v[72:75], a[64:67]
    ds_read_b128 a[144:147], v5 offset:45056
    v_add_f32 v19, v19, v63
    v_cvt_pk_bf16_f32 v83, v62, v63
    v_mfma_f32_16x16x32_bf16 a[68:71], a[176:179], v[76:79], a[68:71]
    v_exp_f32 v64, v64
    v_mfma_f32_16x16x32_bf16 a[80:83], a[180:183], v[72:75], a[80:83]
    ds_read_b128 a[148:151], v6 offset:45056
    v_add_f32 v20, v20, v64
    v_mfma_f32_16x16x32_bf16 a[84:87], a[180:183], v[76:79], a[84:87]
    v_exp_f32 v65, v65
    v_mfma_f32_16x16x32_bf16 a[96:99], a[184:187], v[72:75], a[96:99]
    ds_read_b128 a[152:155], v7 offset:45056
    v_add_f32 v20, v20, v65
    v_cvt_pk_bf16_f32 v84, v64, v65
    v_mfma_f32_16x16x32_bf16 a[100:103], a[184:187], v[76:79], a[100:103]
    v_exp_f32 v66, v66
    v_mfma_f32_16x16x32_bf16 a[112:115], a[188:191], v[72:75], a[112:115]
    ds_read_b128 a[156:159], v8 offset:45056
    v_add_f32 v20, v20, v66
    v_mfma_f32_16x16x32_bf16 a[116:119], a[188:191], v[76:79], a[116:119]
    s_waitcnt vmcnt(20) lgkmcnt(4)
    v_exp_f32 v67, v67
    v_mfma_f32_16x16x32_bf16 v[40:43], a[128:131], v[112:115], v[24:27]
    s_barrier
    v_add_f32 v20, v20, v67
    v_cvt_pk_bf16_f32 v85, v66, v67
    v_mfma_f32_16x16x32_bf16 v[40:43], a[132:135], v[116:119], v[40:43]
    s_add_u32 m0, s37, 0x8000
    v_exp_f32 v68, v68
    v_mfma_f32_16x16x32_bf16 v[40:43], a[136:139], v[120:123], v[40:43]
    buffer_load_dwordx4 v1, s[4:7], s36 offen offset:0 lds
    buffer_store_dword v109, v108, s[96:99], 0 offen sc1
    v_add_f32 v20, v20, v68
    v_mfma_f32_16x16x32_bf16 v[40:43], a[140:143], v[124:127], v[40:43]
    s_waitcnt lgkmcnt(0)
    v_exp_f32 v69, v69
    v_mfma_f32_16x16x32_bf16 v[44:47], a[144:147], v[112:115], v[24:27]
    v_add_f32 v20, v20, v69
    v_cvt_pk_bf16_f32 v86, v68, v69
    v_mfma_f32_16x16x32_bf16 v[44:47], a[148:151], v[116:119], v[44:47]
    v_exp_f32 v70, v70
    v_mfma_f32_16x16x32_bf16 v[44:47], a[152:155], v[120:123], v[44:47]
    buffer_load_dwordx4 v2, s[4:7], s36 offen offset:1024 lds
    v_add_f32 v20, v20, v70
    v_mfma_f32_16x16x32_bf16 v[44:47], a[156:159], v[124:127], v[44:47]
    v_exp_f32 v71, v71
    v_mfma_f32_16x16x32_bf16 v[48:51], a[128:131], v[128:131], v[28:31]
    v_add_f32 v20, v20, v71
    v_cvt_pk_bf16_f32 v87, v70, v71
    v_mfma_f32_16x16x32_bf16 v[48:51], a[132:135], v[132:135], v[48:51]
    s_add_u32 m0, s38, 0x8000
    v_exp_f32 v40, v40
    v_mfma_f32_16x16x32_bf16 v[48:51], a[136:139], v[136:139], v[48:51]
    buffer_load_dwordx4 v3, s[8:11], s36 offen offset:0 lds
    v_add_f32 v17, v17, v40
    v_mfma_f32_16x16x32_bf16 v[48:51], a[140:143], v[140:143], v[48:51]
    v_exp_f32 v41, v41
    v_mfma_f32_16x16x32_bf16 v[52:55], a[144:147], v[128:131], v[28:31]
    v_add_f32 v17, v17, v41
    v_cvt_pk_bf16_f32 v72, v40, v41
    v_mfma_f32_16x16x32_bf16 v[52:55], a[148:151], v[132:135], v[52:55]
    v_exp_f32 v42, v42
    v_mfma_f32_16x16x32_bf16 v[52:55], a[152:155], v[136:139], v[52:55]
    buffer_load_dwordx4 v4, s[8:11], s36 offen offset:1024 lds
    v_add_f32 v17, v17, v42
    v_mfma_f32_16x16x32_bf16 v[52:55], a[156:159], v[140:143], v[52:55]
    s_add_u32 s36, s36, 0x2000
    v_exp_f32 v43, v43
    v_mfma_f32_16x16x32_bf16 a[8:11], a[160:163], v[80:83], a[8:11]
    v_add_f32 v17, v17, v43
    v_cvt_pk_bf16_f32 v73, v42, v43
    v_mfma_f32_16x16x32_bf16 a[12:15], a[160:163], v[84:87], a[12:15]
    v_exp_f32 v44, v44
    v_mfma_f32_16x16x32_bf16 a[24:27], a[164:167], v[80:83], a[24:27]
    ds_read_b64_tr_b16 a[160:161], v9 offset:40960
    v_add_f32 v17, v17, v44
    v_mfma_f32_16x16x32_bf16 a[28:31], a[164:167], v[84:87], a[28:31]
    v_exp_f32 v45, v45
    v_mfma_f32_16x16x32_bf16 a[40:43], a[168:171], v[80:83], a[40:43]
    ds_read_b64_tr_b16 a[162:163], v9 offset:45056
    v_add_f32 v17, v17, v45
    v_cvt_pk_bf16_f32 v74, v44, v45
    v_mfma_f32_16x16x32_bf16 a[44:47], a[168:171], v[84:87], a[44:47]
    v_exp_f32 v46, v46
    v_mfma_f32_16x16x32_bf16 a[56:59], a[172:175], v[80:83], a[56:59]
    ds_read_b64_tr_b16 a[164:165], v10 offset:40960
    v_add_f32 v17, v17, v46
    v_mfma_f32_16x16x32_bf16 a[60:63], a[172:175], v[84:87], a[60:63]
    v_exp_f32 v47, v47
    v_mfma_f32_16x16x32_bf16 a[72:75], a[176:179], v[80:83], a[72:75]
    ds_read_b64_tr_b16 a[166:167], v10 offset:45056
    v_add_f32 v17, v17, v47
    v_cvt_pk_bf16_f32 v75, v46, v47
    v_mfma_f32_16x16x32_bf16 a[76:79], a[176:179], v[84:87], a[76:79]
    v_exp_f32 v48, v48
    v_mfma_f32_16x16x32_bf16 a[88:91], a[180:183], v[80:83], a[88:91]
    ds_read_b64_tr_b16 a[168:169], v11 offset:40960
    v_add_f32 v18, v18, v48
    v_mfma_f32_16x16x32_bf16 a[92:95], a[180:183], v[84:87], a[92:95]
    v_exp_f32 v49, v49
    v_mfma_f32_16x16x32_bf16 a[104:107], a[184:187], v[80:83], a[104:107]
    ds_read_b64_tr_b16 a[170:171], v11 offset:45056
    v_add_f32 v18, v18, v49
    v_cvt_pk_bf16_f32 v76, v48, v49
    v_mfma_f32_16x16x32_bf16 a[108:111], a[184:187], v[84:87], a[108:111]
    v_exp_f32 v50, v50
    v_mfma_f32_16x16x32_bf16 a[120:123], a[188:191], v[80:83], a[120:123]
    ds_read_b64_tr_b16 a[172:173], v12 offset:40960
    v_add_f32 v18, v18, v50
    v_mfma_f32_16x16x32_bf16 a[124:127], a[188:191], v[84:87], a[124:127]
    v_exp_f32 v51, v51
    v_mfma_f32_16x16x32_bf16 v[56:59], a[128:131], v[144:147], v[32:35]
    ds_read_b64_tr_b16 a[174:175], v12 offset:45056
    v_add_f32 v18, v18, v51
    v_cvt_pk_bf16_f32 v77, v50, v51
    v_mfma_f32_16x16x32_bf16 v[56:59], a[132:135], v[148:151], v[56:59]
    v_exp_f32 v52, v52
    v_mfma_f32_16x16x32_bf16 v[56:59], a[136:139], v[152:155], v[56:59]
    ds_read_b64_tr_b16 a[176:177], v13 offset:40960
    v_add_f32 v18, v18, v52
    v_mfma_f32_16x16x32_bf16 v[56:59], a[140:143], v[156:159], v[56:59]
    v_exp_f32 v53, v53
    v_mfma_f32_16x16x32_bf16 v[60:63], a[144:147], v[144:147], v[32:35]
    ds_read_b64_tr_b16 a[178:179], v13 offset:45056
    v_add_f32 v18, v18, v53
    v_cvt_pk_bf16_f32 v78, v52, v53
    v_mfma_f32_16x16x32_bf16 v[60:63], a[148:151], v[148:151], v[60:63]
    v_exp_f32 v54, v54
    v_mfma_f32_16x16x32_bf16 v[60:63], a[152:155], v[152:155], v[60:63]
    ds_read_b64_tr_b16 a[180:181], v14 offset:40960
    v_add_f32 v18, v18, v54
    v_mfma_f32_16x16x32_bf16 v[60:63], a[156:159], v[156:159], v[60:63]
    v_exp_f32 v55, v55
    v_mfma_f32_16x16x32_bf16 v[64:67], a[128:131], v[160:163], v[36:39]
    ds_read_b64_tr_b16 a[182:183], v14 offset:45056
    v_add_f32 v18, v18, v55
    v_cvt_pk_bf16_f32 v79, v54, v55
    v_mfma_f32_16x16x32_bf16 v[64:67], a[132:135], v[164:167], v[64:67]
    v_exp_f32 v56, v56
    v_mfma_f32_16x16x32_bf16 v[64:67], a[136:139], v[168:171], v[64:67]
    ds_read_b64_tr_b16 a[184:185], v15 offset:40960
    v_add_f32 v19, v19, v56
    v_mfma_f32_16x16x32_bf16 v[64:67], a[140:143], v[172:175], v[64:67]
    v_exp_f32 v57, v57
    v_mfma_f32_16x16x32_bf16 v[68:71], a[144:147], v[160:163], v[36:39]
    ds_read_b64_tr_b16 a[186:187], v15 offset:45056
    v_add_f32 v19, v19, v57
    v_cvt_pk_bf16_f32 v80, v56, v57
    v_mfma_f32_16x16x32_bf16 v[68:71], a[148:151], v[164:167], v[68:71]
    v_exp_f32 v58, v58
    v_mfma_f32_16x16x32_bf16 v[68:71], a[152:155], v[168:171], v[68:71]
    ds_read_b64_tr_b16 a[188:189], v16 offset:40960
    v_add_f32 v19, v19, v58
    v_mfma_f32_16x16x32_bf16 v[68:71], a[156:159], v[172:175], v[68:71]
    s_waitcnt lgkmcnt(7)
    v_exp_f32 v59, v59
    v_mfma_f32_16x16x32_bf16 a[0:3], a[160:163], v[72:75], a[0:3]
    ds_read_b64_tr_b16 a[190:191], v16 offset:45056
    v_add_f32 v19, v19, v59
    v_cvt_pk_bf16_f32 v81, v58, v59
    v_mfma_f32_16x16x32_bf16 a[4:7], a[160:163], v[76:79], a[4:7]
    ds_read_b128 a[128:131], v5 offset:49152
    v_exp_f32 v60, v60
    v_mfma_f32_16x16x32_bf16 a[16:19], a[164:167], v[72:75], a[16:19]
    ds_read_b128 a[132:135], v6 offset:49152
    v_add_f32 v19, v19, v60
    v_mfma_f32_16x16x32_bf16 a[20:23], a[164:167], v[76:79], a[20:23]
    v_exp_f32 v61, v61
    v_mfma_f32_16x16x32_bf16 a[32:35], a[168:171], v[72:75], a[32:35]
    ds_read_b128 a[136:139], v7 offset:49152
    v_add_f32 v19, v19, v61
    v_cvt_pk_bf16_f32 v82, v60, v61
    v_mfma_f32_16x16x32_bf16 a[36:39], a[168:171], v[76:79], a[36:39]
    v_exp_f32 v62, v62
    v_mfma_f32_16x16x32_bf16 a[48:51], a[172:175], v[72:75], a[48:51]
    ds_read_b128 a[140:143], v8 offset:49152
    v_add_f32 v19, v19, v62
    v_mfma_f32_16x16x32_bf16 a[52:55], a[172:175], v[76:79], a[52:55]
    s_waitcnt lgkmcnt(4)
    v_exp_f32 v63, v63
    v_mfma_f32_16x16x32_bf16 a[64:67], a[176:179], v[72:75], a[64:67]
    ds_read_b128 a[144:147], v5 offset:53248
    v_add_f32 v19, v19, v63
    v_cvt_pk_bf16_f32 v83, v62, v63
    v_mfma_f32_16x16x32_bf16 a[68:71], a[176:179], v[76:79], a[68:71]
    v_exp_f32 v64, v64
    v_mfma_f32_16x16x32_bf16 a[80:83], a[180:183], v[72:75], a[80:83]
    ds_read_b128 a[148:151], v6 offset:53248
    v_add_f32 v20, v20, v64
    v_mfma_f32_16x16x32_bf16 a[84:87], a[180:183], v[76:79], a[84:87]
    v_exp_f32 v65, v65
    v_mfma_f32_16x16x32_bf16 a[96:99], a[184:187], v[72:75], a[96:99]
    ds_read_b128 a[152:155], v7 offset:53248
    v_add_f32 v20, v20, v65
    v_cvt_pk_bf16_f32 v84, v64, v65
    v_mfma_f32_16x16x32_bf16 a[100:103], a[184:187], v[76:79], a[100:103]
    v_exp_f32 v66, v66
    v_mfma_f32_16x16x32_bf16 a[112:115], a[188:191], v[72:75], a[112:115]
    ds_read_b128 a[156:159], v8 offset:53248
    v_add_f32 v20, v20, v66
    v_mfma_f32_16x16x32_bf16 a[116:119], a[188:191], v[76:79], a[116:119]
    s_waitcnt vmcnt(20) lgkmcnt(4)
    v_exp_f32 v67, v67
    v_mfma_f32_16x16x32_bf16 v[40:43], a[128:131], v[112:115], v[24:27]
    s_barrier
    v_add_f32 v20, v20, v67
    v_cvt_pk_bf16_f32 v85, v66, v67
    v_mfma_f32_16x16x32_bf16 v[40:43], a[132:135], v[116:119], v[40:43]
    s_add_u32 m0, s37, 0xa000
    v_exp_f32 v68, v68
    v_mfma_f32_16x16x32_bf16 v[40:43], a[136:139], v[120:123], v[40:43]
    buffer_load_dwordx4 v1, s[4:7], s36 offen offset:0 lds
    v_add_f32 v20, v20, v68
    v_mfma_f32_16x16x32_bf16 v[40:43], a[140:143], v[124:127], v[40:43]
    s_waitcnt lgkmcnt(0)
    v_exp_f32 v69, v69
    v_mfma_f32_16x16x32_bf16 v[44:47], a[144:147], v[112:115], v[24:27]
    v_add_f32 v20, v20, v69
    v_cvt_pk_bf16_f32 v86, v68, v69
    v_mfma_f32_16x16x32_bf16 v[44:47], a[148:151], v[116:119], v[44:47]
    v_exp_f32 v70, v70
    v_mfma_f32_16x16x32_bf16 v[44:47], a[152:155], v[120:123], v[44:47]
    buffer_load_dwordx4 v2, s[4:7], s36 offen offset:1024 lds
    v_add_f32 v20, v20, v70
    v_mfma_f32_16x16x32_bf16 v[44:47], a[156:159], v[124:127], v[44:47]
    v_exp_f32 v71, v71
    v_mfma_f32_16x16x32_bf16 v[48:51], a[128:131], v[128:131], v[28:31]
    v_add_f32 v20, v20, v71
    v_cvt_pk_bf16_f32 v87, v70, v71
    v_mfma_f32_16x16x32_bf16 v[48:51], a[132:135], v[132:135], v[48:51]
    s_add_u32 m0, s38, 0xa000
    v_exp_f32 v40, v40
    v_mfma_f32_16x16x32_bf16 v[48:51], a[136:139], v[136:139], v[48:51]
    buffer_load_dwordx4 v3, s[8:11], s36 offen offset:0 lds
    v_add_f32 v17, v17, v40
    v_mfma_f32_16x16x32_bf16 v[48:51], a[140:143], v[140:143], v[48:51]
    v_exp_f32 v41, v41
    v_mfma_f32_16x16x32_bf16 v[52:55], a[144:147], v[128:131], v[28:31]
    v_add_f32 v17, v17, v41
    v_cvt_pk_bf16_f32 v72, v40, v41
    v_mfma_f32_16x16x32_bf16 v[52:55], a[148:151], v[132:135], v[52:55]
    v_exp_f32 v42, v42
    v_mfma_f32_16x16x32_bf16 v[52:55], a[152:155], v[136:139], v[52:55]
    buffer_load_dwordx4 v4, s[8:11], s36 offen offset:1024 lds
    v_add_f32 v17, v17, v42
    v_mfma_f32_16x16x32_bf16 v[52:55], a[156:159], v[140:143], v[52:55]
    s_add_u32 s36, s36, 0x2000
    v_exp_f32 v43, v43
    v_mfma_f32_16x16x32_bf16 a[8:11], a[160:163], v[80:83], a[8:11]
    v_add_f32 v17, v17, v43
    v_cvt_pk_bf16_f32 v73, v42, v43
    v_mfma_f32_16x16x32_bf16 a[12:15], a[160:163], v[84:87], a[12:15]
    v_exp_f32 v44, v44
    v_mfma_f32_16x16x32_bf16 a[24:27], a[164:167], v[80:83], a[24:27]
    ds_read_b64_tr_b16 a[160:161], v9 offset:49152
    v_add_f32 v17, v17, v44
    v_mfma_f32_16x16x32_bf16 a[28:31], a[164:167], v[84:87], a[28:31]
    v_exp_f32 v45, v45
    v_mfma_f32_16x16x32_bf16 a[40:43], a[168:171], v[80:83], a[40:43]
    ds_read_b64_tr_b16 a[162:163], v9 offset:53248
    v_add_f32 v17, v17, v45
    v_cvt_pk_bf16_f32 v74, v44, v45
    v_mfma_f32_16x16x32_bf16 a[44:47], a[168:171], v[84:87], a[44:47]
    v_exp_f32 v46, v46
    v_mfma_f32_16x16x32_bf16 a[56:59], a[172:175], v[80:83], a[56:59]
    ds_read_b64_tr_b16 a[164:165], v10 offset:49152
    v_add_f32 v17, v17, v46
    v_mfma_f32_16x16x32_bf16 a[60:63], a[172:175], v[84:87], a[60:63]
    v_exp_f32 v47, v47
    v_mfma_f32_16x16x32_bf16 a[72:75], a[176:179], v[80:83], a[72:75]
    ds_read_b64_tr_b16 a[166:167], v10 offset:53248
    v_add_f32 v17, v17, v47
    v_cvt_pk_bf16_f32 v75, v46, v47
    v_mfma_f32_16x16x32_bf16 a[76:79], a[176:179], v[84:87], a[76:79]
    v_exp_f32 v48, v48
    v_mfma_f32_16x16x32_bf16 a[88:91], a[180:183], v[80:83], a[88:91]
    ds_read_b64_tr_b16 a[168:169], v11 offset:49152
    v_add_f32 v18, v18, v48
    v_mfma_f32_16x16x32_bf16 a[92:95], a[180:183], v[84:87], a[92:95]
    v_exp_f32 v49, v49
    v_mfma_f32_16x16x32_bf16 a[104:107], a[184:187], v[80:83], a[104:107]
    ds_read_b64_tr_b16 a[170:171], v11 offset:53248
    v_add_f32 v18, v18, v49
    v_cvt_pk_bf16_f32 v76, v48, v49
    v_mfma_f32_16x16x32_bf16 a[108:111], a[184:187], v[84:87], a[108:111]
    v_exp_f32 v50, v50
    v_mfma_f32_16x16x32_bf16 a[120:123], a[188:191], v[80:83], a[120:123]
    ds_read_b64_tr_b16 a[172:173], v12 offset:49152
    v_add_f32 v18, v18, v50
    v_mfma_f32_16x16x32_bf16 a[124:127], a[188:191], v[84:87], a[124:127]
    v_exp_f32 v51, v51
    v_mfma_f32_16x16x32_bf16 v[56:59], a[128:131], v[144:147], v[32:35]
    ds_read_b64_tr_b16 a[174:175], v12 offset:53248
    v_add_f32 v18, v18, v51
    v_cvt_pk_bf16_f32 v77, v50, v51
    v_mfma_f32_16x16x32_bf16 v[56:59], a[132:135], v[148:151], v[56:59]
    v_exp_f32 v52, v52
    v_mfma_f32_16x16x32_bf16 v[56:59], a[136:139], v[152:155], v[56:59]
    ds_read_b64_tr_b16 a[176:177], v13 offset:49152
    v_add_f32 v18, v18, v52
    v_mfma_f32_16x16x32_bf16 v[56:59], a[140:143], v[156:159], v[56:59]
    v_exp_f32 v53, v53
    v_mfma_f32_16x16x32_bf16 v[60:63], a[144:147], v[144:147], v[32:35]
    ds_read_b64_tr_b16 a[178:179], v13 offset:53248
    v_add_f32 v18, v18, v53
    v_cvt_pk_bf16_f32 v78, v52, v53
    v_mfma_f32_16x16x32_bf16 v[60:63], a[148:151], v[148:151], v[60:63]
    v_exp_f32 v54, v54
    v_mfma_f32_16x16x32_bf16 v[60:63], a[152:155], v[152:155], v[60:63]
    ds_read_b64_tr_b16 a[180:181], v14 offset:49152
    v_add_f32 v18, v18, v54
    v_mfma_f32_16x16x32_bf16 v[60:63], a[156:159], v[156:159], v[60:63]
    v_exp_f32 v55, v55
    v_mfma_f32_16x16x32_bf16 v[64:67], a[128:131], v[160:163], v[36:39]
    ds_read_b64_tr_b16 a[182:183], v14 offset:53248
    v_add_f32 v18, v18, v55
    v_cvt_pk_bf16_f32 v79, v54, v55
    v_mfma_f32_16x16x32_bf16 v[64:67], a[132:135], v[164:167], v[64:67]
    v_exp_f32 v56, v56
    v_mfma_f32_16x16x32_bf16 v[64:67], a[136:139], v[168:171], v[64:67]
    ds_read_b64_tr_b16 a[184:185], v15 offset:49152
    v_add_f32 v19, v19, v56
    v_mfma_f32_16x16x32_bf16 v[64:67], a[140:143], v[172:175], v[64:67]
    v_exp_f32 v57, v57
    v_mfma_f32_16x16x32_bf16 v[68:71], a[144:147], v[160:163], v[36:39]
    ds_read_b64_tr_b16 a[186:187], v15 offset:53248
    v_add_f32 v19, v19, v57
    v_cvt_pk_bf16_f32 v80, v56, v57
    v_mfma_f32_16x16x32_bf16 v[68:71], a[148:151], v[164:167], v[68:71]
    v_exp_f32 v58, v58
    v_mfma_f32_16x16x32_bf16 v[68:71], a[152:155], v[168:171], v[68:71]
    ds_read_b64_tr_b16 a[188:189], v16 offset:49152
    v_add_f32 v19, v19, v58
    v_mfma_f32_16x16x32_bf16 v[68:71], a[156:159], v[172:175], v[68:71]
    s_waitcnt lgkmcnt(7)
    v_exp_f32 v59, v59
    v_mfma_f32_16x16x32_bf16 a[0:3], a[160:163], v[72:75], a[0:3]
    ds_read_b64_tr_b16 a[190:191], v16 offset:53248
    v_add_f32 v19, v19, v59
    v_cvt_pk_bf16_f32 v81, v58, v59
    v_mfma_f32_16x16x32_bf16 a[4:7], a[160:163], v[76:79], a[4:7]
    ds_read_b128 a[128:131], v5 offset:57344
    v_exp_f32 v60, v60
    v_mfma_f32_16x16x32_bf16 a[16:19], a[164:167], v[72:75], a[16:19]
    ds_read_b128 a[132:135], v6 offset:57344
    v_add_f32 v19, v19, v60
    v_mfma_f32_16x16x32_bf16 a[20:23], a[164:167], v[76:79], a[20:23]
    v_exp_f32 v61, v61
    v_mfma_f32_16x16x32_bf16 a[32:35], a[168:171], v[72:75], a[32:35]
    ds_read_b128 a[136:139], v7 offset:57344
    v_add_f32 v19, v19, v61
    v_cvt_pk_bf16_f32 v82, v60, v61
    v_mfma_f32_16x16x32_bf16 a[36:39], a[168:171], v[76:79], a[36:39]
    v_exp_f32 v62, v62
    v_mfma_f32_16x16x32_bf16 a[48:51], a[172:175], v[72:75], a[48:51]
    ds_read_b128 a[140:143], v8 offset:57344
    v_add_f32 v19, v19, v62
    v_mfma_f32_16x16x32_bf16 a[52:55], a[172:175], v[76:79], a[52:55]
    s_waitcnt lgkmcnt(4)
    v_exp_f32 v63, v63
    v_mfma_f32_16x16x32_bf16 a[64:67], a[176:179], v[72:75], a[64:67]
    ds_read_b128 a[144:147], v5 offset:61440
    v_add_f32 v19, v19, v63
    v_cvt_pk_bf16_f32 v83, v62, v63
    v_mfma_f32_16x16x32_bf16 a[68:71], a[176:179], v[76:79], a[68:71]
    v_exp_f32 v64, v64
    v_mfma_f32_16x16x32_bf16 a[80:83], a[180:183], v[72:75], a[80:83]
    ds_read_b128 a[148:151], v6 offset:61440
    v_add_f32 v20, v20, v64
    v_mfma_f32_16x16x32_bf16 a[84:87], a[180:183], v[76:79], a[84:87]
    v_exp_f32 v65, v65
    v_mfma_f32_16x16x32_bf16 a[96:99], a[184:187], v[72:75], a[96:99]
    ds_read_b128 a[152:155], v7 offset:61440
    v_add_f32 v20, v20, v65
    v_cvt_pk_bf16_f32 v84, v64, v65
    v_mfma_f32_16x16x32_bf16 a[100:103], a[184:187], v[76:79], a[100:103]
    v_exp_f32 v66, v66
    v_mfma_f32_16x16x32_bf16 a[112:115], a[188:191], v[72:75], a[112:115]
    ds_read_b128 a[156:159], v8 offset:61440
    v_add_f32 v20, v20, v66
    v_mfma_f32_16x16x32_bf16 a[116:119], a[188:191], v[76:79], a[116:119]
    s_waitcnt vmcnt(20) lgkmcnt(4)
    v_exp_f32 v67, v67
    v_mfma_f32_16x16x32_bf16 v[40:43], a[128:131], v[112:115], v[24:27]
    s_barrier
    v_add_f32 v20, v20, v67
    v_cvt_pk_bf16_f32 v85, v66, v67
    v_mfma_f32_16x16x32_bf16 v[40:43], a[132:135], v[116:119], v[40:43]
    s_add_u32 m0, s37, 0xc000
    v_exp_f32 v68, v68
    v_mfma_f32_16x16x32_bf16 v[40:43], a[136:139], v[120:123], v[40:43]
    buffer_load_dwordx4 v1, s[4:7], s36 offen offset:0 lds
    v_add_f32 v20, v20, v68
    v_mfma_f32_16x16x32_bf16 v[40:43], a[140:143], v[124:127], v[40:43]
    s_waitcnt lgkmcnt(0)
    v_exp_f32 v69, v69
    v_mfma_f32_16x16x32_bf16 v[44:47], a[144:147], v[112:115], v[24:27]
    v_add_f32 v20, v20, v69
    v_cvt_pk_bf16_f32 v86, v68, v69
    v_mfma_f32_16x16x32_bf16 v[44:47], a[148:151], v[116:119], v[44:47]
    v_exp_f32 v70, v70
    v_mfma_f32_16x16x32_bf16 v[44:47], a[152:155], v[120:123], v[44:47]
    buffer_load_dwordx4 v2, s[4:7], s36 offen offset:1024 lds
    v_add_f32 v20, v20, v70
    v_mfma_f32_16x16x32_bf16 v[44:47], a[156:159], v[124:127], v[44:47]
    v_exp_f32 v71, v71
    v_mfma_f32_16x16x32_bf16 v[48:51], a[128:131], v[128:131], v[28:31]
    v_add_f32 v20, v20, v71
    v_cvt_pk_bf16_f32 v87, v70, v71
    v_mfma_f32_16x16x32_bf16 v[48:51], a[132:135], v[132:135], v[48:51]
    s_add_u32 m0, s38, 0xc000
    v_exp_f32 v40, v40
    v_mfma_f32_16x16x32_bf16 v[48:51], a[136:139], v[136:139], v[48:51]
    buffer_load_dwordx4 v3, s[8:11], s36 offen offset:0 lds
    v_add_f32 v17, v17, v40
    v_mfma_f32_16x16x32_bf16 v[48:51], a[140:143], v[140:143], v[48:51]
    v_exp_f32 v41, v41
    v_mfma_f32_16x16x32_bf16 v[52:55], a[144:147], v[128:131], v[28:31]
    v_add_f32 v17, v17, v41
    v_cvt_pk_bf16_f32 v72, v40, v41
    v_mfma_f32_16x16x32_bf16 v[52:55], a[148:151], v[132:135], v[52:55]
    v_exp_f32 v42, v42
    v_mfma_f32_16x16x32_bf16 v[52:55], a[152:155], v[136:139], v[52:55]
    buffer_load_dwordx4 v4, s[8:11], s36 offen offset:1024 lds
    v_add_f32 v17, v17, v42
    v_mfma_f32_16x16x32_bf16 v[52:55], a[156:159], v[140:143], v[52:55]
    s_add_u32 s36, s36, 0x2000
    v_exp_f32 v43, v43
    v_mfma_f32_16x16x32_bf16 a[8:11], a[160:163], v[80:83], a[8:11]
    v_add_f32 v17, v17, v43
    v_cvt_pk_bf16_f32 v73, v42, v43
    v_mfma_f32_16x16x32_bf16 a[12:15], a[160:163], v[84:87], a[12:15]
    v_exp_f32 v44, v44
    v_mfma_f32_16x16x32_bf16 a[24:27], a[164:167], v[80:83], a[24:27]
    ds_read_b64_tr_b16 a[160:161], v9 offset:57344
    v_add_f32 v17, v17, v44
    v_mfma_f32_16x16x32_bf16 a[28:31], a[164:167], v[84:87], a[28:31]
    v_exp_f32 v45, v45
    v_mfma_f32_16x16x32_bf16 a[40:43], a[168:171], v[80:83], a[40:43]
    ds_read_b64_tr_b16 a[162:163], v9 offset:61440
    v_add_f32 v17, v17, v45
    v_cvt_pk_bf16_f32 v74, v44, v45
    v_mfma_f32_16x16x32_bf16 a[44:47], a[168:171], v[84:87], a[44:47]
    v_exp_f32 v46, v46
    v_mfma_f32_16x16x32_bf16 a[56:59], a[172:175], v[80:83], a[56:59]
    ds_read_b64_tr_b16 a[164:165], v10 offset:57344
    v_add_f32 v17, v17, v46
    v_mfma_f32_16x16x32_bf16 a[60:63], a[172:175], v[84:87], a[60:63]
    v_exp_f32 v47, v47
    v_mfma_f32_16x16x32_bf16 a[72:75], a[176:179], v[80:83], a[72:75]
    ds_read_b64_tr_b16 a[166:167], v10 offset:61440
    v_add_f32 v17, v17, v47
    v_cvt_pk_bf16_f32 v75, v46, v47
    v_mfma_f32_16x16x32_bf16 a[76:79], a[176:179], v[84:87], a[76:79]
    v_exp_f32 v48, v48
    v_mfma_f32_16x16x32_bf16 a[88:91], a[180:183], v[80:83], a[88:91]
    ds_read_b64_tr_b16 a[168:169], v11 offset:57344
    v_add_f32 v18, v18, v48
    v_mfma_f32_16x16x32_bf16 a[92:95], a[180:183], v[84:87], a[92:95]
    v_exp_f32 v49, v49
    v_mfma_f32_16x16x32_bf16 a[104:107], a[184:187], v[80:83], a[104:107]
    ds_read_b64_tr_b16 a[170:171], v11 offset:61440
    v_add_f32 v18, v18, v49
    v_cvt_pk_bf16_f32 v76, v48, v49
    v_mfma_f32_16x16x32_bf16 a[108:111], a[184:187], v[84:87], a[108:111]
    v_exp_f32 v50, v50
    v_mfma_f32_16x16x32_bf16 a[120:123], a[188:191], v[80:83], a[120:123]
    ds_read_b64_tr_b16 a[172:173], v12 offset:57344
    v_add_f32 v18, v18, v50
    v_mfma_f32_16x16x32_bf16 a[124:127], a[188:191], v[84:87], a[124:127]
    v_exp_f32 v51, v51
    v_mfma_f32_16x16x32_bf16 v[56:59], a[128:131], v[144:147], v[32:35]
    ds_read_b64_tr_b16 a[174:175], v12 offset:61440
    v_add_f32 v18, v18, v51
    v_cvt_pk_bf16_f32 v77, v50, v51
    v_mfma_f32_16x16x32_bf16 v[56:59], a[132:135], v[148:151], v[56:59]
    v_exp_f32 v52, v52
    v_mfma_f32_16x16x32_bf16 v[56:59], a[136:139], v[152:155], v[56:59]
    ds_read_b64_tr_b16 a[176:177], v13 offset:57344
    v_add_f32 v18, v18, v52
    v_mfma_f32_16x16x32_bf16 v[56:59], a[140:143], v[156:159], v[56:59]
    v_exp_f32 v53, v53
    v_mfma_f32_16x16x32_bf16 v[60:63], a[144:147], v[144:147], v[32:35]
    ds_read_b64_tr_b16 a[178:179], v13 offset:61440
    v_add_f32 v18, v18, v53
    v_cvt_pk_bf16_f32 v78, v52, v53
    v_mfma_f32_16x16x32_bf16 v[60:63], a[148:151], v[148:151], v[60:63]
    v_exp_f32 v54, v54
    v_mfma_f32_16x16x32_bf16 v[60:63], a[152:155], v[152:155], v[60:63]
    ds_read_b64_tr_b16 a[180:181], v14 offset:57344
    v_add_f32 v18, v18, v54
    v_mfma_f32_16x16x32_bf16 v[60:63], a[156:159], v[156:159], v[60:63]
    v_exp_f32 v55, v55
    v_mfma_f32_16x16x32_bf16 v[64:67], a[128:131], v[160:163], v[36:39]
    ds_read_b64_tr_b16 a[182:183], v14 offset:61440
    v_add_f32 v18, v18, v55
    v_cvt_pk_bf16_f32 v79, v54, v55
    v_mfma_f32_16x16x32_bf16 v[64:67], a[132:135], v[164:167], v[64:67]
    v_exp_f32 v56, v56
    v_mfma_f32_16x16x32_bf16 v[64:67], a[136:139], v[168:171], v[64:67]
    ds_read_b64_tr_b16 a[184:185], v15 offset:57344
    v_add_f32 v19, v19, v56
    v_mfma_f32_16x16x32_bf16 v[64:67], a[140:143], v[172:175], v[64:67]
    v_exp_f32 v57, v57
    v_mfma_f32_16x16x32_bf16 v[68:71], a[144:147], v[160:163], v[36:39]
    ds_read_b64_tr_b16 a[186:187], v15 offset:61440
    v_add_f32 v19, v19, v57
    v_cvt_pk_bf16_f32 v80, v56, v57
    v_mfma_f32_16x16x32_bf16 v[68:71], a[148:151], v[164:167], v[68:71]
    v_exp_f32 v58, v58
    v_mfma_f32_16x16x32_bf16 v[68:71], a[152:155], v[168:171], v[68:71]
    ds_read_b64_tr_b16 a[188:189], v16 offset:57344
    v_add_f32 v19, v19, v58
    v_mfma_f32_16x16x32_bf16 v[68:71], a[156:159], v[172:175], v[68:71]
    s_waitcnt lgkmcnt(7)
    v_exp_f32 v59, v59
    v_mfma_f32_16x16x32_bf16 a[0:3], a[160:163], v[72:75], a[0:3]
    ds_read_b64_tr_b16 a[190:191], v16 offset:61440
    v_add_f32 v19, v19, v59
    v_cvt_pk_bf16_f32 v81, v58, v59
    v_mfma_f32_16x16x32_bf16 a[4:7], a[160:163], v[76:79], a[4:7]
    ds_read_b128 a[128:131], v5 offset:0
    v_exp_f32 v60, v60
    v_mfma_f32_16x16x32_bf16 a[16:19], a[164:167], v[72:75], a[16:19]
    ds_read_b128 a[132:135], v6 offset:0
    v_add_f32 v19, v19, v60
    v_mfma_f32_16x16x32_bf16 a[20:23], a[164:167], v[76:79], a[20:23]
    v_exp_f32 v61, v61
    v_mfma_f32_16x16x32_bf16 a[32:35], a[168:171], v[72:75], a[32:35]
    ds_read_b128 a[136:139], v7 offset:0
    v_add_f32 v19, v19, v61
    v_cvt_pk_bf16_f32 v82, v60, v61
    v_mfma_f32_16x16x32_bf16 a[36:39], a[168:171], v[76:79], a[36:39]
    v_exp_f32 v62, v62
    v_mfma_f32_16x16x32_bf16 a[48:51], a[172:175], v[72:75], a[48:51]
    ds_read_b128 a[140:143], v8 offset:0
    v_add_f32 v19, v19, v62
    v_mfma_f32_16x16x32_bf16 a[52:55], a[172:175], v[76:79], a[52:55]
    s_waitcnt lgkmcnt(4)
    v_exp_f32 v63, v63
    v_mfma_f32_16x16x32_bf16 a[64:67], a[176:179], v[72:75], a[64:67]
    ds_read_b128 a[144:147], v5 offset:4096
    v_add_f32 v19, v19, v63
    v_cvt_pk_bf16_f32 v83, v62, v63
    v_mfma_f32_16x16x32_bf16 a[68:71], a[176:179], v[76:79], a[68:71]
    v_exp_f32 v64, v64
    v_mfma_f32_16x16x32_bf16 a[80:83], a[180:183], v[72:75], a[80:83]
    ds_read_b128 a[148:151], v6 offset:4096
    v_add_f32 v20, v20, v64
    v_mfma_f32_16x16x32_bf16 a[84:87], a[180:183], v[76:79], a[84:87]
    v_exp_f32 v65, v65
    v_mfma_f32_16x16x32_bf16 a[96:99], a[184:187], v[72:75], a[96:99]
    ds_read_b128 a[152:155], v7 offset:4096
    v_add_f32 v20, v20, v65
    v_cvt_pk_bf16_f32 v84, v64, v65
    v_mfma_f32_16x16x32_bf16 a[100:103], a[184:187], v[76:79], a[100:103]
    v_exp_f32 v66, v66
    v_mfma_f32_16x16x32_bf16 a[112:115], a[188:191], v[72:75], a[112:115]
    ds_read_b128 a[156:159], v8 offset:4096
    v_add_f32 v20, v20, v66
    v_mfma_f32_16x16x32_bf16 a[116:119], a[188:191], v[76:79], a[116:119]
    s_waitcnt vmcnt(20) lgkmcnt(4)
    v_exp_f32 v67, v67
    s_sub_u32 s49, s49, 1
    s_cmp_lg_u32 s49, 0
    s_cbranch_scc1 K1_loop
    v_subrev_u32 v111, s78, v111
    v_subrev_u32 v111, 2, v111
    v_cmp_ge_u32 vcc, 5, v111
    s_nop 3
    s_and_b64 s[100:101], vcc, s[50:51]
    s_cmp_eq_u64 s[100:101], s[50:51]
    s_cbranch_scc1 FZ_f2_ok
    s_mov_b32 s79, 0x10000
FZ_f2:
    s_mov_b64 exec, s[50:51]
    buffer_load_dword v111, v110, s[96:99], 0 offen sc1
    s_mov_b64 exec, -1
    s_waitcnt vmcnt(0)
    v_subrev_u32 v111, s78, v111
    v_subrev_u32 v111, 2, v111
    v_cmp_ge_u32 vcc, 5, v111
    s_nop 3
    s_and_b64 s[100:101], vcc, s[50:51]
    s_cmp_eq_u64 s[100:101], s[50:51]
    s_cbranch_scc1 FZ_f2_ok
    s_sub_u32 s79, s79, 1
    s_cmp_lg_u32 s79, 0
    s_cbranch_scc1 FZ_f2
FZ_f2_ok:
    v_mfma_f32_16x16x32_bf16 v[40:43], a[128:131], v[112:115], v[24:27]
    s_barrier
    v_add_f32 v20, v20, v67
    v_cvt_pk_bf16_f32 v85, v66, v67
    v_mfma_f32_16x16x32_bf16 v[40:43], a[132:135], v[116:119], v[40:43]
    s_add_u32 m0, s37, 0xe000
    v_exp_f32 v68, v68
    v_mfma_f32_16x16x32_bf16 v[40:43], a[136:139], v[120:123], v[40:43]
    buffer_load_dwordx4 v1, s[4:7], s36 offen offset:0 lds
    v_add_f32 v20, v20, v68
    v_mfma_f32_16x16x32_bf16 v[40:43], a[140:143], v[124:127], v[40:43]
    s_waitcnt lgkmcnt(0)
    v_exp_f32 v69, v69
    v_mfma_f32_16x16x32_bf16 v[44:47], a[144:147], v[112:115], v[24:27]
    v_add_f32 v20, v20, v69
    v_cvt_pk_bf16_f32 v86, v68, v69
    v_mfma_f32_16x16x32_bf16 v[44:47], a[148:151], v[116:119], v[44:47]
    v_exp_f32 v70, v70
    v_mfma_f32_16x16x32_bf16 v[44:47], a[152:155], v[120:123], v[44:47]
    buffer_load_dwordx4 v2, s[4:7], s36 offen offset:1024 lds
    v_add_f32 v20, v20, v70
    v_mfma_f32_16x16x32_bf16 v[44:47], a[156:159], v[124:127], v[44:47]
    v_exp_f32 v71, v71
    v_mfma_f32_16x16x32_bf16 v[48:51], a[128:131], v[128:131], v[28:31]
    v_add_f32 v20, v20, v71
    v_cvt_pk_bf16_f32 v87, v70, v71
    v_mfma_f32_16x16x32_bf16 v[48:51], a[132:135], v[132:135], v[48:51]
    s_add_u32 m0, s38, 0xe000
    v_exp_f32 v40, v40
    v_mfma_f32_16x16x32_bf16 v[48:51], a[136:139], v[136:139], v[48:51]
    buffer_load_dwordx4 v3, s[8:11], s36 offen offset:0 lds
    v_add_f32 v17, v17, v40
    v_mfma_f32_16x16x32_bf16 v[48:51], a[140:143], v[140:143], v[48:51]
    v_exp_f32 v41, v41
    v_mfma_f32_16x16x32_bf16 v[52:55], a[144:147], v[128:131], v[28:31]
    v_add_f32 v17, v17, v41
    v_cvt_pk_bf16_f32 v72, v40, v41
    v_mfma_f32_16x16x32_bf16 v[52:55], a[148:151], v[132:135], v[52:55]
    v_exp_f32 v42, v42
    v_mfma_f32_16x16x32_bf16 v[52:55], a[152:155], v[136:139], v[52:55]
    buffer_load_dwordx4 v4, s[8:11], s36 offen offset:1024 lds
    v_add_f32 v17, v17, v42
    v_mfma_f32_16x16x32_bf16 v[52:55], a[156:159], v[140:143], v[52:55]
    s_add_u32 s36, s36, 0x2000
    v_exp_f32 v43, v43
    v_mfma_f32_16x16x32_bf16 a[8:11], a[160:163], v[80:83], a[8:11]
    v_add_f32 v17, v17, v43
    v_cvt_pk_bf16_f32 v73, v42, v43
    v_mfma_f32_16x16x32_bf16 a[12:15], a[160:163], v[84:87], a[12:15]
    v_exp_f32 v44, v44
    v_mfma_f32_16x16x32_bf16 a[24:27], a[164:167], v[80:83], a[24:27]
    ds_read_b64_tr_b16 a[160:161], v9 offset:0
    v_add_f32 v17, v17, v44
    v_mfma_f32_16x16x32_bf16 a[28:31], a[164:167], v[84:87], a[28:31]
    v_exp_f32 v45, v45
    v_mfma_f32_16x16x32_bf16 a[40:43], a[168:171], v[80:83], a[40:43]
    ds_read_b64_tr_b16 a[162:163], v9 offset:4096
    v_add_f32 v17, v17, v45
    v_cvt_pk_bf16_f32 v74, v44, v45
    v_mfma_f32_16x16x32_bf16 a[44:47], a[168:171], v[84:87], a[44:47]
    v_exp_f32 v46, v46
    v_mfma_f32_16x16x32_bf16 a[56:59], a[172:175], v[80:83], a[56:59]
    ds_read_b64_tr_b16 a[164:165], v10 offset:0
    v_add_f32 v17, v17, v46
    v_mfma_f32_16x16x32_bf16 a[60:63], a[172:175], v[84:87], a[60:63]
    v_exp_f32 v47, v47
    v_mfma_f32_16x16x32_bf16 a[72:75], a[176:179], v[80:83], a[72:75]
    ds_read_b64_tr_b16 a[166:167], v10 offset:4096
    v_add_f32 v17, v17, v47
    v_cvt_pk_bf16_f32 v75, v46, v47
    v_mfma_f32_16x16x32_bf16 a[76:79], a[176:179], v[84:87], a[76:79]
    v_exp_f32 v48, v48
    v_mfma_f32_16x16x32_bf16 a[88:91], a[180:183], v[80:83], a[88:91]
    ds_read_b64_tr_b16 a[168:169], v11 offset:0
    v_add_f32 v18, v18, v48
    v_mfma_f32_16x16x32_bf16 a[92:95], a[180:183], v[84:87], a[92:95]
    v_exp_f32 v49, v49
    v_mfma_f32_16x16x32_bf16 a[104:107], a[184:187], v[80:83], a[104:107]
    ds_read_b64_tr_b16 a[170:171], v11 offset:4096
    v_add_f32 v18, v18, v49
    v_cvt_pk_bf16_f32 v76, v48, v49
    v_mfma_f32_16x16x32_bf16 a[108:111], a[184:187], v[84:87], a[108:111]
    v_exp_f32 v50, v50
    v_mfma_f32_16x16x32_bf16 a[120:123], a[188:191], v[80:83], a[120:123]
    ds_read_b64_tr_b16 a[172:173], v12 offset:0
    v_add_f32 v18, v18, v50
    v_mfma_f32_16x16x32_bf16 a[124:127], a[188:191], v[84:87], a[124:127]
    v_exp_f32 v51, v51
    v_mfma_f32_16x16x32_bf16 v[56:59], a[128:131], v[144:147], v[32:35]
    ds_read_b64_tr_b16 a[174:175], v12 offset:4096
    v_add_f32 v18, v18, v51
    v_cvt_pk_bf16_f32 v77, v50, v51
    v_mfma_f32_16x16x32_bf16 v[56:59], a[132:135], v[148:151], v[56:59]
    v_exp_f32 v52, v52
    v_mfma_f32_16x16x32_bf16 v[56:59], a[136:139], v[152:155], v[56:59]
    ds_read_b64_tr_b16 a[176:177], v13 offset:0
    v_add_f32 v18, v18, v52
    v_mfma_f32_16x16x32_bf16 v[56:59], a[140:143], v[156:159], v[56:59]
    v_exp_f32 v53, v53
    v_mfma_f32_16x16x32_bf16 v[60:63], a[144:147], v[144:147], v[32:35]
    ds_read_b64_tr_b16 a[178:179], v13 offset:4096
    v_add_f32 v18, v18, v53
    v_cvt_pk_bf16_f32 v78, v52, v53
    v_mfma_f32_16x16x32_bf16 v[60:63], a[148:151], v[148:151], v[60:63]
    v_exp_f32 v54, v54
    v_mfma_f32_16x16x32_bf16 v[60:63], a[152:155], v[152:155], v[60:63]
    ds_read_b64_tr_b16 a[180:181], v14 offset:0
    v_add_f32 v18, v18, v54
    v_mfma_f32_16x16x32_bf16 v[60:63], a[156:159], v[156:159], v[60:63]
    v_exp_f32 v55, v55
    v_mfma_f32_16x16x32_bf16 v[64:67], a[128:131], v[160:163], v[36:39]
    ds_read_b64_tr_b16 a[182:183], v14 offset:4096
    v_add_f32 v18, v18, v55
    v_cvt_pk_bf16_f32 v79, v54, v55
    v_mfma_f32_16x16x32_bf16 v[64:67], a[132:135], v[164:167], v[64:67]
    v_exp_f32 v56, v56
    v_mfma_f32_16x16x32_bf16 v[64:67], a[136:139], v[168:171], v[64:67]
    ds_read_b64_tr_b16 a[184:185], v15 offset:0
    v_add_f32 v19, v19, v56
    v_mfma_f32_16x16x32_bf16 v[64:67], a[140:143], v[172:175], v[64:67]
    v_exp_f32 v57, v57
    v_mfma_f32_16x16x32_bf16 v[68:71], a[144:147], v[160:163], v[36:39]
    ds_read_b64_tr_b16 a[186:187], v15 offset:4096
    v_add_f32 v19, v19, v57
    v_cvt_pk_bf16_f32 v80, v56, v57
    v_mfma_f32_16x16x32_bf16 v[68:71], a[148:151], v[164:167], v[68:71]
    v_exp_f32 v58, v58
    v_mfma_f32_16x16x32_bf16 v[68:71], a[152:155], v[168:171], v[68:71]
    ds_read_b64_tr_b16 a[188:189], v16 offset:0
    v_add_f32 v19, v19, v58
    v_mfma_f32_16x16x32_bf16 v[68:71], a[156:159], v[172:175], v[68:71]
    s_waitcnt lgkmcnt(7)
    v_exp_f32 v59, v59
    v_mfma_f32_16x16x32_bf16 a[0:3], a[160:163], v[72:75], a[0:3]
    ds_read_b64_tr_b16 a[190:191], v16 offset:4096
    v_add_f32 v19, v19, v59
    v_cvt_pk_bf16_f32 v81, v58, v59
    v_mfma_f32_16x16x32_bf16 a[4:7], a[160:163], v[76:79], a[4:7]
    ds_read_b128 a[128:131], v5 offset:8192
    v_exp_f32 v60, v60
    v_mfma_f32_16x16x32_bf16 a[16:19], a[164:167], v[72:75], a[16:19]
    ds_read_b128 a[132:135], v6 offset:8192
    v_add_f32 v19, v19, v60
    v_mfma_f32_16x16x32_bf16 a[20:23], a[164:167], v[76:79], a[20:23]
    v_exp_f32 v61, v61
    v_mfma_f32_16x16x32_bf16 a[32:35], a[168:171], v[72:75], a[32:35]
    ds_read_b128 a[136:139], v7 offset:8192
    v_add_f32 v19, v19, v61
    v_cvt_pk_bf16_f32 v82, v60, v61
    v_mfma_f32_16x16x32_bf16 a[36:39], a[168:171], v[76:79], a[36:39]
    v_exp_f32 v62, v62
    v_mfma_f32_16x16x32_bf16 a[48:51], a[172:175], v[72:75], a[48:51]
    ds_read_b128 a[140:143], v8 offset:8192
    v_add_f32 v19, v19, v62
    v_mfma_f32_16x16x32_bf16 a[52:55], a[172:175], v[76:79], a[52:55]
    s_waitcnt lgkmcnt(4)
    v_exp_f32 v63, v63
    v_mfma_f32_16x16x32_bf16 a[64:67], a[176:179], v[72:75], a[64:67]
    ds_read_b128 a[144:147], v5 offset:12288
    v_add_f32 v19, v19, v63
    v_cvt_pk_bf16_f32 v83, v62, v63
    v_mfma_f32_16x16x32_bf16 a[68:71], a[176:179], v[76:79], a[68:71]
    v_exp_f32 v64, v64
    v_mfma_f32_16x16x32_bf16 a[80:83], a[180:183], v[72:75], a[80:83]
    ds_read_b128 a[148:151], v6 offset:12288
    v_add_f32 v20, v20, v64
    v_mfma_f32_16x16x32_bf16 a[84:87], a[180:183], v[76:79], a[84:87]
    v_exp_f32 v65, v65
    v_mfma_f32_16x16x32_bf16 a[96:99], a[184:187], v[72:75], a[96:99]
    ds_read_b128 a[152:155], v7 offset:12288
    v_add_f32 v20, v20, v65
    v_cvt_pk_bf16_f32 v84, v64, v65
    v_mfma_f32_16x16x32_bf16 a[100:103], a[184:187], v[76:79], a[100:103]
    v_exp_f32 v66, v66
    v_mfma_f32_16x16x32_bf16 a[112:115], a[188:191], v[72:75], a[112:115]
    ds_read_b128 a[156:159], v8 offset:12288
    v_add_f32 v20, v20, v66
    v_mfma_f32_16x16x32_bf16 a[116:119], a[188:191], v[76:79], a[116:119]
    s_waitcnt vmcnt(20) lgkmcnt(4)
    v_exp_f32 v67, v67
    v_mfma_f32_16x16x32_bf16 v[40:43], a[128:131], v[112:115], v[24:27]
    s_barrier
    v_add_f32 v20, v20, v67
    v_cvt_pk_bf16_f32 v85, v66, v67
    v_mfma_f32_16x16x32_bf16 v[40:43], a[132:135], v[116:119], v[40:43]
    s_add_u32 m0, s34, 0x20000
    v_exp_f32 v68, v68
    v_mfma_f32_16x16x32_bf16 v[40:43], a[136:139], v[120:123], v[40:43]
    buffer_load_dwordx4 v192, s[16:19], s32 offen offset:0 lds
    v_add_f32 v20, v20, v68
    v_mfma_f32_16x16x32_bf16 v[40:43], a[140:143], v[124:127], v[40:43]
    s_waitcnt lgkmcnt(0)
    v_exp_f32 v69, v69
    v_mfma_f32_16x16x32_bf16 v[44:47], a[144:147], v[112:115], v[24:27]
    v_add_f32 v20, v20, v69
    v_cvt_pk_bf16_f32 v86, v68, v69
    v_mfma_f32_16x16x32_bf16 v[44:47], a[148:151], v[116:119], v[44:47]
    v_exp_f32 v70, v70
    v_mfma_f32_16x16x32_bf16 v[44:47], a[152:155], v[120:123], v[44:47]
    buffer_load_dwordx4 v193, s[16:19], s32 offen offset:1024 lds
    v_add_f32 v20, v20, v70
    v_mfma_f32_16x16x32_bf16 v[44:47], a[156:159], v[124:127], v[44:47]
    v_exp_f32 v71, v71
    v_mfma_f32_16x16x32_bf16 v[48:51], a[128:131], v[128:131], v[28:31]
    v_add_f32 v20, v20, v71
    v_cvt_pk_bf16_f32 v87, v70, v71
    v_mfma_f32_16x16x32_bf16 v[48:51], a[132:135], v[132:135], v[48:51]
    v_exp_f32 v40, v40
    v_mfma_f32_16x16x32_bf16 v[48:51], a[136:139], v[136:139], v[48:51]
    buffer_load_dwordx4 v194, s[16:19], s32 offen offset:2048 lds
    v_add_f32 v17, v17, v40
    v_mfma_f32_16x16x32_bf16 v[48:51], a[140:143], v[140:143], v[48:51]
    v_exp_f32 v41, v41
    v_mfma_f32_16x16x32_bf16 v[52:55], a[144:147], v[128:131], v[28:31]
    v_add_f32 v17, v17, v41
    v_cvt_pk_bf16_f32 v72, v40, v41
    v_mfma_f32_16x16x32_bf16 v[52:55], a[148:151], v[132:135], v[52:55]
    v_exp_f32 v42, v42
    v_mfma_f32_16x16x32_bf16 v[52:55], a[152:155], v[136:139], v[52:55]
    buffer_load_dwordx4 v195, s[16:19], s32 offen offset:3072 lds
    v_add_f32 v17, v17, v42
    v_mfma_f32_16x16x32_bf16 v[52:55], a[156:159], v[140:143], v[52:55]
    v_exp_f32 v43, v43
    v_mfma_f32_16x16x32_bf16 a[8:11], a[160:163], v[80:83], a[8:11]
    v_add_f32 v17, v17, v43
    v_cvt_pk_bf16_f32 v73, v42, v43
    v_mfma_f32_16x16x32_bf16 a[12:15], a[160:163], v[84:87], a[12:15]
    v_exp_f32 v44, v44
    v_mfma_f32_16x16x32_bf16 a[24:27], a[164:167], v[80:83], a[24:27]
    ds_read_b64_tr_b16 a[160:161], v9 offset:8192
    v_add_f32 v17, v17, v44
    v_mfma_f32_16x16x32_bf16 a[28:31], a[164:167], v[84:87], a[28:31]
    v_exp_f32 v45, v45
    v_mfma_f32_16x16x32_bf16 a[40:43], a[168:171], v[80:83], a[40:43]
    ds_read_b64_tr_b16 a[162:163], v9 offset:12288
    v_add_f32 v17, v17, v45
    v_cvt_pk_bf16_f32 v74, v44, v45
    v_mfma_f32_16x16x32_bf16 a[44:47], a[168:171], v[84:87], a[44:47]
    v_exp_f32 v46, v46
    v_mfma_f32_16x16x32_bf16 a[56:59], a[172:175], v[80:83], a[56:59]
    ds_read_b64_tr_b16 a[164:165], v10 offset:8192
    v_add_f32 v17, v17, v46
    v_mfma_f32_16x16x32_bf16 a[60:63], a[172:175], v[84:87], a[60:63]
    v_exp_f32 v47, v47
    v_mfma_f32_16x16x32_bf16 a[72:75], a[176:179], v[80:83], a[72:75]
    ds_read_b64_tr_b16 a[166:167], v10 offset:12288
    v_add_f32 v17, v17, v47
    v_cvt_pk_bf16_f32 v75, v46, v47
    v_mfma_f32_16x16x32_bf16 a[76:79], a[176:179], v[84:87], a[76:79]
    v_exp_f32 v48, v48
    v_mfma_f32_16x16x32_bf16 a[88:91], a[180:183], v[80:83], a[88:91]
    ds_read_b64_tr_b16 a[168:169], v11 offset:8192
    v_add_f32 v18, v18, v48
    v_mfma_f32_16x16x32_bf16 a[92:95], a[180:183], v[84:87], a[92:95]
    v_exp_f32 v49, v49
    v_mfma_f32_16x16x32_bf16 a[104:107], a[184:187], v[80:83], a[104:107]
    ds_read_b64_tr_b16 a[170:171], v11 offset:12288
    v_add_f32 v18, v18, v49
    v_cvt_pk_bf16_f32 v76, v48, v49
    v_mfma_f32_16x16x32_bf16 a[108:111], a[184:187], v[84:87], a[108:111]
    v_exp_f32 v50, v50
    v_mfma_f32_16x16x32_bf16 a[120:123], a[188:191], v[80:83], a[120:123]
    ds_read_b64_tr_b16 a[172:173], v12 offset:8192
    v_add_f32 v18, v18, v50
    v_mfma_f32_16x16x32_bf16 a[124:127], a[188:191], v[84:87], a[124:127]
    v_exp_f32 v51, v51
    v_mfma_f32_16x16x32_bf16 v[56:59], a[128:131], v[144:147], v[32:35]
    ds_read_b64_tr_b16 a[174:175], v12 offset:12288
    v_add_f32 v18, v18, v51
    v_cvt_pk_bf16_f32 v77, v50, v51
    v_mfma_f32_16x16x32_bf16 v[56:59], a[132:135], v[148:151], v[56:59]
    v_exp_f32 v52, v52
    v_mfma_f32_16x16x32_bf16 v[56:59], a[136:139], v[152:155], v[56:59]
    ds_read_b64_tr_b16 a[176:177], v13 offset:8192
    v_add_f32 v18, v18, v52
    v_mfma_f32_16x16x32_bf16 v[56:59], a[140:143], v[156:159], v[56:59]
    v_exp_f32 v53, v53
    v_mfma_f32_16x16x32_bf16 v[60:63], a[144:147], v[144:147], v[32:35]
    ds_read_b64_tr_b16 a[178:179], v13 offset:12288
    v_add_f32 v18, v18, v53
    v_cvt_pk_bf16_f32 v78, v52, v53
    v_mfma_f32_16x16x32_bf16 v[60:63], a[148:151], v[148:151], v[60:63]
    v_exp_f32 v54, v54
    v_mfma_f32_16x16x32_bf16 v[60:63], a[152:155], v[152:155], v[60:63]
    ds_read_b64_tr_b16 a[180:181], v14 offset:8192
    v_add_f32 v18, v18, v54
    v_mfma_f32_16x16x32_bf16 v[60:63], a[156:159], v[156:159], v[60:63]
    v_exp_f32 v55, v55
    v_mfma_f32_16x16x32_bf16 v[64:67], a[128:131], v[160:163], v[36:39]
    ds_read_b64_tr_b16 a[182:183], v14 offset:12288
    v_add_f32 v18, v18, v55
    v_cvt_pk_bf16_f32 v79, v54, v55
    v_mfma_f32_16x16x32_bf16 v[64:67], a[132:135], v[164:167], v[64:67]
    v_exp_f32 v56, v56
    v_mfma_f32_16x16x32_bf16 v[64:67], a[136:139], v[168:171], v[64:67]
    ds_read_b64_tr_b16 a[184:185], v15 offset:8192
    v_add_f32 v19, v19, v56
    v_mfma_f32_16x16x32_bf16 v[64:67], a[140:143], v[172:175], v[64:67]
    v_exp_f32 v57, v57
    v_mfma_f32_16x16x32_bf16 v[68:71], a[144:147], v[160:163], v[36:39]
    ds_read_b64_tr_b16 a[186:187], v15 offset:12288
    v_add_f32 v19, v19, v57
    v_cvt_pk_bf16_f32 v80, v56, v57
    v_mfma_f32_16x16x32_bf16 v[68:71], a[148:151], v[164:167], v[68:71]
    v_exp_f32 v58, v58
    v_mfma_f32_16x16x32_bf16 v[68:71], a[152:155], v[168:171], v[68:71]
    ds_read_b64_tr_b16 a[188:189], v16 offset:8192
    v_add_f32 v19, v19, v58
    v_mfma_f32_16x16x32_bf16 v[68:71], a[156:159], v[172:175], v[68:71]
    s_waitcnt lgkmcnt(7)
    v_exp_f32 v59, v59
    v_mfma_f32_16x16x32_bf16 a[0:3], a[160:163], v[72:75], a[0:3]
    ds_read_b64_tr_b16 a[190:191], v16 offset:12288
    v_add_f32 v19, v19, v59
    v_cvt_pk_bf16_f32 v81, v58, v59
    v_mfma_f32_16x16x32_bf16 a[4:7], a[160:163], v[76:79], a[4:7]
    ds_read_b128 a[128:131], v5 offset:16384
    v_exp_f32 v60, v60
    v_mfma_f32_16x16x32_bf16 a[16:19], a[164:167], v[72:75], a[16:19]
    ds_read_b128 a[132:135], v6 offset:16384
    v_add_f32 v19, v19, v60
    v_mfma_f32_16x16x32_bf16 a[20:23], a[164:167], v[76:79], a[20:23]
    v_exp_f32 v61, v61
    v_mfma_f32_16x16x32_bf16 a[32:35], a[168:171], v[72:75], a[32:35]
    ds_read_b128 a[136:139], v7 offset:16384
    v_add_f32 v19, v19, v61
    v_cvt_pk_bf16_f32 v82, v60, v61
    v_mfma_f32_16x16x32_bf16 a[36:39], a[168:171], v[76:79], a[36:39]
    v_exp_f32 v62, v62
    v_mfma_f32_16x16x32_bf16 a[48:51], a[172:175], v[72:75], a[48:51]
    ds_read_b128 a[140:143], v8 offset:16384
    v_add_f32 v19, v19, v62
    v_mfma_f32_16x16x32_bf16 a[52:55], a[172:175], v[76:79], a[52:55]
    s_waitcnt lgkmcnt(4)
    v_exp_f32 v63, v63
    v_mfma_f32_16x16x32_bf16 a[64:67], a[176:179], v[72:75], a[64:67]
    ds_read_b128 a[144:147], v5 offset:20480
    v_add_f32 v19, v19, v63
    v_cvt_pk_bf16_f32 v83, v62, v63
    v_mfma_f32_16x16x32_bf16 a[68:71], a[176:179], v[76:79], a[68:71]
    v_exp_f32 v64, v64
    v_mfma_f32_16x16x32_bf16 a[80:83], a[180:183], v[72:75], a[80:83]
    ds_read_b128 a[148:151], v6 offset:20480
    v_add_f32 v20, v20, v64
    v_mfma_f32_16x16x32_bf16 a[84:87], a[180:183], v[76:79], a[84:87]
    v_exp_f32 v65, v65
    v_mfma_f32_16x16x32_bf16 a[96:99], a[184:187], v[72:75], a[96:99]
    ds_read_b128 a[152:155], v7 offset:20480
    v_add_f32 v20, v20, v65
    v_cvt_pk_bf16_f32 v84, v64, v65
    v_mfma_f32_16x16x32_bf16 a[100:103], a[184:187], v[76:79], a[100:103]
    v_exp_f32 v66, v66
    v_mfma_f32_16x16x32_bf16 a[112:115], a[188:191], v[72:75], a[112:115]
    ds_read_b128 a[156:159], v8 offset:20480
    v_add_f32 v20, v20, v66
    v_mfma_f32_16x16x32_bf16 a[116:119], a[188:191], v[76:79], a[116:119]
    s_waitcnt vmcnt(20) lgkmcnt(4)
    v_exp_f32 v67, v67
    v_mfma_f32_16x16x32_bf16 v[40:43], a[128:131], v[112:115], v[24:27]
    s_barrier
    v_add_f32 v20, v20, v67
    v_cvt_pk_bf16_f32 v85, v66, v67
    v_mfma_f32_16x16x32_bf16 v[40:43], a[132:135], v[116:119], v[40:43]
    s_add_u32 m0, s34, 0x21000
    v_exp_f32 v68, v68
    v_mfma_f32_16x16x32_bf16 v[40:43], a[136:139], v[120:123], v[40:43]
    buffer_load_dwordx4 v196, s[16:19], s32 offen offset:0 lds
    v_add_f32 v20, v20, v68
    v_mfma_f32_16x16x32_bf16 v[40:43], a[140:143], v[124:127], v[40:43]
    s_waitcnt lgkmcnt(0)
    s_add_u32 s32, s32, 0x14000
    v_exp_f32 v69, v69
    v_mfma_f32_16x16x32_bf16 v[44:47], a[144:147], v[112:115], v[24:27]
    v_add_f32 v20, v20, v69
    v_cvt_pk_bf16_f32 v86, v68, v69
    v_mfma_f32_16x16x32_bf16 v[44:47], a[148:151], v[116:119], v[44:47]
    v_exp_f32 v70, v70
    v_mfma_f32_16x16x32_bf16 v[44:47], a[152:155], v[120:123], v[44:47]
    buffer_load_dwordx4 a[192:195], v197, s[20:23], s33 offen offset:0 sc1
    v_add_f32 v20, v20, v70
    v_mfma_f32_16x16x32_bf16 v[44:47], a[156:159], v[124:127], v[44:47]
    v_exp_f32 v71, v71
    v_mfma_f32_16x16x32_bf16 v[48:51], a[128:131], v[128:131], v[28:31]
    v_add_f32 v20, v20, v71
    v_cvt_pk_bf16_f32 v87, v70, v71
    v_mfma_f32_16x16x32_bf16 v[48:51], a[132:135], v[132:135], v[48:51]
    v_exp_f32 v40, v40
    v_mfma_f32_16x16x32_bf16 v[48:51], a[136:139], v[136:139], v[48:51]
    buffer_load_dwordx4 a[196:199], v197, s[20:23], s33 offen offset:1024 sc1
    v_add_f32 v17, v17, v40
    v_mfma_f32_16x16x32_bf16 v[48:51], a[140:143], v[140:143], v[48:51]
    v_exp_f32 v41, v41
    v_mfma_f32_16x16x32_bf16 v[52:55], a[144:147], v[128:131], v[28:31]
    v_add_f32 v17, v17, v41
    v_cvt_pk_bf16_f32 v72, v40, v41
    v_mfma_f32_16x16x32_bf16 v[52:55], a[148:151], v[132:135], v[52:55]
    v_exp_f32 v42, v42
    v_mfma_f32_16x16x32_bf16 v[52:55], a[152:155], v[136:139], v[52:55]
    buffer_load_dwordx4 a[200:203], v198, s[20:23], s33 offen offset:0 sc1
    v_add_f32 v17, v17, v42
    v_mfma_f32_16x16x32_bf16 v[52:55], a[156:159], v[140:143], v[52:55]
    v_exp_f32 v43, v43
    v_mfma_f32_16x16x32_bf16 a[8:11], a[160:163], v[80:83], a[8:11]
    v_add_f32 v17, v17, v43
    v_cvt_pk_bf16_f32 v73, v42, v43
    v_mfma_f32_16x16x32_bf16 a[12:15], a[160:163], v[84:87], a[12:15]
    v_exp_f32 v44, v44
    v_mfma_f32_16x16x32_bf16 a[24:27], a[164:167], v[80:83], a[24:27]
    ds_read_b64_tr_b16 a[160:161], v9 offset:16384
    v_add_f32 v17, v17, v44
    v_mfma_f32_16x16x32_bf16 a[28:31], a[164:167], v[84:87], a[28:31]
    v_exp_f32 v45, v45
    v_mfma_f32_16x16x32_bf16 a[40:43], a[168:171], v[80:83], a[40:43]
    ds_read_b64_tr_b16 a[162:163], v9 offset:20480
    v_add_f32 v17, v17, v45
    v_cvt_pk_bf16_f32 v74, v44, v45
    v_mfma_f32_16x16x32_bf16 a[44:47], a[168:171], v[84:87], a[44:47]
    v_exp_f32 v46, v46
    v_mfma_f32_16x16x32_bf16 a[56:59], a[172:175], v[80:83], a[56:59]
    ds_read_b64_tr_b16 a[164:165], v10 offset:16384
    v_add_f32 v17, v17, v46
    v_mfma_f32_16x16x32_bf16 a[60:63], a[172:175], v[84:87], a[60:63]
    v_exp_f32 v47, v47
    v_mfma_f32_16x16x32_bf16 a[72:75], a[176:179], v[80:83], a[72:75]
    ds_read_b64_tr_b16 a[166:167], v10 offset:20480
    v_add_f32 v17, v17, v47
    v_cvt_pk_bf16_f32 v75, v46, v47
    v_mfma_f32_16x16x32_bf16 a[76:79], a[176:179], v[84:87], a[76:79]
    v_exp_f32 v48, v48
    v_mfma_f32_16x16x32_bf16 a[88:91], a[180:183], v[80:83], a[88:91]
    ds_read_b64_tr_b16 a[168:169], v11 offset:16384
    v_add_f32 v18, v18, v48
    v_mfma_f32_16x16x32_bf16 a[92:95], a[180:183], v[84:87], a[92:95]
    v_exp_f32 v49, v49
    v_mfma_f32_16x16x32_bf16 a[104:107], a[184:187], v[80:83], a[104:107]
    ds_read_b64_tr_b16 a[170:171], v11 offset:20480
    v_add_f32 v18, v18, v49
    v_cvt_pk_bf16_f32 v76, v48, v49
    v_mfma_f32_16x16x32_bf16 a[108:111], a[184:187], v[84:87], a[108:111]
    v_exp_f32 v50, v50
    v_mfma_f32_16x16x32_bf16 a[120:123], a[188:191], v[80:83], a[120:123]
    ds_read_b64_tr_b16 a[172:173], v12 offset:16384
    v_add_f32 v18, v18, v50
    v_mfma_f32_16x16x32_bf16 a[124:127], a[188:191], v[84:87], a[124:127]
    v_exp_f32 v51, v51
    v_mfma_f32_16x16x32_bf16 v[56:59], a[128:131], v[144:147], v[32:35]
    ds_read_b64_tr_b16 a[174:175], v12 offset:20480
    v_add_f32 v18, v18, v51
    v_cvt_pk_bf16_f32 v77, v50, v51
    v_mfma_f32_16x16x32_bf16 v[56:59], a[132:135], v[148:151], v[56:59]
    v_exp_f32 v52, v52
    v_mfma_f32_16x16x32_bf16 v[56:59], a[136:139], v[152:155], v[56:59]
    ds_read_b64_tr_b16 a[176:177], v13 offset:16384
    v_add_f32 v18, v18, v52
    v_mfma_f32_16x16x32_bf16 v[56:59], a[140:143], v[156:159], v[56:59]
    v_exp_f32 v53, v53
    v_mfma_f32_16x16x32_bf16 v[60:63], a[144:147], v[144:147], v[32:35]
    ds_read_b64_tr_b16 a[178:179], v13 offset:20480
    v_add_f32 v18, v18, v53
    v_cvt_pk_bf16_f32 v78, v52, v53
    v_mfma_f32_16x16x32_bf16 v[60:63], a[148:151], v[148:151], v[60:63]
    v_exp_f32 v54, v54
    v_mfma_f32_16x16x32_bf16 v[60:63], a[152:155], v[152:155], v[60:63]
    ds_read_b64_tr_b16 a[180:181], v14 offset:16384
    v_add_f32 v18, v18, v54
    v_mfma_f32_16x16x32_bf16 v[60:63], a[156:159], v[156:159], v[60:63]
    v_exp_f32 v55, v55
    v_mfma_f32_16x16x32_bf16 v[64:67], a[128:131], v[160:163], v[36:39]
    ds_read_b64_tr_b16 a[182:183], v14 offset:20480
    v_add_f32 v18, v18, v55
    v_cvt_pk_bf16_f32 v79, v54, v55
    v_mfma_f32_16x16x32_bf16 v[64:67], a[132:135], v[164:167], v[64:67]
    v_exp_f32 v56, v56
    v_mfma_f32_16x16x32_bf16 v[64:67], a[136:139], v[168:171], v[64:67]
    ds_read_b64_tr_b16 a[184:185], v15 offset:16384
    v_add_f32 v19, v19, v56
    v_mfma_f32_16x16x32_bf16 v[64:67], a[140:143], v[172:175], v[64:67]
    v_exp_f32 v57, v57
    v_mfma_f32_16x16x32_bf16 v[68:71], a[144:147], v[160:163], v[36:39]
    ds_read_b64_tr_b16 a[186:187], v15 offset:20480
    v_add_f32 v19, v19, v57
    v_cvt_pk_bf16_f32 v80, v56, v57
    v_mfma_f32_16x16x32_bf16 v[68:71], a[148:151], v[164:167], v[68:71]
    v_exp_f32 v58, v58
    v_mfma_f32_16x16x32_bf16 v[68:71], a[152:155], v[168:171], v[68:71]
    ds_read_b64_tr_b16 a[188:189], v16 offset:16384
    v_add_f32 v19, v19, v58
    v_mfma_f32_16x16x32_bf16 v[68:71], a[156:159], v[172:175], v[68:71]
    s_waitcnt lgkmcnt(7)
    v_exp_f32 v59, v59
    v_mfma_f32_16x16x32_bf16 a[0:3], a[160:163], v[72:75], a[0:3]
    ds_read_b64_tr_b16 a[190:191], v16 offset:20480
    v_add_f32 v19, v19, v59
    v_cvt_pk_bf16_f32 v81, v58, v59
    v_mfma_f32_16x16x32_bf16 a[4:7], a[160:163], v[76:79], a[4:7]
    ds_read_b128 a[128:131], v5 offset:24576
    v_exp_f32 v60, v60
    v_mfma_f32_16x16x32_bf16 a[16:19], a[164:167], v[72:75], a[16:19]
    ds_read_b128 a[132:135], v6 offset:24576
    v_add_f32 v19, v19, v60
    v_mfma_f32_16x16x32_bf16 a[20:23], a[164:167], v[76:79], a[20:23]
    v_exp_f32 v61, v61
    v_mfma_f32_16x16x32_bf16 a[32:35], a[168:171], v[72:75], a[32:35]
    ds_read_b128 a[136:139], v7 offset:24576
    v_add_f32 v19, v19, v61
    v_cvt_pk_bf16_f32 v82, v60, v61
    v_mfma_f32_16x16x32_bf16 a[36:39], a[168:171], v[76:79], a[36:39]
    v_exp_f32 v62, v62
    v_mfma_f32_16x16x32_bf16 a[48:51], a[172:175], v[72:75], a[48:51]
    ds_read_b128 a[140:143], v8 offset:24576
    v_add_f32 v19, v19, v62
    v_mfma_f32_16x16x32_bf16 a[52:55], a[172:175], v[76:79], a[52:55]
    s_waitcnt lgkmcnt(4)
    v_exp_f32 v63, v63
    v_mfma_f32_16x16x32_bf16 a[64:67], a[176:179], v[72:75], a[64:67]
    ds_read_b128 a[144:147], v5 offset:28672
    v_add_f32 v19, v19, v63
    v_cvt_pk_bf16_f32 v83, v62, v63
    v_mfma_f32_16x16x32_bf16 a[68:71], a[176:179], v[76:79], a[68:71]
    v_exp_f32 v64, v64
    v_mfma_f32_16x16x32_bf16 a[80:83], a[180:183], v[72:75], a[80:83]
    ds_read_b128 a[148:151], v6 offset:28672
    v_add_f32 v20, v20, v64
    v_mfma_f32_16x16x32_bf16 a[84:87], a[180:183], v[76:79], a[84:87]
    v_exp_f32 v65, v65
    v_mfma_f32_16x16x32_bf16 a[96:99], a[184:187], v[72:75], a[96:99]
    ds_read_b128 a[152:155], v7 offset:28672
    v_add_f32 v20, v20, v65
    v_cvt_pk_bf16_f32 v84, v64, v65
    v_mfma_f32_16x16x32_bf16 a[100:103], a[184:187], v[76:79], a[100:103]
    v_exp_f32 v66, v66
    v_mfma_f32_16x16x32_bf16 a[112:115], a[188:191], v[72:75], a[112:115]
    ds_read_b128 a[156:159], v8 offset:28672
    v_add_f32 v20, v20, v66
    v_mfma_f32_16x16x32_bf16 a[116:119], a[188:191], v[76:79], a[116:119]
    s_waitcnt vmcnt(20) lgkmcnt(4)
    v_exp_f32 v67, v67
    v_mfma_f32_16x16x32_bf16 v[40:43], a[128:131], v[112:115], v[24:27]
    s_barrier
    v_add_f32 v20, v20, v67
    v_cvt_pk_bf16_f32 v85, v66, v67
    v_mfma_f32_16x16x32_bf16 v[40:43], a[132:135], v[116:119], v[40:43]
    v_exp_f32 v68, v68
    v_mfma_f32_16x16x32_bf16 v[40:43], a[136:139], v[120:123], v[40:43]
    buffer_load_dwordx4 a[204:207], v198, s[20:23], s33 offen offset:1024 sc1
    v_add_f32 v20, v20, v68
    v_mfma_f32_16x16x32_bf16 v[40:43], a[140:143], v[124:127], v[40:43]
    s_waitcnt lgkmcnt(0)
    s_add_u32 s33, s33, 0x40000
    v_exp_f32 v69, v69
    v_mfma_f32_16x16x32_bf16 v[44:47], a[144:147], v[112:115], v[24:27]
    v_add_f32 v20, v20, v69
    v_cvt_pk_bf16_f32 v86, v68, v69
    v_mfma_f32_16x16x32_bf16 v[44:47], a[148:151], v[116:119], v[44:47]
    s_add_u32 m0, s34, 0
    v_exp_f32 v70, v70
    v_mfma_f32_16x16x32_bf16 v[44:47], a[152:155], v[120:123], v[44:47]
    buffer_load_dwordx4 v192, s[16:19], s32 offen offset:0 lds
    v_add_f32 v20, v20, v70
    v_mfma_f32_16x16x32_bf16 v[44:47], a[156:159], v[124:127], v[44:47]
    v_exp_f32 v71, v71
    v_mfma_f32_16x16x32_bf16 v[48:51], a[128:131], v[128:131], v[28:31]
    v_add_f32 v20, v20, v71
    v_cvt_pk_bf16_f32 v87, v70, v71
    v_mfma_f32_16x16x32_bf16 v[48:51], a[132:135], v[132:135], v[48:51]
    v_exp_f32 v40, v40
    v_mfma_f32_16x16x32_bf16 v[48:51], a[136:139], v[136:139], v[48:51]
    buffer_load_dwordx4 v193, s[16:19], s32 offen offset:1024 lds
    v_add_f32 v17, v17, v40
    v_mfma_f32_16x16x32_bf16 v[48:51], a[140:143], v[140:143], v[48:51]
    v_exp_f32 v41, v41
    v_mfma_f32_16x16x32_bf16 v[52:55], a[144:147], v[128:131], v[28:31]
    v_add_f32 v17, v17, v41
    v_cvt_pk_bf16_f32 v72, v40, v41
    v_mfma_f32_16x16x32_bf16 v[52:55], a[148:151], v[132:135], v[52:55]
    v_exp_f32 v42, v42
    v_mfma_f32_16x16x32_bf16 v[52:55], a[152:155], v[136:139], v[52:55]
    buffer_load_dwordx4 v194, s[16:19], s32 offen offset:2048 lds
    v_add_f32 v17, v17, v42
    v_mfma_f32_16x16x32_bf16 v[52:55], a[156:159], v[140:143], v[52:55]
    v_exp_f32 v43, v43
    v_mfma_f32_16x16x32_bf16 a[8:11], a[160:163], v[80:83], a[8:11]
    v_add_f32 v17, v17, v43
    v_cvt_pk_bf16_f32 v73, v42, v43
    v_mfma_f32_16x16x32_bf16 a[12:15], a[160:163], v[84:87], a[12:15]
    v_exp_f32 v44, v44
    v_mfma_f32_16x16x32_bf16 a[24:27], a[164:167], v[80:83], a[24:27]
    ds_read_b64_tr_b16 a[160:161], v9 offset:24576
    v_add_f32 v17, v17, v44
    v_mfma_f32_16x16x32_bf16 a[28:31], a[164:167], v[84:87], a[28:31]
    v_exp_f32 v45, v45
    v_mfma_f32_16x16x32_bf16 a[40:43], a[168:171], v[80:83], a[40:43]
    ds_read_b64_tr_b16 a[162:163], v9 offset:28672
    v_add_f32 v17, v17, v45
    v_cvt_pk_bf16_f32 v74, v44, v45
    v_mfma_f32_16x16x32_bf16 a[44:47], a[168:171], v[84:87], a[44:47]
    v_exp_f32 v46, v46
    v_mfma_f32_16x16x32_bf16 a[56:59], a[172:175], v[80:83], a[56:59]
    ds_read_b64_tr_b16 a[164:165], v10 offset:24576
    v_add_f32 v17, v17, v46
    v_mfma_f32_16x16x32_bf16 a[60:63], a[172:175], v[84:87], a[60:63]
    v_exp_f32 v47, v47
    v_mfma_f32_16x16x32_bf16 a[72:75], a[176:179], v[80:83], a[72:75]
    ds_read_b64_tr_b16 a[166:167], v10 offset:28672
    v_add_f32 v17, v17, v47
    v_cvt_pk_bf16_f32 v75, v46, v47
    v_mfma_f32_16x16x32_bf16 a[76:79], a[176:179], v[84:87], a[76:79]
    v_exp_f32 v48, v48
    v_mfma_f32_16x16x32_bf16 a[88:91], a[180:183], v[80:83], a[88:91]
    ds_read_b64_tr_b16 a[168:169], v11 offset:24576
    v_add_f32 v18, v18, v48
    v_mfma_f32_16x16x32_bf16 a[92:95], a[180:183], v[84:87], a[92:95]
    v_exp_f32 v49, v49
    v_mfma_f32_16x16x32_bf16 a[104:107], a[184:187], v[80:83], a[104:107]
    ds_read_b64_tr_b16 a[170:171], v11 offset:28672
    v_add_f32 v18, v18, v49
    v_cvt_pk_bf16_f32 v76, v48, v49
    v_mfma_f32_16x16x32_bf16 a[108:111], a[184:187], v[84:87], a[108:111]
    v_exp_f32 v50, v50
    v_mfma_f32_16x16x32_bf16 a[120:123], a[188:191], v[80:83], a[120:123]
    ds_read_b64_tr_b16 a[172:173], v12 offset:24576
    v_add_f32 v18, v18, v50
    v_mfma_f32_16x16x32_bf16 a[124:127], a[188:191], v[84:87], a[124:127]
    v_exp_f32 v51, v51
    v_mfma_f32_16x16x32_bf16 v[56:59], a[128:131], v[144:147], v[32:35]
    ds_read_b64_tr_b16 a[174:175], v12 offset:28672
    v_add_f32 v18, v18, v51
    v_cvt_pk_bf16_f32 v77, v50, v51
    v_mfma_f32_16x16x32_bf16 v[56:59], a[132:135], v[148:151], v[56:59]
    v_exp_f32 v52, v52
    v_mfma_f32_16x16x32_bf16 v[56:59], a[136:139], v[152:155], v[56:59]
    ds_read_b64_tr_b16 a[176:177], v13 offset:24576
    v_add_f32 v18, v18, v52
    v_mfma_f32_16x16x32_bf16 v[56:59], a[140:143], v[156:159], v[56:59]
    v_exp_f32 v53, v53
    v_mfma_f32_16x16x32_bf16 v[60:63], a[144:147], v[144:147], v[32:35]
    ds_read_b64_tr_b16 a[178:179], v13 offset:28672
    v_add_f32 v18, v18, v53
    v_cvt_pk_bf16_f32 v78, v52, v53
    v_mfma_f32_16x16x32_bf16 v[60:63], a[148:151], v[148:151], v[60:63]
    v_exp_f32 v54, v54
    v_mfma_f32_16x16x32_bf16 v[60:63], a[152:155], v[152:155], v[60:63]
    ds_read_b64_tr_b16 a[180:181], v14 offset:24576
    v_add_f32 v18, v18, v54
    v_mfma_f32_16x16x32_bf16 v[60:63], a[156:159], v[156:159], v[60:63]
    v_exp_f32 v55, v55
    v_mfma_f32_16x16x32_bf16 v[64:67], a[128:131], v[160:163], v[36:39]
    ds_read_b64_tr_b16 a[182:183], v14 offset:28672
    v_add_f32 v18, v18, v55
    v_cvt_pk_bf16_f32 v79, v54, v55
    v_mfma_f32_16x16x32_bf16 v[64:67], a[132:135], v[164:167], v[64:67]
    v_exp_f32 v56, v56
    v_mfma_f32_16x16x32_bf16 v[64:67], a[136:139], v[168:171], v[64:67]
    ds_read_b64_tr_b16 a[184:185], v15 offset:24576
    v_add_f32 v19, v19, v56
    v_mfma_f32_16x16x32_bf16 v[64:67], a[140:143], v[172:175], v[64:67]
    v_exp_f32 v57, v57
    v_mfma_f32_16x16x32_bf16 v[68:71], a[144:147], v[160:163], v[36:39]
    ds_read_b64_tr_b16 a[186:187], v15 offset:28672
    v_add_f32 v19, v19, v57
    v_cvt_pk_bf16_f32 v80, v56, v57
    v_mfma_f32_16x16x32_bf16 v[68:71], a[148:151], v[164:167], v[68:71]
    v_exp_f32 v58, v58
    v_mfma_f32_16x16x32_bf16 v[68:71], a[152:155], v[168:171], v[68:71]
    ds_read_b64_tr_b16 a[188:189], v16 offset:24576
    v_add_f32 v19, v19, v58
    v_mfma_f32_16x16x32_bf16 v[68:71], a[156:159], v[172:175], v[68:71]
    s_waitcnt lgkmcnt(7)
    v_exp_f32 v59, v59
    v_mfma_f32_16x16x32_bf16 a[0:3], a[160:163], v[72:75], a[0:3]
    ds_read_b64_tr_b16 a[190:191], v16 offset:28672
    v_add_f32 v19, v19, v59
    v_cvt_pk_bf16_f32 v81, v58, v59
    v_mfma_f32_16x16x32_bf16 a[4:7], a[160:163], v[76:79], a[4:7]
    ds_read_b128 a[128:131], v5 offset:32768
    v_exp_f32 v60, v60
    v_mfma_f32_16x16x32_bf16 a[16:19], a[164:167], v[72:75], a[16:19]
    ds_read_b128 a[132:135], v6 offset:32768
    v_add_f32 v19, v19, v60
    v_mfma_f32_16x16x32_bf16 a[20:23], a[164:167], v[76:79], a[20:23]
    v_exp_f32 v61, v61
    v_mfma_f32_16x16x32_bf16 a[32:35], a[168:171], v[72:75], a[32:35]
    ds_read_b128 a[136:139], v7 offset:32768
    v_add_f32 v19, v19, v61
    v_cvt_pk_bf16_f32 v82, v60, v61
    v_mfma_f32_16x16x32_bf16 a[36:39], a[168:171], v[76:79], a[36:39]
    v_exp_f32 v62, v62
    v_mfma_f32_16x16x32_bf16 a[48:51], a[172:175], v[72:75], a[48:51]
    ds_read_b128 a[140:143], v8 offset:32768
    v_add_f32 v19, v19, v62
    v_mfma_f32_16x16x32_bf16 a[52:55], a[172:175], v[76:79], a[52:55]
    s_waitcnt lgkmcnt(4)
    v_exp_f32 v63, v63
    v_mfma_f32_16x16x32_bf16 a[64:67], a[176:179], v[72:75], a[64:67]
    ds_read_b128 a[144:147], v5 offset:36864
    v_add_f32 v19, v19, v63
    v_cvt_pk_bf16_f32 v83, v62, v63
    v_mfma_f32_16x16x32_bf16 a[68:71], a[176:179], v[76:79], a[68:71]
    v_exp_f32 v64, v64
    v_mfma_f32_16x16x32_bf16 a[80:83], a[180:183], v[72:75], a[80:83]
    ds_read_b128 a[148:151], v6 offset:36864
    v_add_f32 v20, v20, v64
    v_mfma_f32_16x16x32_bf16 a[84:87], a[180:183], v[76:79], a[84:87]
    v_exp_f32 v65, v65
    v_mfma_f32_16x16x32_bf16 a[96:99], a[184:187], v[72:75], a[96:99]
    ds_read_b128 a[152:155], v7 offset:36864
    v_add_f32 v20, v20, v65
    v_cvt_pk_bf16_f32 v84, v64, v65
    v_mfma_f32_16x16x32_bf16 a[100:103], a[184:187], v[76:79], a[100:103]
    v_exp_f32 v66, v66
    v_mfma_f32_16x16x32_bf16 a[112:115], a[188:191], v[72:75], a[112:115]
    ds_read_b128 a[156:159], v8 offset:36864
    v_add_f32 v20, v20, v66
    v_mfma_f32_16x16x32_bf16 a[116:119], a[188:191], v[76:79], a[116:119]
    s_waitcnt vmcnt(20) lgkmcnt(4)
    v_exp_f32 v67, v67
    v_mfma_f32_16x16x32_bf16 v[40:43], a[128:131], v[112:115], v[24:27]
    s_barrier
    v_add_f32 v20, v20, v67
    v_cvt_pk_bf16_f32 v85, v66, v67
    v_mfma_f32_16x16x32_bf16 v[40:43], a[132:135], v[116:119], v[40:43]
    v_exp_f32 v68, v68
    v_mfma_f32_16x16x32_bf16 v[40:43], a[136:139], v[120:123], v[40:43]
    buffer_load_dwordx4 v195, s[16:19], s32 offen offset:3072 lds
    v_add_f32 v20, v20, v68
    v_mfma_f32_16x16x32_bf16 v[40:43], a[140:143], v[124:127], v[40:43]
    s_waitcnt lgkmcnt(0)
    v_exp_f32 v69, v69
    v_mfma_f32_16x16x32_bf16 v[44:47], a[144:147], v[112:115], v[24:27]
    v_add_f32 v20, v20, v69
    v_cvt_pk_bf16_f32 v86, v68, v69
    v_mfma_f32_16x16x32_bf16 v[44:47], a[148:151], v[116:119], v[44:47]
    s_add_u32 m0, s34, 0x1000
    v_exp_f32 v70, v70
    v_mfma_f32_16x16x32_bf16 v[44:47], a[152:155], v[120:123], v[44:47]
    buffer_load_dwordx4 v196, s[16:19], s32 offen offset:0 lds
    v_add_f32 v20, v20, v70
    v_mfma_f32_16x16x32_bf16 v[44:47], a[156:159], v[124:127], v[44:47]
    s_add_u32 s32, s32, 0x14000
    v_exp_f32 v71, v71
    v_mfma_f32_16x16x32_bf16 v[48:51], a[128:131], v[128:131], v[28:31]
    v_add_f32 v20, v20, v71
    v_cvt_pk_bf16_f32 v87, v70, v71
    v_mfma_f32_16x16x32_bf16 v[48:51], a[132:135], v[132:135], v[48:51]
    s_add_u32 m0, s34, 0x10000
    v_exp_f32 v40, v40
    v_mfma_f32_16x16x32_bf16 v[48:51], a[136:139], v[136:139], v[48:51]
    buffer_load_dwordx4 v192, s[16:19], s32 offen offset:0 lds
    v_add_f32 v17, v17, v40
    v_mfma_f32_16x16x32_bf16 v[48:51], a[140:143], v[140:143], v[48:51]
    v_exp_f32 v41, v41
    v_mfma_f32_16x16x32_bf16 v[52:55], a[144:147], v[128:131], v[28:31]
    v_add_f32 v17, v17, v41
    v_cvt_pk_bf16_f32 v72, v40, v41
    v_mfma_f32_16x16x32_bf16 v[52:55], a[148:151], v[132:135], v[52:55]
    v_exp_f32 v42, v42
    v_mfma_f32_16x16x32_bf16 v[52:55], a[152:155], v[136:139], v[52:55]
    buffer_load_dwordx4 v193, s[16:19], s32 offen offset:1024 lds
    v_add_f32 v17, v17, v42
    v_mfma_f32_16x16x32_bf16 v[52:55], a[156:159], v[140:143], v[52:55]
    v_exp_f32 v43, v43
    v_mfma_f32_16x16x32_bf16 a[8:11], a[160:163], v[80:83], a[8:11]
    v_add_f32 v17, v17, v43
    v_cvt_pk_bf16_f32 v73, v42, v43
    v_mfma_f32_16x16x32_bf16 a[12:15], a[160:163], v[84:87], a[12:15]
    v_exp_f32 v44, v44
    v_mfma_f32_16x16x32_bf16 a[24:27], a[164:167], v[80:83], a[24:27]
    ds_read_b64_tr_b16 a[160:161], v9 offset:32768
    v_add_f32 v17, v17, v44
    v_mfma_f32_16x16x32_bf16 a[28:31], a[164:167], v[84:87], a[28:31]
    v_exp_f32 v45, v45
    v_mfma_f32_16x16x32_bf16 a[40:43], a[168:171], v[80:83], a[40:43]
    ds_read_b64_tr_b16 a[162:163], v9 offset:36864
    v_add_f32 v17, v17, v45
    v_cvt_pk_bf16_f32 v74, v44, v45
    v_mfma_f32_16x16x32_bf16 a[44:47], a[168:171], v[84:87], a[44:47]
    v_exp_f32 v46, v46
    v_mfma_f32_16x16x32_bf16 a[56:59], a[172:175], v[80:83], a[56:59]
    ds_read_b64_tr_b16 a[164:165], v10 offset:32768
    v_add_f32 v17, v17, v46
    v_mfma_f32_16x16x32_bf16 a[60:63], a[172:175], v[84:87], a[60:63]
    v_exp_f32 v47, v47
    v_mfma_f32_16x16x32_bf16 a[72:75], a[176:179], v[80:83], a[72:75]
    ds_read_b64_tr_b16 a[166:167], v10 offset:36864
    v_add_f32 v17, v17, v47
    v_cvt_pk_bf16_f32 v75, v46, v47
    v_mfma_f32_16x16x32_bf16 a[76:79], a[176:179], v[84:87], a[76:79]
    v_exp_f32 v48, v48
    v_mfma_f32_16x16x32_bf16 a[88:91], a[180:183], v[80:83], a[88:91]
    ds_read_b64_tr_b16 a[168:169], v11 offset:32768
    v_add_f32 v18, v18, v48
    v_mfma_f32_16x16x32_bf16 a[92:95], a[180:183], v[84:87], a[92:95]
    v_exp_f32 v49, v49
    v_mfma_f32_16x16x32_bf16 a[104:107], a[184:187], v[80:83], a[104:107]
    ds_read_b64_tr_b16 a[170:171], v11 offset:36864
    v_add_f32 v18, v18, v49
    v_cvt_pk_bf16_f32 v76, v48, v49
    v_mfma_f32_16x16x32_bf16 a[108:111], a[184:187], v[84:87], a[108:111]
    v_exp_f32 v50, v50
    v_mfma_f32_16x16x32_bf16 a[120:123], a[188:191], v[80:83], a[120:123]
    ds_read_b64_tr_b16 a[172:173], v12 offset:32768
    v_add_f32 v18, v18, v50
    v_mfma_f32_16x16x32_bf16 a[124:127], a[188:191], v[84:87], a[124:127]
    v_exp_f32 v51, v51
    v_mfma_f32_16x16x32_bf16 v[56:59], a[128:131], v[144:147], v[32:35]
    ds_read_b64_tr_b16 a[174:175], v12 offset:36864
    v_add_f32 v18, v18, v51
    v_cvt_pk_bf16_f32 v77, v50, v51
    v_mfma_f32_16x16x32_bf16 v[56:59], a[132:135], v[148:151], v[56:59]
    v_exp_f32 v52, v52
    v_mfma_f32_16x16x32_bf16 v[56:59], a[136:139], v[152:155], v[56:59]
    ds_read_b64_tr_b16 a[176:177], v13 offset:32768
    v_add_f32 v18, v18, v52
    v_mfma_f32_16x16x32_bf16 v[56:59], a[140:143], v[156:159], v[56:59]
    v_exp_f32 v53, v53
    v_mfma_f32_16x16x32_bf16 v[60:63], a[144:147], v[144:147], v[32:35]
    ds_read_b64_tr_b16 a[178:179], v13 offset:36864
    v_add_f32 v18, v18, v53
    v_cvt_pk_bf16_f32 v78, v52, v53
    v_mfma_f32_16x16x32_bf16 v[60:63], a[148:151], v[148:151], v[60:63]
    v_exp_f32 v54, v54
    v_mfma_f32_16x16x32_bf16 v[60:63], a[152:155], v[152:155], v[60:63]
    ds_read_b64_tr_b16 a[180:181], v14 offset:32768
    v_add_f32 v18, v18, v54
    v_mfma_f32_16x16x32_bf16 v[60:63], a[156:159], v[156:159], v[60:63]
    v_exp_f32 v55, v55
    v_mfma_f32_16x16x32_bf16 v[64:67], a[128:131], v[160:163], v[36:39]
    ds_read_b64_tr_b16 a[182:183], v14 offset:36864
    v_add_f32 v18, v18, v55
    v_cvt_pk_bf16_f32 v79, v54, v55
    v_mfma_f32_16x16x32_bf16 v[64:67], a[132:135], v[164:167], v[64:67]
    v_exp_f32 v56, v56
    v_mfma_f32_16x16x32_bf16 v[64:67], a[136:139], v[168:171], v[64:67]
    ds_read_b64_tr_b16 a[184:185], v15 offset:32768
    v_add_f32 v19, v19, v56
    v_mfma_f32_16x16x32_bf16 v[64:67], a[140:143], v[172:175], v[64:67]
    v_exp_f32 v57, v57
    v_mfma_f32_16x16x32_bf16 v[68:71], a[144:147], v[160:163], v[36:39]
    ds_read_b64_tr_b16 a[186:187], v15 offset:36864
    v_add_f32 v19, v19, v57
    v_cvt_pk_bf16_f32 v80, v56, v57
    v_mfma_f32_16x16x32_bf16 v[68:71], a[148:151], v[164:167], v[68:71]
    v_exp_f32 v58, v58
    v_mfma_f32_16x16x32_bf16 v[68:71], a[152:155], v[168:171], v[68:71]
    ds_read_b64_tr_b16 a[188:189], v16 offset:32768
    v_add_f32 v19, v19, v58
    v_mfma_f32_16x16x32_bf16 v[68:71], a[156:159], v[172:175], v[68:71]
    s_waitcnt lgkmcnt(7)
    v_exp_f32 v59, v59
    v_mfma_f32_16x16x32_bf16 a[0:3], a[160:163], v[72:75], a[0:3]
    ds_read_b64_tr_b16 a[190:191], v16 offset:36864
    v_add_f32 v19, v19, v59
    v_cvt_pk_bf16_f32 v81, v58, v59
    v_mfma_f32_16x16x32_bf16 a[4:7], a[160:163], v[76:79], a[4:7]
    ds_read_b128 a[128:131], v5 offset:40960
    v_exp_f32 v60, v60
    v_mfma_f32_16x16x32_bf16 a[16:19], a[164:167], v[72:75], a[16:19]
    ds_read_b128 a[132:135], v6 offset:40960
    v_add_f32 v19, v19, v60
    v_mfma_f32_16x16x32_bf16 a[20:23], a[164:167], v[76:79], a[20:23]
    v_exp_f32 v61, v61
    v_mfma_f32_16x16x32_bf16 a[32:35], a[168:171], v[72:75], a[32:35]
    ds_read_b128 a[136:139], v7 offset:40960
    v_add_f32 v19, v19, v61
    v_cvt_pk_bf16_f32 v82, v60, v61
    v_mfma_f32_16x16x32_bf16 a[36:39], a[168:171], v[76:79], a[36:39]
    v_exp_f32 v62, v62
    v_mfma_f32_16x16x32_bf16 a[48:51], a[172:175], v[72:75], a[48:51]
    ds_read_b128 a[140:143], v8 offset:40960
    v_add_f32 v19, v19, v62
    v_mfma_f32_16x16x32_bf16 a[52:55], a[172:175], v[76:79], a[52:55]
    s_waitcnt lgkmcnt(4)
    v_exp_f32 v63, v63
    v_mfma_f32_16x16x32_bf16 a[64:67], a[176:179], v[72:75], a[64:67]
    ds_read_b128 a[144:147], v5 offset:45056
    v_add_f32 v19, v19, v63
    v_cvt_pk_bf16_f32 v83, v62, v63
    v_mfma_f32_16x16x32_bf16 a[68:71], a[176:179], v[76:79], a[68:71]
    v_exp_f32 v64, v64
    v_mfma_f32_16x16x32_bf16 a[80:83], a[180:183], v[72:75], a[80:83]
    ds_read_b128 a[148:151], v6 offset:45056
    v_add_f32 v20, v20, v64
    v_mfma_f32_16x16x32_bf16 a[84:87], a[180:183], v[76:79], a[84:87]
    v_exp_f32 v65, v65
    v_mfma_f32_16x16x32_bf16 a[96:99], a[184:187], v[72:75], a[96:99]
    ds_read_b128 a[152:155], v7 offset:45056
    v_add_f32 v20, v20, v65
    v_cvt_pk_bf16_f32 v84, v64, v65
    v_mfma_f32_16x16x32_bf16 a[100:103], a[184:187], v[76:79], a[100:103]
    v_exp_f32 v66, v66
    v_mfma_f32_16x16x32_bf16 a[112:115], a[188:191], v[72:75], a[112:115]
    ds_read_b128 a[156:159], v8 offset:45056
    v_add_f32 v20, v20, v66
    v_mfma_f32_16x16x32_bf16 a[116:119], a[188:191], v[76:79], a[116:119]
    s_waitcnt vmcnt(20) lgkmcnt(4)
    v_exp_f32 v67, v67
    v_mfma_f32_16x16x32_bf16 v[40:43], a[128:131], v[112:115], v[24:27]
    s_barrier
    v_add_f32 v20, v20, v67
    v_cvt_pk_bf16_f32 v85, v66, v67
    v_mfma_f32_16x16x32_bf16 v[40:43], a[132:135], v[116:119], v[40:43]
    v_exp_f32 v68, v68
    v_mfma_f32_16x16x32_bf16 v[40:43], a[136:139], v[120:123], v[40:43]
    buffer_load_dwordx4 v194, s[16:19], s32 offen offset:2048 lds
    v_add_f32 v20, v20, v68
    v_mfma_f32_16x16x32_bf16 v[40:43], a[140:143], v[124:127], v[40:43]
    s_waitcnt lgkmcnt(0)
    v_exp_f32 v69, v69
    v_mfma_f32_16x16x32_bf16 v[44:47], a[144:147], v[112:115], v[24:27]
    v_add_f32 v20, v20, v69
    v_cvt_pk_bf16_f32 v86, v68, v69
    v_mfma_f32_16x16x32_bf16 v[44:47], a[148:151], v[116:119], v[44:47]
    v_exp_f32 v70, v70
    v_mfma_f32_16x16x32_bf16 v[44:47], a[152:155], v[120:123], v[44:47]
    buffer_load_dwordx4 v195, s[16:19], s32 offen offset:3072 lds
    v_add_f32 v20, v20, v70
    v_mfma_f32_16x16x32_bf16 v[44:47], a[156:159], v[124:127], v[44:47]
    v_exp_f32 v71, v71
    v_mfma_f32_16x16x32_bf16 v[48:51], a[128:131], v[128:131], v[28:31]
    v_add_f32 v20, v20, v71
    v_cvt_pk_bf16_f32 v87, v70, v71
    v_mfma_f32_16x16x32_bf16 v[48:51], a[132:135], v[132:135], v[48:51]
    s_add_u32 m0, s34, 0x11000
    v_exp_f32 v40, v40
    v_mfma_f32_16x16x32_bf16 v[48:51], a[136:139], v[136:139], v[48:51]
    buffer_load_dwordx4 v196, s[16:19], s32 offen offset:0 lds
    v_add_f32 v17, v17, v40
    v_mfma_f32_16x16x32_bf16 v[48:51], a[140:143], v[140:143], v[48:51]
    s_add_u32 s32, s32, 0x14000
    v_exp_f32 v41, v41
    v_mfma_f32_16x16x32_bf16 v[52:55], a[144:147], v[128:131], v[28:31]
    v_add_f32 v17, v17, v41
    v_cvt_pk_bf16_f32 v72, v40, v41
    v_mfma_f32_16x16x32_bf16 v[52:55], a[148:151], v[132:135], v[52:55]
    v_exp_f32 v42, v42
    v_mfma_f32_16x16x32_bf16 v[52:55], a[152:155], v[136:139], v[52:55]
    buffer_load_dwordx4 a[208:211], v197, s[20:23], s33 offen offset:0 sc1
    v_add_f32 v17, v17, v42
    v_mfma_f32_16x16x32_bf16 v[52:55], a[156:159], v[140:143], v[52:55]
    v_exp_f32 v43, v43
    v_mfma_f32_16x16x32_bf16 a[8:11], a[160:163], v[80:83], a[8:11]
    v_add_f32 v17, v17, v43
    v_cvt_pk_bf16_f32 v73, v42, v43
    v_mfma_f32_16x16x32_bf16 a[12:15], a[160:163], v[84:87], a[12:15]
    v_exp_f32 v44, v44
    v_mfma_f32_16x16x32_bf16 a[24:27], a[164:167], v[80:83], a[24:27]
    ds_read_b64_tr_b16 a[160:161], v9 offset:40960
    v_add_f32 v17, v17, v44
    v_mfma_f32_16x16x32_bf16 a[28:31], a[164:167], v[84:87], a[28:31]
    v_exp_f32 v45, v45
    v_mfma_f32_16x16x32_bf16 a[40:43], a[168:171], v[80:83], a[40:43]
    ds_read_b64_tr_b16 a[162:163], v9 offset:45056
    v_add_f32 v17, v17, v45
    v_cvt_pk_bf16_f32 v74, v44, v45
    v_mfma_f32_16x16x32_bf16 a[44:47], a[168:171], v[84:87], a[44:47]
    v_exp_f32 v46, v46
    v_mfma_f32_16x16x32_bf16 a[56:59], a[172:175], v[80:83], a[56:59]
    ds_read_b64_tr_b16 a[164:165], v10 offset:40960
    v_add_f32 v17, v17, v46
    v_mfma_f32_16x16x32_bf16 a[60:63], a[172:175], v[84:87], a[60:63]
    v_exp_f32 v47, v47
    v_mfma_f32_16x16x32_bf16 a[72:75], a[176:179], v[80:83], a[72:75]
    ds_read_b64_tr_b16 a[166:167], v10 offset:45056
    v_add_f32 v17, v17, v47
    v_cvt_pk_bf16_f32 v75, v46, v47
    v_mfma_f32_16x16x32_bf16 a[76:79], a[176:179], v[84:87], a[76:79]
    v_exp_f32 v48, v48
    v_mfma_f32_16x16x32_bf16 a[88:91], a[180:183], v[80:83], a[88:91]
    ds_read_b64_tr_b16 a[168:169], v11 offset:40960
    v_add_f32 v18, v18, v48
    v_mfma_f32_16x16x32_bf16 a[92:95], a[180:183], v[84:87], a[92:95]
    v_exp_f32 v49, v49
    v_mfma_f32_16x16x32_bf16 a[104:107], a[184:187], v[80:83], a[104:107]
    ds_read_b64_tr_b16 a[170:171], v11 offset:45056
    v_add_f32 v18, v18, v49
    v_cvt_pk_bf16_f32 v76, v48, v49
    v_mfma_f32_16x16x32_bf16 a[108:111], a[184:187], v[84:87], a[108:111]
    v_exp_f32 v50, v50
    v_mfma_f32_16x16x32_bf16 a[120:123], a[188:191], v[80:83], a[120:123]
    ds_read_b64_tr_b16 a[172:173], v12 offset:40960
    v_add_f32 v18, v18, v50
    v_mfma_f32_16x16x32_bf16 a[124:127], a[188:191], v[84:87], a[124:127]
    v_exp_f32 v51, v51
    v_mfma_f32_16x16x32_bf16 v[56:59], a[128:131], v[144:147], v[32:35]
    ds_read_b64_tr_b16 a[174:175], v12 offset:45056
    v_add_f32 v18, v18, v51
    v_cvt_pk_bf16_f32 v77, v50, v51
    v_mfma_f32_16x16x32_bf16 v[56:59], a[132:135], v[148:151], v[56:59]
    v_exp_f32 v52, v52
    v_mfma_f32_16x16x32_bf16 v[56:59], a[136:139], v[152:155], v[56:59]
    ds_read_b64_tr_b16 a[176:177], v13 offset:40960
    v_add_f32 v18, v18, v52
    v_mfma_f32_16x16x32_bf16 v[56:59], a[140:143], v[156:159], v[56:59]
    v_exp_f32 v53, v53
    v_mfma_f32_16x16x32_bf16 v[60:63], a[144:147], v[144:147], v[32:35]
    ds_read_b64_tr_b16 a[178:179], v13 offset:45056
    v_add_f32 v18, v18, v53
    v_cvt_pk_bf16_f32 v78, v52, v53
    v_mfma_f32_16x16x32_bf16 v[60:63], a[148:151], v[148:151], v[60:63]
    v_exp_f32 v54, v54
    v_mfma_f32_16x16x32_bf16 v[60:63], a[152:155], v[152:155], v[60:63]
    ds_read_b64_tr_b16 a[180:181], v14 offset:40960
    v_add_f32 v18, v18, v54
    v_mfma_f32_16x16x32_bf16 v[60:63], a[156:159], v[156:159], v[60:63]
    v_exp_f32 v55, v55
    v_mfma_f32_16x16x32_bf16 v[64:67], a[128:131], v[160:163], v[36:39]
    ds_read_b64_tr_b16 a[182:183], v14 offset:45056
    v_add_f32 v18, v18, v55
    v_cvt_pk_bf16_f32 v79, v54, v55
    v_mfma_f32_16x16x32_bf16 v[64:67], a[132:135], v[164:167], v[64:67]
    v_exp_f32 v56, v56
    v_mfma_f32_16x16x32_bf16 v[64:67], a[136:139], v[168:171], v[64:67]
    ds_read_b64_tr_b16 a[184:185], v15 offset:40960
    v_add_f32 v19, v19, v56
    v_mfma_f32_16x16x32_bf16 v[64:67], a[140:143], v[172:175], v[64:67]
    v_exp_f32 v57, v57
    v_mfma_f32_16x16x32_bf16 v[68:71], a[144:147], v[160:163], v[36:39]
    ds_read_b64_tr_b16 a[186:187], v15 offset:45056
    v_add_f32 v19, v19, v57
    v_cvt_pk_bf16_f32 v80, v56, v57
    v_mfma_f32_16x16x32_bf16 v[68:71], a[148:151], v[164:167], v[68:71]
    v_exp_f32 v58, v58
    v_mfma_f32_16x16x32_bf16 v[68:71], a[152:155], v[168:171], v[68:71]
    ds_read_b64_tr_b16 a[188:189], v16 offset:40960
    v_add_f32 v19, v19, v58
    v_mfma_f32_16x16x32_bf16 v[68:71], a[156:159], v[172:175], v[68:71]
    s_waitcnt lgkmcnt(7)
    v_exp_f32 v59, v59
    v_mfma_f32_16x16x32_bf16 a[0:3], a[160:163], v[72:75], a[0:3]
    ds_read_b64_tr_b16 a[190:191], v16 offset:45056
    v_add_f32 v19, v19, v59
    v_cvt_pk_bf16_f32 v81, v58, v59
    v_mfma_f32_16x16x32_bf16 a[4:7], a[160:163], v[76:79], a[4:7]
    ds_read_b128 a[128:131], v5 offset:49152
    v_exp_f32 v60, v60
    v_mfma_f32_16x16x32_bf16 a[16:19], a[164:167], v[72:75], a[16:19]
    ds_read_b128 a[132:135], v6 offset:49152
    v_add_f32 v19, v19, v60
    v_mfma_f32_16x16x32_bf16 a[20:23], a[164:167], v[76:79], a[20:23]
    v_exp_f32 v61, v61
    v_mfma_f32_16x16x32_bf16 a[32:35], a[168:171], v[72:75], a[32:35]
    ds_read_b128 a[136:139], v7 offset:49152
    v_add_f32 v19, v19, v61
    v_cvt_pk_bf16_f32 v82, v60, v61
    v_mfma_f32_16x16x32_bf16 a[36:39], a[168:171], v[76:79], a[36:39]
    v_exp_f32 v62, v62
    v_mfma_f32_16x16x32_bf16 a[48:51], a[172:175], v[72:75], a[48:51]
    ds_read_b128 a[140:143], v8 offset:49152
    v_add_f32 v19, v19, v62
    v_mfma_f32_16x16x32_bf16 a[52:55], a[172:175], v[76:79], a[52:55]
    s_waitcnt lgkmcnt(4)
    v_exp_f32 v63, v63
    v_mfma_f32_16x16x32_bf16 a[64:67], a[176:179], v[72:75], a[64:67]
    ds_read_b128 a[144:147], v5 offset:53248
    v_add_f32 v19, v19, v63
    v_cvt_pk_bf16_f32 v83, v62, v63
    v_mfma_f32_16x16x32_bf16 a[68:71], a[176:179], v[76:79], a[68:71]
    v_exp_f32 v64, v64
    v_mfma_f32_16x16x32_bf16 a[80:83], a[180:183], v[72:75], a[80:83]
    ds_read_b128 a[148:151], v6 offset:53248
    v_add_f32 v20, v20, v64
    v_mfma_f32_16x16x32_bf16 a[84:87], a[180:183], v[76:79], a[84:87]
    v_exp_f32 v65, v65
    v_mfma_f32_16x16x32_bf16 a[96:99], a[184:187], v[72:75], a[96:99]
    ds_read_b128 a[152:155], v7 offset:53248
    v_add_f32 v20, v20, v65
    v_cvt_pk_bf16_f32 v84, v64, v65
    v_mfma_f32_16x16x32_bf16 a[100:103], a[184:187], v[76:79], a[100:103]
    v_exp_f32 v66, v66
    v_mfma_f32_16x16x32_bf16 a[112:115], a[188:191], v[72:75], a[112:115]
    ds_read_b128 a[156:159], v8 offset:53248
    v_add_f32 v20, v20, v66
    v_mfma_f32_16x16x32_bf16 a[116:119], a[188:191], v[76:79], a[116:119]
    s_waitcnt vmcnt(20) lgkmcnt(4)
    v_exp_f32 v67, v67
    v_mfma_f32_16x16x32_bf16 v[40:43], a[128:131], v[112:115], v[24:27]
    s_barrier
    v_add_f32 v20, v20, v67
    v_cvt_pk_bf16_f32 v85, v66, v67
    v_mfma_f32_16x16x32_bf16 v[40:43], a[132:135], v[116:119], v[40:43]
    v_exp_f32 v68, v68
    v_mfma_f32_16x16x32_bf16 v[40:43], a[136:139], v[120:123], v[40:43]
    buffer_load_dwordx4 a[212:215], v197, s[20:23], s33 offen offset:1024 sc1
    v_add_f32 v20, v20, v68
    v_mfma_f32_16x16x32_bf16 v[40:43], a[140:143], v[124:127], v[40:43]
    s_waitcnt lgkmcnt(0)
    v_exp_f32 v69, v69
    v_mfma_f32_16x16x32_bf16 v[44:47], a[144:147], v[112:115], v[24:27]
    v_add_f32 v20, v20, v69
    v_cvt_pk_bf16_f32 v86, v68, v69
    v_mfma_f32_16x16x32_bf16 v[44:47], a[148:151], v[116:119], v[44:47]
    v_exp_f32 v70, v70
    v_mfma_f32_16x16x32_bf16 v[44:47], a[152:155], v[120:123], v[44:47]
    buffer_load_dwordx4 a[216:219], v198, s[20:23], s33 offen offset:0 sc1
    v_add_f32 v20, v20, v70
    v_mfma_f32_16x16x32_bf16 v[44:47], a[156:159], v[124:127], v[44:47]
    v_exp_f32 v71, v71
    v_mfma_f32_16x16x32_bf16 v[48:51], a[128:131], v[128:131], v[28:31]
    v_add_f32 v20, v20, v71
    v_cvt_pk_bf16_f32 v87, v70, v71
    v_mfma_f32_16x16x32_bf16 v[48:51], a[132:135], v[132:135], v[48:51]
    v_exp_f32 v40, v40
    v_mfma_f32_16x16x32_bf16 v[48:51], a[136:139], v[136:139], v[48:51]
    buffer_load_dwordx4 a[220:223], v198, s[20:23], s33 offen offset:1024 sc1
    v_add_f32 v17, v17, v40
    v_mfma_f32_16x16x32_bf16 v[48:51], a[140:143], v[140:143], v[48:51]
    s_add_u32 s33, s33, 0x40000
    v_exp_f32 v41, v41
    v_mfma_f32_16x16x32_bf16 v[52:55], a[144:147], v[128:131], v[28:31]
    v_add_f32 v17, v17, v41
    v_cvt_pk_bf16_f32 v72, v40, v41
    v_mfma_f32_16x16x32_bf16 v[52:55], a[148:151], v[132:135], v[52:55]
    v_exp_f32 v42, v42
    v_mfma_f32_16x16x32_bf16 v[52:55], a[152:155], v[136:139], v[52:55]
    buffer_load_dwordx4 a[224:227], v197, s[20:23], s33 offen offset:0 sc1
    v_add_f32 v17, v17, v42
    v_mfma_f32_16x16x32_bf16 v[52:55], a[156:159], v[140:143], v[52:55]
    v_exp_f32 v43, v43
    v_mfma_f32_16x16x32_bf16 a[8:11], a[160:163], v[80:83], a[8:11]
    v_add_f32 v17, v17, v43
    v_cvt_pk_bf16_f32 v73, v42, v43
    v_mfma_f32_16x16x32_bf16 a[12:15], a[160:163], v[84:87], a[12:15]
    v_exp_f32 v44, v44
    v_mfma_f32_16x16x32_bf16 a[24:27], a[164:167], v[80:83], a[24:27]
    ds_read_b64_tr_b16 a[160:161], v9 offset:49152
    v_add_f32 v17, v17, v44
    v_mfma_f32_16x16x32_bf16 a[28:31], a[164:167], v[84:87], a[28:31]
    v_exp_f32 v45, v45
    v_mfma_f32_16x16x32_bf16 a[40:43], a[168:171], v[80:83], a[40:43]
    ds_read_b64_tr_b16 a[162:163], v9 offset:53248
    v_add_f32 v17, v17, v45
    v_cvt_pk_bf16_f32 v74, v44, v45
    v_mfma_f32_16x16x32_bf16 a[44:47], a[168:171], v[84:87], a[44:47]
    v_exp_f32 v46, v46
    v_mfma_f32_16x16x32_bf16 a[56:59], a[172:175], v[80:83], a[56:59]
    ds_read_b64_tr_b16 a[164:165], v10 offset:49152
    v_add_f32 v17, v17, v46
    v_mfma_f32_16x16x32_bf16 a[60:63], a[172:175], v[84:87], a[60:63]
    v_exp_f32 v47, v47
    v_mfma_f32_16x16x32_bf16 a[72:75], a[176:179], v[80:83], a[72:75]
    ds_read_b64_tr_b16 a[166:167], v10 offset:53248
    v_add_f32 v17, v17, v47
    v_cvt_pk_bf16_f32 v75, v46, v47
    v_mfma_f32_16x16x32_bf16 a[76:79], a[176:179], v[84:87], a[76:79]
    v_exp_f32 v48, v48
    v_mfma_f32_16x16x32_bf16 a[88:91], a[180:183], v[80:83], a[88:91]
    ds_read_b64_tr_b16 a[168:169], v11 offset:49152
    v_add_f32 v18, v18, v48
    v_mfma_f32_16x16x32_bf16 a[92:95], a[180:183], v[84:87], a[92:95]
    v_exp_f32 v49, v49
    v_mfma_f32_16x16x32_bf16 a[104:107], a[184:187], v[80:83], a[104:107]
    ds_read_b64_tr_b16 a[170:171], v11 offset:53248
    v_add_f32 v18, v18, v49
    v_cvt_pk_bf16_f32 v76, v48, v49
    v_mfma_f32_16x16x32_bf16 a[108:111], a[184:187], v[84:87], a[108:111]
    v_exp_f32 v50, v50
    v_mfma_f32_16x16x32_bf16 a[120:123], a[188:191], v[80:83], a[120:123]
    ds_read_b64_tr_b16 a[172:173], v12 offset:49152
    v_add_f32 v18, v18, v50
    v_mfma_f32_16x16x32_bf16 a[124:127], a[188:191], v[84:87], a[124:127]
    v_exp_f32 v51, v51
    v_mfma_f32_16x16x32_bf16 v[56:59], a[128:131], v[144:147], v[32:35]
    ds_read_b64_tr_b16 a[174:175], v12 offset:53248
    v_add_f32 v18, v18, v51
    v_cvt_pk_bf16_f32 v77, v50, v51
    v_mfma_f32_16x16x32_bf16 v[56:59], a[132:135], v[148:151], v[56:59]
    v_exp_f32 v52, v52
    v_mfma_f32_16x16x32_bf16 v[56:59], a[136:139], v[152:155], v[56:59]
    ds_read_b64_tr_b16 a[176:177], v13 offset:49152
    v_add_f32 v18, v18, v52
    v_mfma_f32_16x16x32_bf16 v[56:59], a[140:143], v[156:159], v[56:59]
    v_exp_f32 v53, v53
    v_mfma_f32_16x16x32_bf16 v[60:63], a[144:147], v[144:147], v[32:35]
    ds_read_b64_tr_b16 a[178:179], v13 offset:53248
    v_add_f32 v18, v18, v53
    v_cvt_pk_bf16_f32 v78, v52, v53
    v_mfma_f32_16x16x32_bf16 v[60:63], a[148:151], v[148:151], v[60:63]
    v_exp_f32 v54, v54
    v_mfma_f32_16x16x32_bf16 v[60:63], a[152:155], v[152:155], v[60:63]
    ds_read_b64_tr_b16 a[180:181], v14 offset:49152
    v_add_f32 v18, v18, v54
    v_mfma_f32_16x16x32_bf16 v[60:63], a[156:159], v[156:159], v[60:63]
    v_exp_f32 v55, v55
    v_mfma_f32_16x16x32_bf16 v[64:67], a[128:131], v[160:163], v[36:39]
    ds_read_b64_tr_b16 a[182:183], v14 offset:53248
    v_add_f32 v18, v18, v55
    v_cvt_pk_bf16_f32 v79, v54, v55
    v_mfma_f32_16x16x32_bf16 v[64:67], a[132:135], v[164:167], v[64:67]
    v_exp_f32 v56, v56
    v_mfma_f32_16x16x32_bf16 v[64:67], a[136:139], v[168:171], v[64:67]
    ds_read_b64_tr_b16 a[184:185], v15 offset:49152
    v_add_f32 v19, v19, v56
    v_mfma_f32_16x16x32_bf16 v[64:67], a[140:143], v[172:175], v[64:67]
    v_exp_f32 v57, v57
    v_mfma_f32_16x16x32_bf16 v[68:71], a[144:147], v[160:163], v[36:39]
    ds_read_b64_tr_b16 a[186:187], v15 offset:53248
    v_add_f32 v19, v19, v57
    v_cvt_pk_bf16_f32 v80, v56, v57
    v_mfma_f32_16x16x32_bf16 v[68:71], a[148:151], v[164:167], v[68:71]
    v_exp_f32 v58, v58
    v_mfma_f32_16x16x32_bf16 v[68:71], a[152:155], v[168:171], v[68:71]
    ds_read_b64_tr_b16 a[188:189], v16 offset:49152
    v_add_f32 v19, v19, v58
    v_mfma_f32_16x16x32_bf16 v[68:71], a[156:159], v[172:175], v[68:71]
    s_waitcnt lgkmcnt(7)
    v_exp_f32 v59, v59
    v_mfma_f32_16x16x32_bf16 a[0:3], a[160:163], v[72:75], a[0:3]
    ds_read_b64_tr_b16 a[190:191], v16 offset:53248
    v_add_f32 v19, v19, v59
    v_cvt_pk_bf16_f32 v81, v58, v59
    v_mfma_f32_16x16x32_bf16 a[4:7], a[160:163], v[76:79], a[4:7]
    ds_read_b128 a[128:131], v5 offset:57344
    v_exp_f32 v60, v60
    v_mfma_f32_16x16x32_bf16 a[16:19], a[164:167], v[72:75], a[16:19]
    ds_read_b128 a[132:135], v6 offset:57344
    v_add_f32 v19, v19, v60
    v_mfma_f32_16x16x32_bf16 a[20:23], a[164:167], v[76:79], a[20:23]
    v_exp_f32 v61, v61
    v_mfma_f32_16x16x32_bf16 a[32:35], a[168:171], v[72:75], a[32:35]
    ds_read_b128 a[136:139], v7 offset:57344
    v_add_f32 v19, v19, v61
    v_cvt_pk_bf16_f32 v82, v60, v61
    v_mfma_f32_16x16x32_bf16 a[36:39], a[168:171], v[76:79], a[36:39]
    v_exp_f32 v62, v62
    v_mfma_f32_16x16x32_bf16 a[48:51], a[172:175], v[72:75], a[48:51]
    ds_read_b128 a[140:143], v8 offset:57344
    v_add_f32 v19, v19, v62
    v_mfma_f32_16x16x32_bf16 a[52:55], a[172:175], v[76:79], a[52:55]
    s_waitcnt lgkmcnt(4)
    v_exp_f32 v63, v63
    v_mfma_f32_16x16x32_bf16 a[64:67], a[176:179], v[72:75], a[64:67]
    ds_read_b128 a[144:147], v5 offset:61440
    v_add_f32 v19, v19, v63
    v_cvt_pk_bf16_f32 v83, v62, v63
    v_mfma_f32_16x16x32_bf16 a[68:71], a[176:179], v[76:79], a[68:71]
    v_exp_f32 v64, v64
    v_mfma_f32_16x16x32_bf16 a[80:83], a[180:183], v[72:75], a[80:83]
    ds_read_b128 a[148:151], v6 offset:61440
    v_add_f32 v20, v20, v64
    v_mfma_f32_16x16x32_bf16 a[84:87], a[180:183], v[76:79], a[84:87]
    v_exp_f32 v65, v65
    v_mfma_f32_16x16x32_bf16 a[96:99], a[184:187], v[72:75], a[96:99]
    ds_read_b128 a[152:155], v7 offset:61440
    v_add_f32 v20, v20, v65
    v_cvt_pk_bf16_f32 v84, v64, v65
    v_mfma_f32_16x16x32_bf16 a[100:103], a[184:187], v[76:79], a[100:103]
    v_exp_f32 v66, v66
    v_mfma_f32_16x16x32_bf16 a[112:115], a[188:191], v[72:75], a[112:115]
    ds_read_b128 a[156:159], v8 offset:61440
    v_add_f32 v20, v20, v66
    v_mfma_f32_16x16x32_bf16 a[116:119], a[188:191], v[76:79], a[116:119]
    s_waitcnt vmcnt(20) lgkmcnt(4)
    v_exp_f32 v67, v67
    v_mfma_f32_16x16x32_bf16 v[40:43], a[128:131], v[112:115], v[24:27]
    s_barrier
    v_add_f32 v20, v20, v67
    v_cvt_pk_bf16_f32 v85, v66, v67
    v_mfma_f32_16x16x32_bf16 v[40:43], a[132:135], v[116:119], v[40:43]
    v_exp_f32 v68, v68
    v_mfma_f32_16x16x32_bf16 v[40:43], a[136:139], v[120:123], v[40:43]
    buffer_load_dwordx4 a[228:231], v197, s[20:23], s33 offen offset:1024 sc1
    v_add_f32 v20, v20, v68
    v_mfma_f32_16x16x32_bf16 v[40:43], a[140:143], v[124:127], v[40:43]
    s_waitcnt lgkmcnt(0)
    v_exp_f32 v69, v69
    v_mfma_f32_16x16x32_bf16 v[44:47], a[144:147], v[112:115], v[24:27]
    v_add_f32 v20, v20, v69
    v_cvt_pk_bf16_f32 v86, v68, v69
    v_mfma_f32_16x16x32_bf16 v[44:47], a[148:151], v[116:119], v[44:47]
    v_exp_f32 v70, v70
    v_mfma_f32_16x16x32_bf16 v[44:47], a[152:155], v[120:123], v[44:47]
    buffer_load_dwordx4 a[232:235], v198, s[20:23], s33 offen offset:0 sc1
    v_add_f32 v20, v20, v70
    v_mfma_f32_16x16x32_bf16 v[44:47], a[156:159], v[124:127], v[44:47]
    v_exp_f32 v71, v71
    v_mfma_f32_16x16x32_bf16 v[48:51], a[128:131], v[128:131], v[28:31]
    v_add_f32 v20, v20, v71
    v_cvt_pk_bf16_f32 v87, v70, v71
    v_mfma_f32_16x16x32_bf16 v[48:51], a[132:135], v[132:135], v[48:51]
    v_exp_f32 v40, v40
    v_mfma_f32_16x16x32_bf16 v[48:51], a[136:139], v[136:139], v[48:51]
    buffer_load_dwordx4 a[236:239], v198, s[20:23], s33 offen offset:1024 sc1
    v_add_f32 v17, v17, v40
    v_mfma_f32_16x16x32_bf16 v[48:51], a[140:143], v[140:143], v[48:51]
    s_add_u32 s33, s33, 0x40000
    v_exp_f32 v41, v41
    v_mfma_f32_16x16x32_bf16 v[52:55], a[144:147], v[128:131], v[28:31]
    v_add_f32 v17, v17, v41
    v_cvt_pk_bf16_f32 v72, v40, v41
    v_mfma_f32_16x16x32_bf16 v[52:55], a[148:151], v[132:135], v[52:55]
    v_exp_f32 v42, v42
    v_mfma_f32_16x16x32_bf16 v[52:55], a[152:155], v[136:139], v[52:55]
    buffer_load_dword v92, v215, s[20:23], 0 offen sc1
    v_add_f32 v17, v17, v42
    v_mfma_f32_16x16x32_bf16 v[52:55], a[156:159], v[140:143], v[52:55]
    v_exp_f32 v43, v43
    v_mfma_f32_16x16x32_bf16 a[8:11], a[160:163], v[80:83], a[8:11]
    v_add_f32 v17, v17, v43
    v_cvt_pk_bf16_f32 v73, v42, v43
    v_mfma_f32_16x16x32_bf16 a[12:15], a[160:163], v[84:87], a[12:15]
    v_exp_f32 v44, v44
    v_mfma_f32_16x16x32_bf16 a[24:27], a[164:167], v[80:83], a[24:27]
    ds_read_b64_tr_b16 a[160:161], v9 offset:57344
    v_add_f32 v17, v17, v44
    v_mfma_f32_16x16x32_bf16 a[28:31], a[164:167], v[84:87], a[28:31]
    v_exp_f32 v45, v45
    v_mfma_f32_16x16x32_bf16 a[40:43], a[168:171], v[80:83], a[40:43]
    ds_read_b64_tr_b16 a[162:163], v9 offset:61440
    v_add_f32 v17, v17, v45
    v_cvt_pk_bf16_f32 v74, v44, v45
    v_mfma_f32_16x16x32_bf16 a[44:47], a[168:171], v[84:87], a[44:47]
    v_exp_f32 v46, v46
    v_mfma_f32_16x16x32_bf16 a[56:59], a[172:175], v[80:83], a[56:59]
    ds_read_b64_tr_b16 a[164:165], v10 offset:57344
    v_add_f32 v17, v17, v46
    v_mfma_f32_16x16x32_bf16 a[60:63], a[172:175], v[84:87], a[60:63]
    v_exp_f32 v47, v47
    v_mfma_f32_16x16x32_bf16 a[72:75], a[176:179], v[80:83], a[72:75]
    ds_read_b64_tr_b16 a[166:167], v10 offset:61440
    v_add_f32 v17, v17, v47
    v_cvt_pk_bf16_f32 v75, v46, v47
    v_mfma_f32_16x16x32_bf16 a[76:79], a[176:179], v[84:87], a[76:79]
    v_exp_f32 v48, v48
    v_mfma_f32_16x16x32_bf16 a[88:91], a[180:183], v[80:83], a[88:91]
    ds_read_b64_tr_b16 a[168:169], v11 offset:57344
    v_add_f32 v18, v18, v48
    v_mfma_f32_16x16x32_bf16 a[92:95], a[180:183], v[84:87], a[92:95]
    v_exp_f32 v49, v49
    v_mfma_f32_16x16x32_bf16 a[104:107], a[184:187], v[80:83], a[104:107]
    ds_read_b64_tr_b16 a[170:171], v11 offset:61440
    v_add_f32 v18, v18, v49
    v_cvt_pk_bf16_f32 v76, v48, v49
    v_mfma_f32_16x16x32_bf16 a[108:111], a[184:187], v[84:87], a[108:111]
    v_exp_f32 v50, v50
    v_mfma_f32_16x16x32_bf16 a[120:123], a[188:191], v[80:83], a[120:123]
    ds_read_b64_tr_b16 a[172:173], v12 offset:57344
    v_add_f32 v18, v18, v50
    v_mfma_f32_16x16x32_bf16 a[124:127], a[188:191], v[84:87], a[124:127]
    v_exp_f32 v51, v51
    v_mfma_f32_16x16x32_bf16 v[56:59], a[128:131], v[144:147], v[32:35]
    ds_read_b64_tr_b16 a[174:175], v12 offset:61440
    v_add_f32 v18, v18, v51
    v_cvt_pk_bf16_f32 v77, v50, v51
    v_mfma_f32_16x16x32_bf16 v[56:59], a[132:135], v[148:151], v[56:59]
    v_exp_f32 v52, v52
    v_mfma_f32_16x16x32_bf16 v[56:59], a[136:139], v[152:155], v[56:59]
    ds_read_b64_tr_b16 a[176:177], v13 offset:57344
    v_add_f32 v18, v18, v52
    v_mfma_f32_16x16x32_bf16 v[56:59], a[140:143], v[156:159], v[56:59]
    v_exp_f32 v53, v53
    v_mfma_f32_16x16x32_bf16 v[60:63], a[144:147], v[144:147], v[32:35]
    ds_read_b64_tr_b16 a[178:179], v13 offset:61440
    v_add_f32 v18, v18, v53
    v_cvt_pk_bf16_f32 v78, v52, v53
    v_mfma_f32_16x16x32_bf16 v[60:63], a[148:151], v[148:151], v[60:63]
    v_exp_f32 v54, v54
    v_mfma_f32_16x16x32_bf16 v[60:63], a[152:155], v[152:155], v[60:63]
    ds_read_b64_tr_b16 a[180:181], v14 offset:57344
    v_add_f32 v18, v18, v54
    v_mfma_f32_16x16x32_bf16 v[60:63], a[156:159], v[156:159], v[60:63]
    v_exp_f32 v55, v55
    v_mfma_f32_16x16x32_bf16 v[64:67], a[128:131], v[160:163], v[36:39]
    ds_read_b64_tr_b16 a[182:183], v14 offset:61440
    v_add_f32 v18, v18, v55
    v_cvt_pk_bf16_f32 v79, v54, v55
    v_mfma_f32_16x16x32_bf16 v[64:67], a[132:135], v[164:167], v[64:67]
    v_exp_f32 v56, v56
    v_mfma_f32_16x16x32_bf16 v[64:67], a[136:139], v[168:171], v[64:67]
    ds_read_b64_tr_b16 a[184:185], v15 offset:57344
    v_add_f32 v19, v19, v56
    v_mfma_f32_16x16x32_bf16 v[64:67], a[140:143], v[172:175], v[64:67]
    v_exp_f32 v57, v57
    v_mfma_f32_16x16x32_bf16 v[68:71], a[144:147], v[160:163], v[36:39]
    ds_read_b64_tr_b16 a[186:187], v15 offset:61440
    v_add_f32 v19, v19, v57
    v_cvt_pk_bf16_f32 v80, v56, v57
    v_mfma_f32_16x16x32_bf16 v[68:71], a[148:151], v[164:167], v[68:71]
    v_exp_f32 v58, v58
    v_mfma_f32_16x16x32_bf16 v[68:71], a[152:155], v[168:171], v[68:71]
    ds_read_b64_tr_b16 a[188:189], v16 offset:57344
    v_add_f32 v19, v19, v58
    v_mfma_f32_16x16x32_bf16 v[68:71], a[156:159], v[172:175], v[68:71]
    s_waitcnt lgkmcnt(7)
    v_exp_f32 v59, v59
    v_mfma_f32_16x16x32_bf16 a[0:3], a[160:163], v[72:75], a[0:3]
    ds_read_b64_tr_b16 a[190:191], v16 offset:61440
    v_add_f32 v19, v19, v59
    v_cvt_pk_bf16_f32 v81, v58, v59
    v_mfma_f32_16x16x32_bf16 a[4:7], a[160:163], v[76:79], a[4:7]
    ds_read_b128 a[128:131], v5 offset:0
    v_exp_f32 v60, v60
    v_mfma_f32_16x16x32_bf16 a[16:19], a[164:167], v[72:75], a[16:19]
    ds_read_b128 a[132:135], v6 offset:0
    v_add_f32 v19, v19, v60
    v_mfma_f32_16x16x32_bf16 a[20:23], a[164:167], v[76:79], a[20:23]
    v_exp_f32 v61, v61
    v_mfma_f32_16x16x32_bf16 a[32:35], a[168:171], v[72:75], a[32:35]
    ds_read_b128 a[136:139], v7 offset:0
    v_add_f32 v19, v19, v61
    v_cvt_pk_bf16_f32 v82, v60, v61
    v_mfma_f32_16x16x32_bf16 a[36:39], a[168:171], v[76:79], a[36:39]
    v_exp_f32 v62, v62
    v_mfma_f32_16x16x32_bf16 a[48:51], a[172:175], v[72:75], a[48:51]
    ds_read_b128 a[140:143], v8 offset:0
    v_add_f32 v19, v19, v62
    v_mfma_f32_16x16x32_bf16 a[52:55], a[172:175], v[76:79], a[52:55]
    s_waitcnt lgkmcnt(4)
    v_exp_f32 v63, v63
    v_mfma_f32_16x16x32_bf16 a[64:67], a[176:179], v[72:75], a[64:67]
    ds_read_b128 a[144:147], v5 offset:4096
    v_add_f32 v19, v19, v63
    v_cvt_pk_bf16_f32 v83, v62, v63
    v_mfma_f32_16x16x32_bf16 a[68:71], a[176:179], v[76:79], a[68:71]
    v_exp_f32 v64, v64
    v_mfma_f32_16x16x32_bf16 a[80:83], a[180:183], v[72:75], a[80:83]
    ds_read_b128 a[148:151], v6 offset:4096
    v_add_f32 v20, v20, v64
    v_mfma_f32_16x16x32_bf16 a[84:87], a[180:183], v[76:79], a[84:87]
    v_exp_f32 v65, v65
    v_mfma_f32_16x16x32_bf16 a[96:99], a[184:187], v[72:75], a[96:99]
    ds_read_b128 a[152:155], v7 offset:4096
    v_add_f32 v20, v20, v65
    v_cvt_pk_bf16_f32 v84, v64, v65
    v_mfma_f32_16x16x32_bf16 a[100:103], a[184:187], v[76:79], a[100:103]
    v_exp_f32 v66, v66
    v_mfma_f32_16x16x32_bf16 a[112:115], a[188:191], v[72:75], a[112:115]
    ds_read_b128 a[156:159], v8 offset:4096
    v_add_f32 v20, v20, v66
    v_mfma_f32_16x16x32_bf16 a[116:119], a[188:191], v[76:79], a[116:119]
    s_waitcnt vmcnt(20) lgkmcnt(4)
    v_exp_f32 v67, v67
    s_nop 0
    v_add_f32 v20, v20, v67
    v_cvt_pk_bf16_f32 v85, v66, v67
    v_exp_f32 v68, v68
    v_exp_f32 v69, v69
    v_exp_f32 v70, v70
    v_exp_f32 v71, v71
    v_add_f32 v20, v20, v68
    v_add_f32 v20, v20, v69
    v_add_f32 v20, v20, v70
    v_add_f32 v20, v20, v71
    v_cvt_pk_bf16_f32 v86, v68, v69
    v_cvt_pk_bf16_f32 v87, v70, v71
    s_nop 1
    v_mfma_f32_16x16x32_bf16 a[8:11], a[160:163], v[80:83], a[8:11]
    v_mfma_f32_16x16x32_bf16 a[12:15], a[160:163], v[84:87], a[12:15]
    v_mfma_f32_16x16x32_bf16 a[24:27], a[164:167], v[80:83], a[24:27]
    v_mfma_f32_16x16x32_bf16 a[28:31], a[164:167], v[84:87], a[28:31]
    v_mfma_f32_16x16x32_bf16 a[40:43], a[168:171], v[80:83], a[40:43]
    v_mfma_f32_16x16x32_bf16 a[44:47], a[168:171], v[84:87], a[44:47]
    v_mfma_f32_16x16x32_bf16 a[56:59], a[172:175], v[80:83], a[56:59]
    v_mfma_f32_16x16x32_bf16 a[60:63], a[172:175], v[84:87], a[60:63]
    v_mfma_f32_16x16x32_bf16 a[72:75], a[176:179], v[80:83], a[72:75]
    v_mfma_f32_16x16x32_bf16 a[76:79], a[176:179], v[84:87], a[76:79]
    v_mfma_f32_16x16x32_bf16 a[88:91], a[180:183], v[80:83], a[88:91]
    v_mfma_f32_16x16x32_bf16 a[92:95], a[180:183], v[84:87], a[92:95]
    v_mfma_f32_16x16x32_bf16 a[104:107], a[184:187], v[80:83], a[104:107]
    v_mfma_f32_16x16x32_bf16 a[108:111], a[184:187], v[84:87], a[108:111]
    v_mfma_f32_16x16x32_bf16 a[120:123], a[188:191], v[80:83], a[120:123]
    v_mfma_f32_16x16x32_bf16 a[124:127], a[188:191], v[84:87], a[124:127]
    v_mov_b32 v88, v17
    v_mov_b32 v89, v18
    v_mov_b32 v90, v19
    v_mov_b32 v91, v20
    v_permlane32_swap_b32 v17, v88
    v_permlane32_swap_b32 v18, v89
    v_permlane32_swap_b32 v19, v90
    v_permlane32_swap_b32 v20, v91
    v_add_f32 v17, v17, v88
    v_add_f32 v18, v18, v89
    v_add_f32 v19, v19, v90
    v_add_f32 v20, v20, v91
    v_mov_b32 v88, v17
    v_mov_b32 v89, v18
    v_mov_b32 v90, v19
    v_mov_b32 v91, v20
    v_permlane16_swap_b32 v17, v88
    v_permlane16_swap_b32 v18, v89
    v_permlane16_swap_b32 v19, v90
    v_permlane16_swap_b32 v20, v91
    v_add_f32 v17, v17, v88
    v_add_f32 v18, v18, v89
    v_add_f32 v19, v19, v90
    v_add_f32 v20, v20, v91
    s_mov_b32 s54, 0x5d800000
    v_cmp_nle_f32 s[56:57], v17, s54
    v_cmp_nle_f32 s[58:59], v18, s54
    v_cmp_nle_f32 s[60:61], v19, s54
    v_cmp_nle_f32 s[62:63], v20, s54
    s_nop 1
    s_or_b64 s[56:57], s[56:57], s[58:59]
    s_or_b64 s[60:61], s[60:61], s[62:63]
    s_or_b64 s[56:57], s[56:57], s[60:61]
    s_cmp_lg_u64 s[56:57], 0
    s_cselect_b32 s54, 1, 0
    s_lshl_b32 s55, s41, 2
    v_mov_b32 v88, s54
    v_mov_b32 v89, s55
    v_add_u32 v89, 0x25800, v89
    ds_write_b32 v89, v88
    v_mov_b32 v89, 0x25800
    s_waitcnt vmcnt(0) lgkmcnt(0)
    s_barrier
    ds_read_b128 v[104:107], v89
    s_waitcnt lgkmcnt(0)
    v_or3_b32 v88, v104, v105, v106
    v_or_b32 v88, v88, v107
    s_nop 0
    v_readfirstlane_b32 s54, v88
    s_cmp_lg_u32 s54, 0
    s_cbranch_scc1 K1_fb
K1_norm:
    s_add_u32 s24, s64, 0x1000000
    s_addc_u32 s25, s65, 0
    s_mov_b32 s26, 0x1000000
    s_mov_b32 s27, 0x20000
    s_lshl_b32 s54, s39, 19
    s_lshl_b32 s55, s42, 10
    s_add_u32 s54, s54, s55
    v_and_b32 v21, 63, v0
    v_lshlrev_b32 v21, 4, v21
    v_add_u32 v21, s54, v21
    s_mov_b32 s57, 0x20000
    s_mov_b32 s58, 0x40000
    s_mov_b32 s59, 0x60000
    v_rcp_f32 v24, v17
    v_rcp_f32 v26, v18
    v_rcp_f32 v28, v19
    v_rcp_f32 v30, v20
    s_mov_b32 s4, s68
    s_mov_b32 s5, s69
    s_mov_b32 s6, 0x21c000
    s_mov_b32 s7, 0x20000
    s_add_u32 s8, s64, 0x300000
    s_addc_u32 s9, s65, 0
    s_mov_b32 s10, 0x6c0000
    s_mov_b32 s11, 0x20000
    s_mul_i32 s36, s46, 0x8c000
    s_mul_i32 s37, s46, 0x1c0000
    s_add_u32 s36, s36, 0x3c000
    s_add_u32 s37, s37, 0xc0000
    s_mul_i32 s49, s46, 0x140000
    s_mul_i32 s38, s41, 0x1400
    s_add_u32 s12, s64, 0x2000000
    s_addc_u32 s13, s65, 0
    s_mov_b32 s14, 0x1800000
    s_mov_b32 s15, 0x20000
    s_lshr_b32 s54, s2, 2
    s_lshl_b32 s54, s54, 2
    s_add_u32 s54, s54, s41
    s_mul_i32 s54, s54, 40
    s_add_u32 s54, s54, s46
    s_lshl_b32 s45, s54, 10
    s_add_u32 s45, s45, 0xc00000
    s_lshl_b32 s54, s46, 1
    s_lshl_b32 s50, 0x3030303, s54
    s_mov_b32 s51, 0
    v_accvgpr_read_b32 v40, a0
    v_accvgpr_read_b32 v41, a1
    v_accvgpr_read_b32 v42, a2
    v_accvgpr_read_b32 v43, a3
    v_accvgpr_read_b32 v44, a16
    v_accvgpr_read_b32 v45, a17
    v_accvgpr_read_b32 v46, a18
    v_accvgpr_read_b32 v47, a19
    v_pk_mul_f32 v[40:41], v[40:41], v[24:25] op_sel_hi:[1,0]
    v_pk_mul_f32 v[42:43], v[42:43], v[24:25] op_sel_hi:[1,0]
    v_pk_mul_f32 v[44:45], v[44:45], v[24:25] op_sel_hi:[1,0]
    v_pk_mul_f32 v[46:47], v[46:47], v[24:25] op_sel_hi:[1,0]
    v_cvt_pk_bf16_f32 v72, v40, v41
    v_cvt_pk_bf16_f32 v73, v42, v43
    v_cvt_pk_bf16_f32 v74, v44, v45
    v_cvt_pk_bf16_f32 v75, v46, v47
    buffer_store_dwordx4 v[72:75], v21, s[24:27], 0 offen offset:0 sc1
    v_accvgpr_read_b32 v48, a4
    v_accvgpr_read_b32 v49, a5
    v_accvgpr_read_b32 v50, a6
    v_accvgpr_read_b32 v51, a7
    v_accvgpr_read_b32 v52, a20
    v_accvgpr_read_b32 v53, a21
    v_accvgpr_read_b32 v54, a22
    v_accvgpr_read_b32 v55, a23
    v_pk_mul_f32 v[48:49], v[48:49], v[26:27] op_sel_hi:[1,0]
    v_pk_mul_f32 v[50:51], v[50:51], v[26:27] op_sel_hi:[1,0]
    v_pk_mul_f32 v[52:53], v[52:53], v[26:27] op_sel_hi:[1,0]
    v_pk_mul_f32 v[54:55], v[54:55], v[26:27] op_sel_hi:[1,0]
    v_cvt_pk_bf16_f32 v76, v48, v49
    v_cvt_pk_bf16_f32 v77, v50, v51
    v_cvt_pk_bf16_f32 v78, v52, v53
    v_cvt_pk_bf16_f32 v79, v54, v55
    buffer_store_dwordx4 v[76:79], v21, s[24:27], 0 offen offset:1024 sc1
    v_accvgpr_read_b32 v56, a8
    v_accvgpr_read_b32 v57, a9
    v_accvgpr_read_b32 v58, a10
    v_accvgpr_read_b32 v59, a11
    v_accvgpr_read_b32 v60, a24
    v_accvgpr_read_b32 v61, a25
    v_accvgpr_read_b32 v62, a26
    v_accvgpr_read_b32 v63, a27
    v_pk_mul_f32 v[56:57], v[56:57], v[28:29] op_sel_hi:[1,0]
    v_pk_mul_f32 v[58:59], v[58:59], v[28:29] op_sel_hi:[1,0]
    v_pk_mul_f32 v[60:61], v[60:61], v[28:29] op_sel_hi:[1,0]
    v_pk_mul_f32 v[62:63], v[62:63], v[28:29] op_sel_hi:[1,0]
    v_cvt_pk_bf16_f32 v80, v56, v57
    v_cvt_pk_bf16_f32 v81, v58, v59
    v_cvt_pk_bf16_f32 v82, v60, v61
    v_cvt_pk_bf16_f32 v83, v62, v63
    buffer_store_dwordx4 v[80:83], v21, s[24:27], 0 offen offset:2048 sc1
    v_accvgpr_read_b32 v64, a12
    v_accvgpr_read_b32 v65, a13
    v_accvgpr_read_b32 v66, a14
    v_accvgpr_read_b32 v67, a15
    v_accvgpr_read_b32 v68, a28
    v_accvgpr_read_b32 v69, a29
    v_accvgpr_read_b32 v70, a30
    v_accvgpr_read_b32 v71, a31
    v_pk_mul_f32 v[64:65], v[64:65], v[30:31] op_sel_hi:[1,0]
    v_pk_mul_f32 v[66:67], v[66:67], v[30:31] op_sel_hi:[1,0]
    v_pk_mul_f32 v[68:69], v[68:69], v[30:31] op_sel_hi:[1,0]
    v_pk_mul_f32 v[70:71], v[70:71], v[30:31] op_sel_hi:[1,0]
    v_cvt_pk_bf16_f32 v84, v64, v65
    v_cvt_pk_bf16_f32 v85, v66, v67
    v_cvt_pk_bf16_f32 v86, v68, v69
    v_cvt_pk_bf16_f32 v87, v70, v71
    buffer_store_dwordx4 v[84:87], v21, s[24:27], 0 offen offset:3072 sc1
    v_accvgpr_read_b32 v40, a32
    v_accvgpr_read_b32 v41, a33
    v_accvgpr_read_b32 v42, a34
    v_accvgpr_read_b32 v43, a35
    v_accvgpr_read_b32 v44, a48
    v_accvgpr_read_b32 v45, a49
    v_accvgpr_read_b32 v46, a50
    v_accvgpr_read_b32 v47, a51
    v_pk_mul_f32 v[40:41], v[40:41], v[24:25] op_sel_hi:[1,0]
    v_pk_mul_f32 v[42:43], v[42:43], v[24:25] op_sel_hi:[1,0]
    v_pk_mul_f32 v[44:45], v[44:45], v[24:25] op_sel_hi:[1,0]
    v_pk_mul_f32 v[46:47], v[46:47], v[24:25] op_sel_hi:[1,0]
    v_cvt_pk_bf16_f32 v72, v40, v41
    v_cvt_pk_bf16_f32 v73, v42, v43
    v_cvt_pk_bf16_f32 v74, v44, v45
    v_cvt_pk_bf16_f32 v75, v46, v47
    buffer_store_dwordx4 v[72:75], v21, s[24:27], s57 offen offset:0 sc1
    v_accvgpr_read_b32 v48, a36
    v_accvgpr_read_b32 v49, a37
    v_accvgpr_read_b32 v50, a38
    v_accvgpr_read_b32 v51, a39
    v_accvgpr_read_b32 v52, a52
    v_accvgpr_read_b32 v53, a53
    v_accvgpr_read_b32 v54, a54
    v_accvgpr_read_b32 v55, a55
    v_pk_mul_f32 v[48:49], v[48:49], v[26:27] op_sel_hi:[1,0]
    v_pk_mul_f32 v[50:51], v[50:51], v[26:27] op_sel_hi:[1,0]
    v_pk_mul_f32 v[52:53], v[52:53], v[26:27] op_sel_hi:[1,0]
    v_pk_mul_f32 v[54:55], v[54:55], v[26:27] op_sel_hi:[1,0]
    v_cvt_pk_bf16_f32 v76, v48, v49
    v_cvt_pk_bf16_f32 v77, v50, v51
    v_cvt_pk_bf16_f32 v78, v52, v53
    v_cvt_pk_bf16_f32 v79, v54, v55
    buffer_store_dwordx4 v[76:79], v21, s[24:27], s57 offen offset:1024 sc1
    v_accvgpr_read_b32 v56, a40
    v_accvgpr_read_b32 v57, a41
    v_accvgpr_read_b32 v58, a42
    v_accvgpr_read_b32 v59, a43
    v_accvgpr_read_b32 v60, a56
    v_accvgpr_read_b32 v61, a57
    v_accvgpr_read_b32 v62, a58
    v_accvgpr_read_b32 v63, a59
    v_pk_mul_f32 v[56:57], v[56:57], v[28:29] op_sel_hi:[1,0]
    v_pk_mul_f32 v[58:59], v[58:59], v[28:29] op_sel_hi:[1,0]
    v_pk_mul_f32 v[60:61], v[60:61], v[28:29] op_sel_hi:[1,0]
    v_pk_mul_f32 v[62:63], v[62:63], v[28:29] op_sel_hi:[1,0]
    v_cvt_pk_bf16_f32 v80, v56, v57
    v_cvt_pk_bf16_f32 v81, v58, v59
    v_cvt_pk_bf16_f32 v82, v60, v61
    v_cvt_pk_bf16_f32 v83, v62, v63
    buffer_store_dwordx4 v[80:83], v21, s[24:27], s57 offen offset:2048 sc1
    v_accvgpr_read_b32 v64, a44
    v_accvgpr_read_b32 v65, a45
    v_accvgpr_read_b32 v66, a46
    v_accvgpr_read_b32 v67, a47
    v_accvgpr_read_b32 v68, a60
    v_accvgpr_read_b32 v69, a61
    v_accvgpr_read_b32 v70, a62
    v_accvgpr_read_b32 v71, a63
    v_pk_mul_f32 v[64:65], v[64:65], v[30:31] op_sel_hi:[1,0]
    v_pk_mul_f32 v[66:67], v[66:67], v[30:31] op_sel_hi:[1,0]
    v_pk_mul_f32 v[68:69], v[68:69], v[30:31] op_sel_hi:[1,0]
    v_pk_mul_f32 v[70:71], v[70:71], v[30:31] op_sel_hi:[1,0]
    v_cvt_pk_bf16_f32 v84, v64, v65
    v_cvt_pk_bf16_f32 v85, v66, v67
    v_cvt_pk_bf16_f32 v86, v68, v69
    v_cvt_pk_bf16_f32 v87, v70, v71
    buffer_store_dwordx4 v[84:87], v21, s[24:27], s57 offen offset:3072 sc1
    v_accvgpr_read_b32 v40, a64
    v_accvgpr_read_b32 v41, a65
    v_accvgpr_read_b32 v42, a66
    v_accvgpr_read_b32 v43, a67
    v_accvgpr_read_b32 v44, a80
    v_accvgpr_read_b32 v45, a81
    v_accvgpr_read_b32 v46, a82
    v_accvgpr_read_b32 v47, a83
    v_pk_mul_f32 v[40:41], v[40:41], v[24:25] op_sel_hi:[1,0]
    v_pk_mul_f32 v[42:43], v[42:43], v[24:25] op_sel_hi:[1,0]
    v_pk_mul_f32 v[44:45], v[44:45], v[24:25] op_sel_hi:[1,0]
    v_pk_mul_f32 v[46:47], v[46:47], v[24:25] op_sel_hi:[1,0]
    v_cvt_pk_bf16_f32 v72, v40, v41
    v_cvt_pk_bf16_f32 v73, v42, v43
    v_cvt_pk_bf16_f32 v74, v44, v45
    v_cvt_pk_bf16_f32 v75, v46, v47
    buffer_store_dwordx4 v[72:75], v21, s[24:27], s58 offen offset:0 sc1
    v_accvgpr_read_b32 v48, a68
    v_accvgpr_read_b32 v49, a69
    v_accvgpr_read_b32 v50, a70
    v_accvgpr_read_b32 v51, a71
    v_accvgpr_read_b32 v52, a84
    v_accvgpr_read_b32 v53, a85
    v_accvgpr_read_b32 v54, a86
    v_accvgpr_read_b32 v55, a87
    v_pk_mul_f32 v[48:49], v[48:49], v[26:27] op_sel_hi:[1,0]
    v_pk_mul_f32 v[50:51], v[50:51], v[26:27] op_sel_hi:[1,0]
    v_pk_mul_f32 v[52:53], v[52:53], v[26:27] op_sel_hi:[1,0]
    v_pk_mul_f32 v[54:55], v[54:55], v[26:27] op_sel_hi:[1,0]
    v_cvt_pk_bf16_f32 v76, v48, v49
    v_cvt_pk_bf16_f32 v77, v50, v51
    v_cvt_pk_bf16_f32 v78, v52, v53
    v_cvt_pk_bf16_f32 v79, v54, v55
    buffer_store_dwordx4 v[76:79], v21, s[24:27], s58 offen offset:1024 sc1
    v_accvgpr_read_b32 v56, a72
    v_accvgpr_read_b32 v57, a73
    v_accvgpr_read_b32 v58, a74
    v_accvgpr_read_b32 v59, a75
    v_accvgpr_read_b32 v60, a88
    v_accvgpr_read_b32 v61, a89
    v_accvgpr_read_b32 v62, a90
    v_accvgpr_read_b32 v63, a91
    v_pk_mul_f32 v[56:57], v[56:57], v[28:29] op_sel_hi:[1,0]
    v_pk_mul_f32 v[58:59], v[58:59], v[28:29] op_sel_hi:[1,0]
    v_pk_mul_f32 v[60:61], v[60:61], v[28:29] op_sel_hi:[1,0]
    v_pk_mul_f32 v[62:63], v[62:63], v[28:29] op_sel_hi:[1,0]
    v_cvt_pk_bf16_f32 v80, v56, v57
    v_cvt_pk_bf16_f32 v81, v58, v59
    v_cvt_pk_bf16_f32 v82, v60, v61
    v_cvt_pk_bf16_f32 v83, v62, v63
    buffer_store_dwordx4 v[80:83], v21, s[24:27], s58 offen offset:2048 sc1
    v_accvgpr_read_b32 v64, a76
    v_accvgpr_read_b32 v65, a77
    v_accvgpr_read_b32 v66, a78
    v_accvgpr_read_b32 v67, a79
    v_accvgpr_read_b32 v68, a92
    v_accvgpr_read_b32 v69, a93
    v_accvgpr_read_b32 v70, a94
    v_accvgpr_read_b32 v71, a95
    v_pk_mul_f32 v[64:65], v[64:65], v[30:31] op_sel_hi:[1,0]
    v_pk_mul_f32 v[66:67], v[66:67], v[30:31] op_sel_hi:[1,0]
    v_pk_mul_f32 v[68:69], v[68:69], v[30:31] op_sel_hi:[1,0]
    v_pk_mul_f32 v[70:71], v[70:71], v[30:31] op_sel_hi:[1,0]
    v_cvt_pk_bf16_f32 v84, v64, v65
    v_cvt_pk_bf16_f32 v85, v66, v67
    v_cvt_pk_bf16_f32 v86, v68, v69
    v_cvt_pk_bf16_f32 v87, v70, v71
    buffer_store_dwordx4 v[84:87], v21, s[24:27], s58 offen offset:3072 sc1
    v_accvgpr_read_b32 v40, a96
    v_accvgpr_read_b32 v41, a97
    v_accvgpr_read_b32 v42, a98
    v_accvgpr_read_b32 v43, a99
    v_accvgpr_read_b32 v44, a112
    v_accvgpr_read_b32 v45, a113
    v_accvgpr_read_b32 v46, a114
    v_accvgpr_read_b32 v47, a115
    v_pk_mul_f32 v[40:41], v[40:41], v[24:25] op_sel_hi:[1,0]
    v_pk_mul_f32 v[42:43], v[42:43], v[24:25] op_sel_hi:[1,0]
    v_pk_mul_f32 v[44:45], v[44:45], v[24:25] op_sel_hi:[1,0]
    v_pk_mul_f32 v[46:47], v[46:47], v[24:25] op_sel_hi:[1,0]
    v_cvt_pk_bf16_f32 v72, v40, v41
    v_cvt_pk_bf16_f32 v73, v42, v43
    v_cvt_pk_bf16_f32 v74, v44, v45
    v_cvt_pk_bf16_f32 v75, v46, v47
    buffer_store_dwordx4 v[72:75], v21, s[24:27], s59 offen offset:0 sc1
    v_accvgpr_read_b32 v48, a100
    v_accvgpr_read_b32 v49, a101
    v_accvgpr_read_b32 v50, a102
    v_accvgpr_read_b32 v51, a103
    v_accvgpr_read_b32 v52, a116
    v_accvgpr_read_b32 v53, a117
    v_accvgpr_read_b32 v54, a118
    v_accvgpr_read_b32 v55, a119
    v_pk_mul_f32 v[48:49], v[48:49], v[26:27] op_sel_hi:[1,0]
    v_pk_mul_f32 v[50:51], v[50:51], v[26:27] op_sel_hi:[1,0]
    v_pk_mul_f32 v[52:53], v[52:53], v[26:27] op_sel_hi:[1,0]
    v_pk_mul_f32 v[54:55], v[54:55], v[26:27] op_sel_hi:[1,0]
    v_cvt_pk_bf16_f32 v76, v48, v49
    v_cvt_pk_bf16_f32 v77, v50, v51
    v_cvt_pk_bf16_f32 v78, v52, v53
    v_cvt_pk_bf16_f32 v79, v54, v55
    buffer_store_dwordx4 v[76:79], v21, s[24:27], s59 offen offset:1024 sc1
    v_accvgpr_read_b32 v56, a104
    v_accvgpr_read_b32 v57, a105
    v_accvgpr_read_b32 v58, a106
    v_accvgpr_read_b32 v59, a107
    v_accvgpr_read_b32 v60, a120
    v_accvgpr_read_b32 v61, a121
    v_accvgpr_read_b32 v62, a122
    v_accvgpr_read_b32 v63, a123
    v_pk_mul_f32 v[56:57], v[56:57], v[28:29] op_sel_hi:[1,0]
    v_pk_mul_f32 v[58:59], v[58:59], v[28:29] op_sel_hi:[1,0]
    v_pk_mul_f32 v[60:61], v[60:61], v[28:29] op_sel_hi:[1,0]
    v_pk_mul_f32 v[62:63], v[62:63], v[28:29] op_sel_hi:[1,0]
    v_cvt_pk_bf16_f32 v80, v56, v57
    v_cvt_pk_bf16_f32 v81, v58, v59
    v_cvt_pk_bf16_f32 v82, v60, v61
    v_cvt_pk_bf16_f32 v83, v62, v63
    buffer_store_dwordx4 v[80:83], v21, s[24:27], s59 offen offset:2048 sc1
    v_accvgpr_read_b32 v64, a108
    v_accvgpr_read_b32 v65, a109
    v_accvgpr_read_b32 v66, a110
    v_accvgpr_read_b32 v67, a111
    v_accvgpr_read_b32 v68, a124
    v_accvgpr_read_b32 v69, a125
    v_accvgpr_read_b32 v70, a126
    v_accvgpr_read_b32 v71, a127
    v_pk_mul_f32 v[64:65], v[64:65], v[30:31] op_sel_hi:[1,0]
    v_pk_mul_f32 v[66:67], v[66:67], v[30:31] op_sel_hi:[1,0]
    v_pk_mul_f32 v[68:69], v[68:69], v[30:31] op_sel_hi:[1,0]
    v_pk_mul_f32 v[70:71], v[70:71], v[30:31] op_sel_hi:[1,0]
    v_cvt_pk_bf16_f32 v84, v64, v65
    v_cvt_pk_bf16_f32 v85, v66, v67
    v_cvt_pk_bf16_f32 v86, v68, v69
    v_cvt_pk_bf16_f32 v87, v70, v71
    buffer_store_dwordx4 v[84:87], v21, s[24:27], s59 offen offset:3072 sc1
    s_add_u32 m0, s38, 0x5000
    v_mov_b32 v112, 0
    v_mov_b32 v113, 0
    v_mov_b32 v114, 0
    v_mov_b32 v115, 0
    v_mov_b32 v116, 0
    v_mov_b32 v117, 0
    v_mov_b32 v118, 0
    v_mov_b32 v119, 0
    v_mov_b32 v120, 0
    buffer_load_dwordx4 v192, s[4:7], s36 offen offset:0 lds
    v_mov_b32 v121, 0
    v_mov_b32 v122, 0
    v_mov_b32 v123, 0
    v_mov_b32 v124, 0
    v_mov_b32 v125, 0
    v_mov_b32 v126, 0
    v_mov_b32 v127, 0
    v_mov_b32 v128, 0
    v_mov_b32 v129, 0
    buffer_load_dwordx4 v193, s[4:7], s36 offen offset:1024 lds
    v_mov_b32 v130, 0
    v_mov_b32 v131, 0
    v_mov_b32 v132, 0
    v_mov_b32 v133, 0
    v_mov_b32 v134, 0
    v_mov_b32 v135, 0
    v_mov_b32 v136, 0
    v_mov_b32 v137, 0
    v_mov_b32 v138, 0
    buffer_load_dwordx4 v194, s[4:7], s36 offen offset:2048 lds
    v_mov_b32 v139, 0
    v_mov_b32 v140, 0
    v_mov_b32 v141, 0
    v_mov_b32 v142, 0
    v_mov_b32 v143, 0
    v_mov_b32 v144, 0
    v_mov_b32 v145, 0
    v_mov_b32 v146, 0
    v_mov_b32 v147, 0
    buffer_load_dwordx4 v195, s[4:7], s36 offen offset:3072 lds
    s_add_u32 m0, s38, 0x6000
    v_mov_b32 v148, 0
    v_mov_b32 v149, 0
    v_mov_b32 v150, 0
    v_mov_b32 v151, 0
    v_mov_b32 v152, 0
    v_mov_b32 v153, 0
    v_mov_b32 v154, 0
    v_mov_b32 v155, 0
    v_mov_b32 v156, 0
    buffer_load_dwordx4 v196, s[4:7], s36 offen offset:0 lds
    v_mov_b32 v157, 0
    v_mov_b32 v158, 0
    v_mov_b32 v159, 0
    v_mov_b32 v160, 0
    v_mov_b32 v161, 0
    v_mov_b32 v162, 0
    v_mov_b32 v163, 0
    v_mov_b32 v164, 0
    v_mov_b32 v165, 0
    buffer_load_dwordx4 a[240:243], v197, s[8:11], s37 offen offset:0 sc1
    v_mov_b32 v166, 0
    v_mov_b32 v167, 0
    v_mov_b32 v168, 0
    v_mov_b32 v169, 0
    v_mov_b32 v170, 0
    v_mov_b32 v171, 0
    v_mov_b32 v172, 0
    v_mov_b32 v173, 0
    v_mov_b32 v174, 0
    buffer_load_dwordx4 a[244:247], v197, s[8:11], s37 offen offset:1024 sc1
    v_mov_b32 v175, 0
    v_mov_b32 v176, 0
    v_mov_b32 v177, 0
    v_mov_b32 v178, 0
    v_mov_b32 v179, 0
    v_mov_b32 v180, 0
    v_mov_b32 v181, 0
    v_mov_b32 v182, 0
    v_mov_b32 v183, 0
    buffer_load_dwordx4 a[248:251], v198, s[8:11], s37 offen offset:0 sc1
    v_mov_b32 v184, 0
    v_mov_b32 v185, 0
    v_mov_b32 v186, 0
    v_mov_b32 v187, 0
    v_mov_b32 v188, 0
    v_mov_b32 v189, 0
    v_mov_b32 v190, 0
    v_mov_b32 v191, 0
    buffer_load_dwordx4 a[252:255], v198, s[8:11], s37 offen offset:1024 sc1
    s_add_u32 s36, s36, 0x14000
    s_add_u32 s37, s37, 0x40000
    s_mov_b32 s44, 0
    ds_read_b64_tr_b16 a[160:161], v213 offset:0
    ds_read_b64_tr_b16 a[162:163], v213 offset:5120
    ds_read_b64_tr_b16 a[164:165], v214 offset:32
    ds_read_b64_tr_b16 a[166:167], v214 offset:5152
    ds_read_b64_tr_b16 a[168:169], v213 offset:64
    ds_read_b64_tr_b16 a[170:171], v213 offset:5184
    ds_read_b64_tr_b16 a[172:173], v214 offset:96
    ds_read_b64_tr_b16 a[174:175], v214 offset:5216
    ds_read_b64_tr_b16 a[176:177], v213 offset:128
    ds_read_b64_tr_b16 a[178:179], v213 offset:5248
    ds_read_b64_tr_b16 a[180:181], v214 offset:160
    ds_read_b64_tr_b16 a[182:183], v214 offset:5280
    s_waitcnt lgkmcnt(10)
P3_loop:
    s_cmp_eq_u32 s44, 18
    s_cbranch_scc1 P3_side18
P3_u0:
    v_mfma_f32_16x16x32_bf16 v[112:115], a[160:163], a[192:195], v[112:115]
    ds_read_b64_tr_b16 a[184:185], v213 offset:192
    v_mfma_f32_16x16x32_bf16 v[152:155], a[160:163], a[196:199], v[152:155]
    s_waitcnt lgkmcnt(9)
    s_add_u32 m0, s38, 0x15000
    ds_read_b64_tr_b16 a[186:187], v213 offset:5312
    v_mfma_f32_16x16x32_bf16 v[116:119], a[164:167], a[192:195], v[116:119]
    buffer_load_dwordx4 v192, s[4:7], s36 offen offset:0 lds
    ds_read_b64_tr_b16 a[188:189], v214 offset:224
    v_mfma_f32_16x16x32_bf16 v[156:159], a[164:167], a[196:199], v[156:159]
    s_waitcnt lgkmcnt(9)
    ds_read_b64_tr_b16 a[190:191], v214 offset:5344
    v_mfma_f32_16x16x32_bf16 v[120:123], a[168:171], a[192:195], v[120:123]
    ds_read_b64_tr_b16 a[160:161], v213 offset:256
    v_mfma_f32_16x16x32_bf16 v[160:163], a[168:171], a[196:199], v[160:163]
    s_waitcnt lgkmcnt(9)
    ds_read_b64_tr_b16 a[162:163], v213 offset:5376
    v_mfma_f32_16x16x32_bf16 v[124:127], a[172:175], a[192:195], v[124:127]
    buffer_load_dwordx4 v193, s[4:7], s36 offen offset:1024 lds
    ds_read_b64_tr_b16 a[164:165], v214 offset:288
    v_mfma_f32_16x16x32_bf16 v[164:167], a[172:175], a[196:199], v[164:167]
    s_waitcnt lgkmcnt(9)
    ds_read_b64_tr_b16 a[166:167], v214 offset:5408
    v_mfma_f32_16x16x32_bf16 v[128:131], a[176:179], a[192:195], v[128:131]
    ds_read_b64_tr_b16 a[168:169], v213 offset:10240
    v_mfma_f32_16x16x32_bf16 v[168:171], a[176:179], a[196:199], v[168:171]
    s_waitcnt lgkmcnt(9)
    ds_read_b64_tr_b16 a[170:171], v213 offset:15360
    v_mfma_f32_16x16x32_bf16 v[132:135], a[180:183], a[192:195], v[132:135]
    ds_read_b64_tr_b16 a[172:173], v214 offset:10272
    v_mfma_f32_16x16x32_bf16 v[172:175], a[180:183], a[196:199], v[172:175]
    s_waitcnt lgkmcnt(9)
    buffer_load_dwordx4 v194, s[4:7], s36 offen offset:2048 lds
    ds_read_b64_tr_b16 a[174:175], v214 offset:15392
    v_mfma_f32_16x16x32_bf16 v[136:139], a[184:187], a[192:195], v[136:139]
    ds_read_b64_tr_b16 a[176:177], v213 offset:10304
    v_mfma_f32_16x16x32_bf16 v[176:179], a[184:187], a[196:199], v[176:179]
    s_waitcnt lgkmcnt(9)
    ds_read_b64_tr_b16 a[178:179], v213 offset:15424
    v_mfma_f32_16x16x32_bf16 v[140:143], a[188:191], a[192:195], v[140:143]
    ds_read_b64_tr_b16 a[180:181], v214 offset:10336
    v_mfma_f32_16x16x32_bf16 v[180:183], a[188:191], a[196:199], v[180:183]
    s_waitcnt lgkmcnt(9)
    buffer_load_dwordx4 v195, s[4:7], s36 offen offset:3072 lds
    ds_read_b64_tr_b16 a[182:183], v214 offset:15456
    v_mfma_f32_16x16x32_bf16 v[144:147], a[160:163], a[192:195], v[144:147]
    ds_read_b64_tr_b16 a[184:185], v213 offset:10368
    v_mfma_f32_16x16x32_bf16 v[184:187], a[160:163], a[196:199], v[184:187]
    s_waitcnt lgkmcnt(9)
    ds_read_b64_tr_b16 a[186:187], v213 offset:15488
    v_mfma_f32_16x16x32_bf16 v[148:151], a[164:167], a[192:195], v[148:151]
    ds_read_b64_tr_b16 a[188:189], v214 offset:10400
    v_mfma_f32_16x16x32_bf16 v[188:191], a[164:167], a[196:199], v[188:191]
    s_waitcnt lgkmcnt(9)
    s_add_u32 m0, s38, 0x16000
    ds_read_b64_tr_b16 a[190:191], v214 offset:15520
    v_mfma_f32_16x16x32_bf16 v[112:115], a[168:171], a[200:203], v[112:115]
    buffer_load_dwordx4 v196, s[4:7], s36 offen offset:0 lds
    ds_read_b64_tr_b16 a[160:161], v213 offset:10432
    v_mfma_f32_16x16x32_bf16 v[152:155], a[168:171], a[204:207], v[152:155]
    s_waitcnt lgkmcnt(9)
    s_add_u32 s36, s36, 0x14000
    ds_read_b64_tr_b16 a[162:163], v213 offset:15552
    v_mfma_f32_16x16x32_bf16 v[116:119], a[172:175], a[200:203], v[116:119]
    ds_read_b64_tr_b16 a[164:165], v214 offset:10464
    v_mfma_f32_16x16x32_bf16 v[156:159], a[172:175], a[204:207], v[156:159]
    s_waitcnt lgkmcnt(9)
    ds_read_b64_tr_b16 a[166:167], v214 offset:15584
    v_mfma_f32_16x16x32_bf16 v[120:123], a[176:179], a[200:203], v[120:123]
    buffer_load_dwordx4 a[128:131], v197, s[8:11], s37 offen offset:0 sc1
    ds_read_b64_tr_b16 a[168:169], v213 offset:10496
    v_mfma_f32_16x16x32_bf16 v[160:163], a[176:179], a[204:207], v[160:163]
    s_waitcnt lgkmcnt(9)
    ds_read_b64_tr_b16 a[170:171], v213 offset:15616
    v_mfma_f32_16x16x32_bf16 v[124:127], a[180:183], a[200:203], v[124:127]
    ds_read_b64_tr_b16 a[172:173], v214 offset:10528
    v_mfma_f32_16x16x32_bf16 v[164:167], a[180:183], a[204:207], v[164:167]
    s_waitcnt lgkmcnt(9)
    s_cmp_eq_u32 s44, 12
    s_cbranch_scc1 P3w0_24
    s_cmp_eq_u32 s44, 18
    s_cbranch_scc1 P3w0_25
    s_cmp_eq_u32 s44, 0
    s_cbranch_scc1 P3w0_63
    s_waitcnt vmcnt(19)
P3w0_24:
    s_waitcnt vmcnt(24)
P3w0_25:
    s_waitcnt vmcnt(25)
P3w0_63:
    s_waitcnt vmcnt(63)
    s_barrier
    ds_read_b64_tr_b16 a[174:175], v214 offset:15648
    v_mfma_f32_16x16x32_bf16 v[128:131], a[184:187], a[200:203], v[128:131]
    ds_read_b64_tr_b16 a[176:177], v199 offset:0
    v_mfma_f32_16x16x32_bf16 v[168:171], a[184:187], a[204:207], v[168:171]
    s_waitcnt lgkmcnt(9)
    buffer_load_dwordx4 a[132:135], v197, s[8:11], s37 offen offset:1024 sc1
    ds_read_b64_tr_b16 a[178:179], v199 offset:5120
    v_mfma_f32_16x16x32_bf16 v[132:135], a[188:191], a[200:203], v[132:135]
    ds_read_b64_tr_b16 a[180:181], v200 offset:32
    v_mfma_f32_16x16x32_bf16 v[172:175], a[188:191], a[204:207], v[172:175]
    s_waitcnt lgkmcnt(9)
    ds_read_b64_tr_b16 a[182:183], v200 offset:5152
    v_mfma_f32_16x16x32_bf16 v[136:139], a[160:163], a[200:203], v[136:139]
    ds_read_b64_tr_b16 a[184:185], v199 offset:64
    v_mfma_f32_16x16x32_bf16 v[176:179], a[160:163], a[204:207], v[176:179]
    s_waitcnt lgkmcnt(9)
    buffer_load_dwordx4 a[136:139], v198, s[8:11], s37 offen offset:0 sc1
    ds_read_b64_tr_b16 a[186:187], v199 offset:5184
    v_mfma_f32_16x16x32_bf16 v[140:143], a[164:167], a[200:203], v[140:143]
    ds_read_b64_tr_b16 a[188:189], v200 offset:96
    v_mfma_f32_16x16x32_bf16 v[180:183], a[164:167], a[204:207], v[180:183]
    s_waitcnt lgkmcnt(9)
    ds_read_b64_tr_b16 a[190:191], v200 offset:5216
    v_mfma_f32_16x16x32_bf16 v[144:147], a[168:171], a[200:203], v[144:147]
    s_add_u32 s44, s44, 1
    ds_read_b64_tr_b16 a[160:161], v199 offset:128
    v_mfma_f32_16x16x32_bf16 v[184:187], a[168:171], a[204:207], v[184:187]
    s_waitcnt lgkmcnt(9)
    ds_read_b64_tr_b16 a[162:163], v199 offset:5248
    v_mfma_f32_16x16x32_bf16 v[148:151], a[172:175], a[200:203], v[148:151]
    buffer_load_dwordx4 a[140:143], v198, s[8:11], s37 offen offset:1024 sc1
    ds_read_b64_tr_b16 a[164:165], v200 offset:160
    v_mfma_f32_16x16x32_bf16 v[188:191], a[172:175], a[204:207], v[188:191]
    s_waitcnt lgkmcnt(9)
    s_add_u32 s37, s37, 0x40000
    ds_read_b64_tr_b16 a[166:167], v200 offset:5280
    s_cmp_eq_u32 s44, 7
    s_cbranch_scc1 P3_bound
P3_t1:
    s_cmp_eq_u32 s44, 19
    s_cbranch_scc1 P3_side19
P3_u1:
    v_mfma_f32_16x16x32_bf16 v[112:115], a[176:179], a[208:211], v[112:115]
    s_cmp_eq_u32 s44, 19
    s_cselect_b32 s6, 0, s6
    s_cselect_b32 s10, 0, s10
    ds_read_b64_tr_b16 a[168:169], v199 offset:192
    v_mfma_f32_16x16x32_bf16 v[152:155], a[176:179], a[212:215], v[152:155]
    s_waitcnt lgkmcnt(9)
    s_add_u32 m0, s38, 0xa000
    ds_read_b64_tr_b16 a[170:171], v199 offset:5312
    v_mfma_f32_16x16x32_bf16 v[116:119], a[180:183], a[208:211], v[116:119]
    buffer_load_dwordx4 v192, s[4:7], s36 offen offset:0 lds
    ds_read_b64_tr_b16 a[172:173], v200 offset:224
    v_mfma_f32_16x16x32_bf16 v[156:159], a[180:183], a[212:215], v[156:159]
    s_waitcnt lgkmcnt(9)
    ds_read_b64_tr_b16 a[174:175], v200 offset:5344
    v_mfma_f32_16x16x32_bf16 v[120:123], a[184:187], a[208:211], v[120:123]
    ds_read_b64_tr_b16 a[176:177], v199 offset:256
    v_mfma_f32_16x16x32_bf16 v[160:163], a[184:187], a[212:215], v[160:163]
    s_waitcnt lgkmcnt(9)
    ds_read_b64_tr_b16 a[178:179], v199 offset:5376
    v_mfma_f32_16x16x32_bf16 v[124:127], a[188:191], a[208:211], v[124:127]
    buffer_load_dwordx4 v193, s[4:7], s36 offen offset:1024 lds
    ds_read_b64_tr_b16 a[180:181], v200 offset:288
    v_mfma_f32_16x16x32_bf16 v[164:167], a[188:191], a[212:215], v[164:167]
    s_waitcnt lgkmcnt(9)
    ds_read_b64_tr_b16 a[182:183], v200 offset:5408
    v_mfma_f32_16x16x32_bf16 v[128:131], a[160:163], a[208:211], v[128:131]
    ds_read_b64_tr_b16 a[184:185], v199 offset:10240
    v_mfma_f32_16x16x32_bf16 v[168:171], a[160:163], a[212:215], v[168:171]
    s_waitcnt lgkmcnt(9)
    ds_read_b64_tr_b16 a[186:187], v199 offset:15360
    v_mfma_f32_16x16x32_bf16 v[132:135], a[164:167], a[208:211], v[132:135]
    ds_read_b64_tr_b16 a[188:189], v200 offset:10272
    v_mfma_f32_16x16x32_bf16 v[172:175], a[164:167], a[212:215], v[172:175]
    s_waitcnt lgkmcnt(9)
    buffer_load_dwordx4 v194, s[4:7], s36 offen offset:2048 lds
    ds_read_b64_tr_b16 a[190:191], v200 offset:15392
    v_mfma_f32_16x16x32_bf16 v[136:139], a[168:171], a[208:211], v[136:139]
    ds_read_b64_tr_b16 a[160:161], v199 offset:10304
    v_mfma_f32_16x16x32_bf16 v[176:179], a[168:171], a[212:215], v[176:179]
    s_waitcnt lgkmcnt(9)
    ds_read_b64_tr_b16 a[162:163], v199 offset:15424
    v_mfma_f32_16x16x32_bf16 v[140:143], a[172:175], a[208:211], v[140:143]
    ds_read_b64_tr_b16 a[164:165], v200 offset:10336
    v_mfma_f32_16x16x32_bf16 v[180:183], a[172:175], a[212:215], v[180:183]
    s_waitcnt lgkmcnt(9)
    buffer_load_dwordx4 v195, s[4:7], s36 offen offset:3072 lds
    ds_read_b64_tr_b16 a[166:167], v200 offset:15456
    v_mfma_f32_16x16x32_bf16 v[144:147], a[176:179], a[208:211], v[144:147]
    ds_read_b64_tr_b16 a[168:169], v199 offset:10368
    v_mfma_f32_16x16x32_bf16 v[184:187], a[176:179], a[212:215], v[184:187]
    s_waitcnt lgkmcnt(9)
    ds_read_b64_tr_b16 a[170:171], v199 offset:15488
    v_mfma_f32_16x16x32_bf16 v[148:151], a[180:183], a[208:211], v[148:151]
    ds_read_b64_tr_b16 a[172:173], v200 offset:10400
    v_mfma_f32_16x16x32_bf16 v[188:191], a[180:183], a[212:215], v[188:191]
    s_waitcnt lgkmcnt(9)
    s_add_u32 m0, s38, 0xb000
    ds_read_b64_tr_b16 a[174:175], v200 offset:15520
    v_mfma_f32_16x16x32_bf16 v[112:115], a[184:187], a[216:219], v[112:115]
    buffer_load_dwordx4 v196, s[4:7], s36 offen offset:0 lds
    ds_read_b64_tr_b16 a[176:177], v199 offset:10432
    v_mfma_f32_16x16x32_bf16 v[152:155], a[184:187], a[220:223], v[152:155]
    s_waitcnt lgkmcnt(9)
    s_add_u32 s36, s36, 0x14000
    ds_read_b64_tr_b16 a[178:179], v199 offset:15552
    v_mfma_f32_16x16x32_bf16 v[116:119], a[188:191], a[216:219], v[116:119]
    ds_read_b64_tr_b16 a[180:181], v200 offset:10464
    v_mfma_f32_16x16x32_bf16 v[156:159], a[188:191], a[220:223], v[156:159]
    s_waitcnt lgkmcnt(9)
    ds_read_b64_tr_b16 a[182:183], v200 offset:15584
    v_mfma_f32_16x16x32_bf16 v[120:123], a[160:163], a[216:219], v[120:123]
    buffer_load_dwordx4 a[144:147], v197, s[8:11], s37 offen offset:0 sc1
    ds_read_b64_tr_b16 a[184:185], v199 offset:10496
    v_mfma_f32_16x16x32_bf16 v[160:163], a[160:163], a[220:223], v[160:163]
    s_waitcnt lgkmcnt(9)
    ds_read_b64_tr_b16 a[186:187], v199 offset:15616
    v_mfma_f32_16x16x32_bf16 v[124:127], a[164:167], a[216:219], v[124:127]
    ds_read_b64_tr_b16 a[188:189], v200 offset:10528
    v_mfma_f32_16x16x32_bf16 v[164:167], a[164:167], a[220:223], v[164:167]
    s_waitcnt lgkmcnt(9)
    s_cmp_eq_u32 s44, 7
    s_cbranch_scc1 P3w1_34
    s_cmp_eq_u32 s44, 19
    s_cbranch_scc1 P3w1_43
    s_cmp_eq_u32 s44, 1
    s_cbranch_scc1 P3w1_63
    s_waitcnt vmcnt(24)
P3w1_34:
    s_waitcnt vmcnt(34)
P3w1_43:
    s_waitcnt vmcnt(43)
P3w1_63:
    s_waitcnt vmcnt(63)
    s_barrier
    ds_read_b64_tr_b16 a[190:191], v200 offset:15648
    v_mfma_f32_16x16x32_bf16 v[128:131], a[168:171], a[216:219], v[128:131]
    ds_read_b64_tr_b16 a[160:161], v201 offset:0
    v_mfma_f32_16x16x32_bf16 v[168:171], a[168:171], a[220:223], v[168:171]
    s_waitcnt lgkmcnt(9)
    buffer_load_dwordx4 a[148:151], v197, s[8:11], s37 offen offset:1024 sc1
    ds_read_b64_tr_b16 a[162:163], v201 offset:5120
    v_mfma_f32_16x16x32_bf16 v[132:135], a[172:175], a[216:219], v[132:135]
    ds_read_b64_tr_b16 a[164:165], v202 offset:32
    v_mfma_f32_16x16x32_bf16 v[172:175], a[172:175], a[220:223], v[172:175]
    s_waitcnt lgkmcnt(9)
    ds_read_b64_tr_b16 a[166:167], v202 offset:5152
    v_mfma_f32_16x16x32_bf16 v[136:139], a[176:179], a[216:219], v[136:139]
    ds_read_b64_tr_b16 a[168:169], v201 offset:64
    v_mfma_f32_16x16x32_bf16 v[176:179], a[176:179], a[220:223], v[176:179]
    s_waitcnt lgkmcnt(9)
    buffer_load_dwordx4 a[152:155], v198, s[8:11], s37 offen offset:0 sc1
    ds_read_b64_tr_b16 a[170:171], v201 offset:5184
    v_mfma_f32_16x16x32_bf16 v[140:143], a[180:183], a[216:219], v[140:143]
    ds_read_b64_tr_b16 a[172:173], v202 offset:96
    v_mfma_f32_16x16x32_bf16 v[180:183], a[180:183], a[220:223], v[180:183]
    s_waitcnt lgkmcnt(9)
    ds_read_b64_tr_b16 a[174:175], v202 offset:5216
    v_mfma_f32_16x16x32_bf16 v[144:147], a[184:187], a[216:219], v[144:147]
    s_add_u32 s44, s44, 1
    ds_read_b64_tr_b16 a[176:177], v201 offset:128
    v_mfma_f32_16x16x32_bf16 v[184:187], a[184:187], a[220:223], v[184:187]
    s_waitcnt lgkmcnt(9)
    ds_read_b64_tr_b16 a[178:179], v201 offset:5248
    v_mfma_f32_16x16x32_bf16 v[148:151], a[188:191], a[216:219], v[148:151]
    buffer_load_dwordx4 a[156:159], v198, s[8:11], s37 offen offset:1024 sc1
    ds_read_b64_tr_b16 a[180:181], v202 offset:160
    v_mfma_f32_16x16x32_bf16 v[188:191], a[188:191], a[220:223], v[188:191]
    s_waitcnt lgkmcnt(9)
    s_add_u32 s37, s37, 0x40000
    ds_read_b64_tr_b16 a[182:183], v202 offset:5280
P3_t2:
P3_u2:
    v_mfma_f32_16x16x32_bf16 v[112:115], a[160:163], a[224:227], v[112:115]
    ds_read_b64_tr_b16 a[184:185], v201 offset:192
    v_mfma_f32_16x16x32_bf16 v[152:155], a[160:163], a[228:231], v[152:155]
    s_waitcnt lgkmcnt(9)
    s_add_u32 m0, s38, 0x20000
    ds_read_b64_tr_b16 a[186:187], v201 offset:5312
    v_mfma_f32_16x16x32_bf16 v[116:119], a[164:167], a[224:227], v[116:119]
    buffer_load_dwordx4 v192, s[4:7], s36 offen offset:0 lds
    ds_read_b64_tr_b16 a[188:189], v202 offset:224
    v_mfma_f32_16x16x32_bf16 v[156:159], a[164:167], a[228:231], v[156:159]
    s_waitcnt lgkmcnt(9)
    ds_read_b64_tr_b16 a[190:191], v202 offset:5344
    v_mfma_f32_16x16x32_bf16 v[120:123], a[168:171], a[224:227], v[120:123]
    ds_read_b64_tr_b16 a[160:161], v201 offset:256
    v_mfma_f32_16x16x32_bf16 v[160:163], a[168:171], a[228:231], v[160:163]
    s_waitcnt lgkmcnt(9)
    ds_read_b64_tr_b16 a[162:163], v201 offset:5376
    v_mfma_f32_16x16x32_bf16 v[124:127], a[172:175], a[224:227], v[124:127]
    buffer_load_dwordx4 v193, s[4:7], s36 offen offset:1024 lds
    ds_read_b64_tr_b16 a[164:165], v202 offset:288
    v_mfma_f32_16x16x32_bf16 v[164:167], a[172:175], a[228:231], v[164:167]
    s_waitcnt lgkmcnt(9)
    ds_read_b64_tr_b16 a[166:167], v202 offset:5408
    v_mfma_f32_16x16x32_bf16 v[128:131], a[176:179], a[224:227], v[128:131]
    ds_read_b64_tr_b16 a[168:169], v201 offset:10240
    v_mfma_f32_16x16x32_bf16 v[168:171], a[176:179], a[228:231], v[168:171]
    s_waitcnt lgkmcnt(9)
    ds_read_b64_tr_b16 a[170:171], v201 offset:15360
    v_mfma_f32_16x16x32_bf16 v[132:135], a[180:183], a[224:227], v[132:135]
    ds_read_b64_tr_b16 a[172:173], v202 offset:10272
    v_mfma_f32_16x16x32_bf16 v[172:175], a[180:183], a[228:231], v[172:175]
    s_waitcnt lgkmcnt(9)
    buffer_load_dwordx4 v194, s[4:7], s36 offen offset:2048 lds
    ds_read_b64_tr_b16 a[174:175], v202 offset:15392
    v_mfma_f32_16x16x32_bf16 v[136:139], a[184:187], a[224:227], v[136:139]
    ds_read_b64_tr_b16 a[176:177], v201 offset:10304
    v_mfma_f32_16x16x32_bf16 v[176:179], a[184:187], a[228:231], v[176:179]
    s_waitcnt lgkmcnt(9)
    ds_read_b64_tr_b16 a[178:179], v201 offset:15424
    v_mfma_f32_16x16x32_bf16 v[140:143], a[188:191], a[224:227], v[140:143]
    ds_read_b64_tr_b16 a[180:181], v202 offset:10336
    v_mfma_f32_16x16x32_bf16 v[180:183], a[188:191], a[228:231], v[180:183]
    s_waitcnt lgkmcnt(9)
    buffer_load_dwordx4 v195, s[4:7], s36 offen offset:3072 lds
    ds_read_b64_tr_b16 a[182:183], v202 offset:15456
    v_mfma_f32_16x16x32_bf16 v[144:147], a[160:163], a[224:227], v[144:147]
    ds_read_b64_tr_b16 a[184:185], v201 offset:10368
    v_mfma_f32_16x16x32_bf16 v[184:187], a[160:163], a[228:231], v[184:187]
    s_waitcnt lgkmcnt(9)
    ds_read_b64_tr_b16 a[186:187], v201 offset:15488
    v_mfma_f32_16x16x32_bf16 v[148:151], a[164:167], a[224:227], v[148:151]
    ds_read_b64_tr_b16 a[188:189], v202 offset:10400
    v_mfma_f32_16x16x32_bf16 v[188:191], a[164:167], a[228:231], v[188:191]
    s_waitcnt lgkmcnt(9)
    s_add_u32 m0, s38, 0x21000
    ds_read_b64_tr_b16 a[190:191], v202 offset:15520
    v_mfma_f32_16x16x32_bf16 v[112:115], a[168:171], a[232:235], v[112:115]
    buffer_load_dwordx4 v196, s[4:7], s36 offen offset:0 lds
    ds_read_b64_tr_b16 a[160:161], v201 offset:10432
    v_mfma_f32_16x16x32_bf16 v[152:155], a[168:171], a[236:239], v[152:155]
    s_waitcnt lgkmcnt(9)
    s_add_u32 s36, s36, 0x14000
    ds_read_b64_tr_b16 a[162:163], v201 offset:15552
    v_mfma_f32_16x16x32_bf16 v[116:119], a[172:175], a[232:235], v[116:119]
    ds_read_b64_tr_b16 a[164:165], v202 offset:10464
    v_mfma_f32_16x16x32_bf16 v[156:159], a[172:175], a[236:239], v[156:159]
    s_waitcnt lgkmcnt(9)
    ds_read_b64_tr_b16 a[166:167], v202 offset:15584
    v_mfma_f32_16x16x32_bf16 v[120:123], a[176:179], a[232:235], v[120:123]
    buffer_load_dwordx4 a[192:195], v197, s[8:11], s37 offen offset:0 sc1
    ds_read_b64_tr_b16 a[168:169], v201 offset:10496
    v_mfma_f32_16x16x32_bf16 v[160:163], a[176:179], a[236:239], v[160:163]
    s_waitcnt lgkmcnt(9)
    ds_read_b64_tr_b16 a[170:171], v201 offset:15616
    v_mfma_f32_16x16x32_bf16 v[124:127], a[180:183], a[232:235], v[124:127]
    ds_read_b64_tr_b16 a[172:173], v202 offset:10528
    v_mfma_f32_16x16x32_bf16 v[164:167], a[180:183], a[236:239], v[164:167]
    s_waitcnt lgkmcnt(9)
    s_cmp_eq_u32 s44, 8
    s_cbranch_scc1 P3w2_34
    s_cmp_eq_u32 s44, 20
    s_cbranch_scc1 P3w2_43
    s_waitcnt vmcnt(24)
P3w2_34:
    s_waitcnt vmcnt(34)
P3w2_43:
    s_waitcnt vmcnt(43)
    s_barrier
    ds_read_b64_tr_b16 a[174:175], v202 offset:15648
    v_mfma_f32_16x16x32_bf16 v[128:131], a[184:187], a[232:235], v[128:131]
    ds_read_b64_tr_b16 a[176:177], v199 offset:20480
    v_mfma_f32_16x16x32_bf16 v[168:171], a[184:187], a[236:239], v[168:171]
    s_waitcnt lgkmcnt(9)
    buffer_load_dwordx4 a[196:199], v197, s[8:11], s37 offen offset:1024 sc1
    ds_read_b64_tr_b16 a[178:179], v199 offset:25600
    v_mfma_f32_16x16x32_bf16 v[132:135], a[188:191], a[232:235], v[132:135]
    s_cmp_ge_u32 s44, 14
    s_cselect_b32 s3, 4, 3
    ds_read_b64_tr_b16 a[180:181], v200 offset:20512
    v_mfma_f32_16x16x32_bf16 v[172:175], a[188:191], a[236:239], v[172:175]
    s_waitcnt lgkmcnt(9)
    s_add_u32 s3, s3, s78
    ds_read_b64_tr_b16 a[182:183], v200 offset:25632
    v_mfma_f32_16x16x32_bf16 v[136:139], a[160:163], a[232:235], v[136:139]
    ds_read_b64_tr_b16 a[184:185], v199 offset:20544
    v_mov_b32 v109, s3
    v_mfma_f32_16x16x32_bf16 v[176:179], a[160:163], a[236:239], v[176:179]
    s_waitcnt lgkmcnt(9)
    buffer_load_dwordx4 a[200:203], v198, s[8:11], s37 offen offset:0 sc1
    ds_read_b64_tr_b16 a[186:187], v199 offset:25664
    v_mfma_f32_16x16x32_bf16 v[140:143], a[164:167], a[232:235], v[140:143]
    ds_read_b64_tr_b16 a[188:189], v200 offset:20576
    buffer_store_dword v109, v108, s[96:99], 0 offen sc1
    v_mfma_f32_16x16x32_bf16 v[180:183], a[164:167], a[236:239], v[180:183]
    s_waitcnt lgkmcnt(9)
    ds_read_b64_tr_b16 a[190:191], v200 offset:25696
    v_mfma_f32_16x16x32_bf16 v[144:147], a[168:171], a[232:235], v[144:147]
    s_add_u32 s44, s44, 1
    ds_read_b64_tr_b16 a[160:161], v199 offset:20608
    v_mfma_f32_16x16x32_bf16 v[184:187], a[168:171], a[236:239], v[184:187]
    s_waitcnt lgkmcnt(9)
    ds_read_b64_tr_b16 a[162:163], v199 offset:25728
    v_mfma_f32_16x16x32_bf16 v[148:151], a[172:175], a[232:235], v[148:151]
    buffer_load_dwordx4 a[204:207], v198, s[8:11], s37 offen offset:1024 sc1
    ds_read_b64_tr_b16 a[164:165], v200 offset:20640
    v_mfma_f32_16x16x32_bf16 v[188:191], a[172:175], a[236:239], v[188:191]
    s_waitcnt lgkmcnt(9)
    s_add_u32 s37, s37, 0x40000
    ds_read_b64_tr_b16 a[166:167], v200 offset:25760
P3_t3:
P3_u3:
    v_mfma_f32_16x16x32_bf16 v[112:115], a[176:179], a[240:243], v[112:115]
    s_cmp_eq_u32 s44, 3
    s_cselect_b32 s4, s66, s4
    s_cselect_b32 s5, s67, s5
    s_cselect_b32 s6, 0x500000, s6
    s_cselect_b32 s36, s49, s36
    s_cselect_b32 s10, 0, s10
    ds_read_b64_tr_b16 a[168:169], v199 offset:20672
    v_mfma_f32_16x16x32_bf16 v[152:155], a[176:179], a[244:247], v[152:155]
    s_waitcnt lgkmcnt(9)
    s_add_u32 m0, s38, 0
    ds_read_b64_tr_b16 a[170:171], v199 offset:25792
    v_mfma_f32_16x16x32_bf16 v[116:119], a[180:183], a[240:243], v[116:119]
    buffer_load_dwordx4 v192, s[4:7], s36 offen offset:0 lds
    ds_read_b64_tr_b16 a[172:173], v200 offset:20704
    v_mfma_f32_16x16x32_bf16 v[156:159], a[180:183], a[244:247], v[156:159]
    s_waitcnt lgkmcnt(9)
    ds_read_b64_tr_b16 a[174:175], v200 offset:25824
    v_mfma_f32_16x16x32_bf16 v[120:123], a[184:187], a[240:243], v[120:123]
    ds_read_b64_tr_b16 a[176:177], v199 offset:20736
    v_mfma_f32_16x16x32_bf16 v[160:163], a[184:187], a[244:247], v[160:163]
    s_waitcnt lgkmcnt(9)
    ds_read_b64_tr_b16 a[178:179], v199 offset:25856
    v_mfma_f32_16x16x32_bf16 v[124:127], a[188:191], a[240:243], v[124:127]
    buffer_load_dwordx4 v193, s[4:7], s36 offen offset:1024 lds
    ds_read_b64_tr_b16 a[180:181], v200 offset:20768
    v_mfma_f32_16x16x32_bf16 v[164:167], a[188:191], a[244:247], v[164:167]
    s_waitcnt lgkmcnt(9)
    ds_read_b64_tr_b16 a[182:183], v200 offset:25888
    v_mfma_f32_16x16x32_bf16 v[128:131], a[160:163], a[240:243], v[128:131]
    ds_read_b64_tr_b16 a[184:185], v199 offset:30720
    v_mfma_f32_16x16x32_bf16 v[168:171], a[160:163], a[244:247], v[168:171]
    s_waitcnt lgkmcnt(9)
    ds_read_b64_tr_b16 a[186:187], v199 offset:35840
    v_mfma_f32_16x16x32_bf16 v[132:135], a[164:167], a[240:243], v[132:135]
    ds_read_b64_tr_b16 a[188:189], v200 offset:30752
    v_mfma_f32_16x16x32_bf16 v[172:175], a[164:167], a[244:247], v[172:175]
    s_waitcnt lgkmcnt(9)
    buffer_load_dwordx4 v194, s[4:7], s36 offen offset:2048 lds
    ds_read_b64_tr_b16 a[190:191], v200 offset:35872
    v_mfma_f32_16x16x32_bf16 v[136:139], a[168:171], a[240:243], v[136:139]
    ds_read_b64_tr_b16 a[160:161], v199 offset:30784
    v_mfma_f32_16x16x32_bf16 v[176:179], a[168:171], a[244:247], v[176:179]
    s_waitcnt lgkmcnt(9)
    ds_read_b64_tr_b16 a[162:163], v199 offset:35904
    v_mfma_f32_16x16x32_bf16 v[140:143], a[172:175], a[240:243], v[140:143]
    ds_read_b64_tr_b16 a[164:165], v200 offset:30816
    v_mfma_f32_16x16x32_bf16 v[180:183], a[172:175], a[244:247], v[180:183]
    s_waitcnt lgkmcnt(9)
    buffer_load_dwordx4 v195, s[4:7], s36 offen offset:3072 lds
    ds_read_b64_tr_b16 a[166:167], v200 offset:35936
    v_mfma_f32_16x16x32_bf16 v[144:147], a[176:179], a[240:243], v[144:147]
    ds_read_b64_tr_b16 a[168:169], v199 offset:30848
    v_mfma_f32_16x16x32_bf16 v[184:187], a[176:179], a[244:247], v[184:187]
    s_waitcnt lgkmcnt(9)
    ds_read_b64_tr_b16 a[170:171], v199 offset:35968
    v_mfma_f32_16x16x32_bf16 v[148:151], a[180:183], a[240:243], v[148:151]
    ds_read_b64_tr_b16 a[172:173], v200 offset:30880
    v_mfma_f32_16x16x32_bf16 v[188:191], a[180:183], a[244:247], v[188:191]
    s_waitcnt lgkmcnt(9)
    s_add_u32 m0, s38, 0x1000
    ds_read_b64_tr_b16 a[174:175], v200 offset:36000
    v_mfma_f32_16x16x32_bf16 v[112:115], a[184:187], a[248:251], v[112:115]
    buffer_load_dwordx4 v196, s[4:7], s36 offen offset:0 lds
    ds_read_b64_tr_b16 a[176:177], v199 offset:30912
    v_mfma_f32_16x16x32_bf16 v[152:155], a[184:187], a[252:255], v[152:155]
    s_waitcnt lgkmcnt(9)
    s_add_u32 s36, s36, 0x14000
    ds_read_b64_tr_b16 a[178:179], v199 offset:36032
    v_mfma_f32_16x16x32_bf16 v[116:119], a[188:191], a[248:251], v[116:119]
    ds_read_b64_tr_b16 a[180:181], v200 offset:30944
    v_mfma_f32_16x16x32_bf16 v[156:159], a[188:191], a[252:255], v[156:159]
    s_waitcnt lgkmcnt(9)
    ds_read_b64_tr_b16 a[182:183], v200 offset:36064
    v_mfma_f32_16x16x32_bf16 v[120:123], a[160:163], a[248:251], v[120:123]
    buffer_load_dwordx4 a[208:211], v197, s[8:11], s37 offen offset:0 sc1
    ds_read_b64_tr_b16 a[184:185], v199 offset:30976
    v_mfma_f32_16x16x32_bf16 v[160:163], a[160:163], a[252:255], v[160:163]
    s_waitcnt lgkmcnt(9)
    ds_read_b64_tr_b16 a[186:187], v199 offset:36096
    v_mfma_f32_16x16x32_bf16 v[124:127], a[164:167], a[248:251], v[124:127]
    ds_read_b64_tr_b16 a[188:189], v200 offset:31008
    v_mfma_f32_16x16x32_bf16 v[164:167], a[164:167], a[252:255], v[164:167]
    s_waitcnt lgkmcnt(9)
    s_cmp_eq_u32 s44, 9
    s_cbranch_scc1 P3w3_35
    s_cmp_eq_u32 s44, 21
    s_cbranch_scc1 P3w3_43
    s_waitcnt vmcnt(25)
P3w3_35:
    s_waitcnt vmcnt(35)
P3w3_43:
    s_waitcnt vmcnt(43)
    s_barrier
    ds_read_b64_tr_b16 a[190:191], v200 offset:36128
    v_mfma_f32_16x16x32_bf16 v[128:131], a[168:171], a[248:251], v[128:131]
    ds_read_b64_tr_b16 a[160:161], v201 offset:20480
    v_mfma_f32_16x16x32_bf16 v[168:171], a[168:171], a[252:255], v[168:171]
    s_waitcnt lgkmcnt(9)
    buffer_load_dwordx4 a[212:215], v197, s[8:11], s37 offen offset:1024 sc1
    ds_read_b64_tr_b16 a[162:163], v201 offset:25600
    v_mfma_f32_16x16x32_bf16 v[132:135], a[172:175], a[248:251], v[132:135]
    ds_read_b64_tr_b16 a[164:165], v202 offset:20512
    v_mfma_f32_16x16x32_bf16 v[172:175], a[172:175], a[252:255], v[172:175]
    s_waitcnt lgkmcnt(9)
    ds_read_b64_tr_b16 a[166:167], v202 offset:25632
    v_mfma_f32_16x16x32_bf16 v[136:139], a[176:179], a[248:251], v[136:139]
    ds_read_b64_tr_b16 a[168:169], v201 offset:20544
    v_mfma_f32_16x16x32_bf16 v[176:179], a[176:179], a[252:255], v[176:179]
    s_waitcnt lgkmcnt(9)
    buffer_load_dwordx4 a[216:219], v198, s[8:11], s37 offen offset:0 sc1
    ds_read_b64_tr_b16 a[170:171], v201 offset:25664
    v_mfma_f32_16x16x32_bf16 v[140:143], a[180:183], a[248:251], v[140:143]
    ds_read_b64_tr_b16 a[172:173], v202 offset:20576
    v_mfma_f32_16x16x32_bf16 v[180:183], a[180:183], a[252:255], v[180:183]
    s_waitcnt lgkmcnt(9)
    ds_read_b64_tr_b16 a[174:175], v202 offset:25696
    v_mfma_f32_16x16x32_bf16 v[144:147], a[184:187], a[248:251], v[144:147]
    s_add_u32 s44, s44, 1
    ds_read_b64_tr_b16 a[176:177], v201 offset:20608
    v_mfma_f32_16x16x32_bf16 v[184:187], a[184:187], a[252:255], v[184:187]
    s_waitcnt lgkmcnt(9)
    ds_read_b64_tr_b16 a[178:179], v201 offset:25728
    v_mfma_f32_16x16x32_bf16 v[148:151], a[188:191], a[248:251], v[148:151]
    buffer_load_dwordx4 a[220:223], v198, s[8:11], s37 offen offset:1024 sc1
    ds_read_b64_tr_b16 a[180:181], v202 offset:20640
    v_mfma_f32_16x16x32_bf16 v[188:191], a[188:191], a[252:255], v[188:191]
    s_waitcnt lgkmcnt(9)
    s_add_u32 s37, s37, 0x40000
    ds_read_b64_tr_b16 a[182:183], v202 offset:25760
P3_t4:
    s_cmp_eq_u32 s44, 4
    s_cbranch_scc1 P3_side4
P3_u4:
    v_mfma_f32_16x16x32_bf16 v[112:115], a[160:163], a[128:131], v[112:115]
    ds_read_b64_tr_b16 a[184:185], v201 offset:20672
    v_mfma_f32_16x16x32_bf16 v[152:155], a[160:163], a[132:135], v[152:155]
    s_waitcnt lgkmcnt(9)
    s_add_u32 m0, s38, 0x10000
    ds_read_b64_tr_b16 a[186:187], v201 offset:25792
    v_mfma_f32_16x16x32_bf16 v[116:119], a[164:167], a[128:131], v[116:119]
    buffer_load_dwordx4 v192, s[4:7], s36 offen offset:0 lds
    ds_read_b64_tr_b16 a[188:189], v202 offset:20704
    v_mfma_f32_16x16x32_bf16 v[156:159], a[164:167], a[132:135], v[156:159]
    s_waitcnt lgkmcnt(9)
    ds_read_b64_tr_b16 a[190:191], v202 offset:25824
    v_mfma_f32_16x16x32_bf16 v[120:123], a[168:171], a[128:131], v[120:123]
    ds_read_b64_tr_b16 a[160:161], v201 offset:20736
    v_mfma_f32_16x16x32_bf16 v[160:163], a[168:171], a[132:135], v[160:163]
    s_waitcnt lgkmcnt(9)
    ds_read_b64_tr_b16 a[162:163], v201 offset:25856
    v_mfma_f32_16x16x32_bf16 v[124:127], a[172:175], a[128:131], v[124:127]
    buffer_load_dwordx4 v193, s[4:7], s36 offen offset:1024 lds
    ds_read_b64_tr_b16 a[164:165], v202 offset:20768
    v_mfma_f32_16x16x32_bf16 v[164:167], a[172:175], a[132:135], v[164:167]
    s_waitcnt lgkmcnt(9)
    ds_read_b64_tr_b16 a[166:167], v202 offset:25888
    v_mfma_f32_16x16x32_bf16 v[128:131], a[176:179], a[128:131], v[128:131]
    ds_read_b64_tr_b16 a[168:169], v201 offset:30720
    v_mfma_f32_16x16x32_bf16 v[168:171], a[176:179], a[132:135], v[168:171]
    s_waitcnt lgkmcnt(9)
    ds_read_b64_tr_b16 a[170:171], v201 offset:35840
    v_mfma_f32_16x16x32_bf16 v[132:135], a[180:183], a[128:131], v[132:135]
    ds_read_b64_tr_b16 a[172:173], v202 offset:30752
    v_mfma_f32_16x16x32_bf16 v[172:175], a[180:183], a[132:135], v[172:175]
    s_waitcnt lgkmcnt(9)
    buffer_load_dwordx4 v194, s[4:7], s36 offen offset:2048 lds
    ds_read_b64_tr_b16 a[174:175], v202 offset:35872
    v_mfma_f32_16x16x32_bf16 v[136:139], a[184:187], a[128:131], v[136:139]
    ds_read_b64_tr_b16 a[176:177], v201 offset:30784
    v_mfma_f32_16x16x32_bf16 v[176:179], a[184:187], a[132:135], v[176:179]
    s_waitcnt lgkmcnt(9)
    ds_read_b64_tr_b16 a[178:179], v201 offset:35904
    v_mfma_f32_16x16x32_bf16 v[140:143], a[188:191], a[128:131], v[140:143]
    ds_read_b64_tr_b16 a[180:181], v202 offset:30816
    v_mfma_f32_16x16x32_bf16 v[180:183], a[188:191], a[132:135], v[180:183]
    s_waitcnt lgkmcnt(9)
    buffer_load_dwordx4 v195, s[4:7], s36 offen offset:3072 lds
    ds_read_b64_tr_b16 a[182:183], v202 offset:35936
    v_mfma_f32_16x16x32_bf16 v[144:147], a[160:163], a[128:131], v[144:147]
    ds_read_b64_tr_b16 a[184:185], v201 offset:30848
    v_mfma_f32_16x16x32_bf16 v[184:187], a[160:163], a[132:135], v[184:187]
    s_waitcnt lgkmcnt(9)
    ds_read_b64_tr_b16 a[186:187], v201 offset:35968
    v_mfma_f32_16x16x32_bf16 v[148:151], a[164:167], a[128:131], v[148:151]
    ds_read_b64_tr_b16 a[188:189], v202 offset:30880
    v_mfma_f32_16x16x32_bf16 v[188:191], a[164:167], a[132:135], v[188:191]
    s_waitcnt lgkmcnt(9)
    s_add_u32 m0, s38, 0x11000
    ds_read_b64_tr_b16 a[190:191], v202 offset:36000
    v_mfma_f32_16x16x32_bf16 v[112:115], a[168:171], a[136:139], v[112:115]
    buffer_load_dwordx4 v196, s[4:7], s36 offen offset:0 lds
    ds_read_b64_tr_b16 a[160:161], v201 offset:30912
    v_mfma_f32_16x16x32_bf16 v[152:155], a[168:171], a[140:143], v[152:155]
    s_waitcnt lgkmcnt(9)
    s_add_u32 s36, s36, 0x14000
    ds_read_b64_tr_b16 a[162:163], v201 offset:36032
    v_mfma_f32_16x16x32_bf16 v[116:119], a[172:175], a[136:139], v[116:119]
    ds_read_b64_tr_b16 a[164:165], v202 offset:30944
    v_mfma_f32_16x16x32_bf16 v[156:159], a[172:175], a[140:143], v[156:159]
    s_waitcnt lgkmcnt(9)
    ds_read_b64_tr_b16 a[166:167], v202 offset:36064
    v_mfma_f32_16x16x32_bf16 v[120:123], a[176:179], a[136:139], v[120:123]
    buffer_load_dwordx4 a[224:227], v197, s[8:11], s37 offen offset:0 sc1
    ds_read_b64_tr_b16 a[168:169], v201 offset:30976
    v_mfma_f32_16x16x32_bf16 v[160:163], a[176:179], a[140:143], v[160:163]
    s_waitcnt lgkmcnt(9)
    ds_read_b64_tr_b16 a[170:171], v201 offset:36096
    v_mfma_f32_16x16x32_bf16 v[124:127], a[180:183], a[136:139], v[124:127]
    ds_read_b64_tr_b16 a[172:173], v202 offset:31008
    v_mfma_f32_16x16x32_bf16 v[164:167], a[180:183], a[140:143], v[164:167]
    s_waitcnt lgkmcnt(9)
    s_cmp_eq_u32 s44, 10
    s_cbranch_scc1 P3w4_25
    s_cmp_eq_u32 s44, 16
    s_cbranch_scc1 P3w4_25
    s_cmp_eq_u32 s44, 4
    s_cbranch_scc1 P3w4_26
    s_waitcnt vmcnt(24)
P3w4_25:
    s_waitcnt vmcnt(25)
P3w4_26:
    s_waitcnt vmcnt(26)
    s_barrier
    ds_read_b64_tr_b16 a[174:175], v202 offset:36128
    v_mfma_f32_16x16x32_bf16 v[128:131], a[184:187], a[136:139], v[128:131]
    ds_read_b64_tr_b16 a[176:177], v199 offset:40960
    v_mfma_f32_16x16x32_bf16 v[168:171], a[184:187], a[140:143], v[168:171]
    s_waitcnt lgkmcnt(9)
    buffer_load_dwordx4 a[228:231], v197, s[8:11], s37 offen offset:1024 sc1
    ds_read_b64_tr_b16 a[178:179], v199 offset:46080
    v_mfma_f32_16x16x32_bf16 v[132:135], a[188:191], a[136:139], v[132:135]
    ds_read_b64_tr_b16 a[180:181], v200 offset:40992
    v_mfma_f32_16x16x32_bf16 v[172:175], a[188:191], a[140:143], v[172:175]
    s_waitcnt lgkmcnt(9)
    ds_read_b64_tr_b16 a[182:183], v200 offset:46112
    v_mfma_f32_16x16x32_bf16 v[136:139], a[160:163], a[136:139], v[136:139]
    ds_read_b64_tr_b16 a[184:185], v199 offset:41024
    v_mfma_f32_16x16x32_bf16 v[176:179], a[160:163], a[140:143], v[176:179]
    s_waitcnt lgkmcnt(9)
    buffer_load_dwordx4 a[232:235], v198, s[8:11], s37 offen offset:0 sc1
    ds_read_b64_tr_b16 a[186:187], v199 offset:46144
    v_mfma_f32_16x16x32_bf16 v[140:143], a[164:167], a[136:139], v[140:143]
    ds_read_b64_tr_b16 a[188:189], v200 offset:41056
    v_mfma_f32_16x16x32_bf16 v[180:183], a[164:167], a[140:143], v[180:183]
    s_waitcnt lgkmcnt(9)
    ds_read_b64_tr_b16 a[190:191], v200 offset:46176
    v_mfma_f32_16x16x32_bf16 v[144:147], a[168:171], a[136:139], v[144:147]
    s_add_u32 s44, s44, 1
    ds_read_b64_tr_b16 a[160:161], v199 offset:41088
    v_mfma_f32_16x16x32_bf16 v[184:187], a[168:171], a[140:143], v[184:187]
    s_waitcnt lgkmcnt(9)
    ds_read_b64_tr_b16 a[162:163], v199 offset:46208
    v_mfma_f32_16x16x32_bf16 v[148:151], a[172:175], a[136:139], v[148:151]
    buffer_load_dwordx4 a[236:239], v198, s[8:11], s37 offen offset:1024 sc1
    ds_read_b64_tr_b16 a[164:165], v200 offset:41120
    v_mfma_f32_16x16x32_bf16 v[188:191], a[172:175], a[140:143], v[188:191]
    s_waitcnt lgkmcnt(9)
    s_add_u32 s37, s37, 0x40000
    ds_read_b64_tr_b16 a[166:167], v200 offset:46240
    s_cmp_eq_u32 s44, 23
    s_cbranch_scc1 P3_fin
P3_t5:
    s_cmp_eq_u32 s44, 5
    s_cbranch_scc1 P3_side5
P3_u5:
    v_mfma_f32_16x16x32_bf16 v[112:115], a[176:179], a[144:147], v[112:115]
    ds_read_b64_tr_b16 a[168:169], v199 offset:41152
    v_mfma_f32_16x16x32_bf16 v[152:155], a[176:179], a[148:151], v[152:155]
    s_waitcnt lgkmcnt(9)
    s_add_u32 m0, s38, 0x5000
    ds_read_b64_tr_b16 a[170:171], v199 offset:46272
    v_mfma_f32_16x16x32_bf16 v[116:119], a[180:183], a[144:147], v[116:119]
    buffer_load_dwordx4 v192, s[4:7], s36 offen offset:0 lds
    ds_read_b64_tr_b16 a[172:173], v200 offset:41184
    v_mfma_f32_16x16x32_bf16 v[156:159], a[180:183], a[148:151], v[156:159]
    s_waitcnt lgkmcnt(9)
    ds_read_b64_tr_b16 a[174:175], v200 offset:46304
    v_mfma_f32_16x16x32_bf16 v[120:123], a[184:187], a[144:147], v[120:123]
    ds_read_b64_tr_b16 a[176:177], v199 offset:41216
    v_mfma_f32_16x16x32_bf16 v[160:163], a[184:187], a[148:151], v[160:163]
    s_waitcnt lgkmcnt(9)
    ds_read_b64_tr_b16 a[178:179], v199 offset:46336
    v_mfma_f32_16x16x32_bf16 v[124:127], a[188:191], a[144:147], v[124:127]
    buffer_load_dwordx4 v193, s[4:7], s36 offen offset:1024 lds
    ds_read_b64_tr_b16 a[180:181], v200 offset:41248
    v_mfma_f32_16x16x32_bf16 v[164:167], a[188:191], a[148:151], v[164:167]
    s_waitcnt lgkmcnt(9)
    ds_read_b64_tr_b16 a[182:183], v200 offset:46368
    v_mfma_f32_16x16x32_bf16 v[128:131], a[160:163], a[144:147], v[128:131]
    ds_read_b64_tr_b16 a[184:185], v199 offset:51200
    v_mfma_f32_16x16x32_bf16 v[168:171], a[160:163], a[148:151], v[168:171]
    s_waitcnt lgkmcnt(9)
    ds_read_b64_tr_b16 a[186:187], v199 offset:56320
    v_mfma_f32_16x16x32_bf16 v[132:135], a[164:167], a[144:147], v[132:135]
    ds_read_b64_tr_b16 a[188:189], v200 offset:51232
    v_mfma_f32_16x16x32_bf16 v[172:175], a[164:167], a[148:151], v[172:175]
    s_waitcnt lgkmcnt(9)
    buffer_load_dwordx4 v194, s[4:7], s36 offen offset:2048 lds
    ds_read_b64_tr_b16 a[190:191], v200 offset:56352
    v_mfma_f32_16x16x32_bf16 v[136:139], a[168:171], a[144:147], v[136:139]
    ds_read_b64_tr_b16 a[160:161], v199 offset:51264
    v_mfma_f32_16x16x32_bf16 v[176:179], a[168:171], a[148:151], v[176:179]
    s_waitcnt lgkmcnt(9)
    ds_read_b64_tr_b16 a[162:163], v199 offset:56384
    v_mfma_f32_16x16x32_bf16 v[140:143], a[172:175], a[144:147], v[140:143]
    ds_read_b64_tr_b16 a[164:165], v200 offset:51296
    v_mfma_f32_16x16x32_bf16 v[180:183], a[172:175], a[148:151], v[180:183]
    s_waitcnt lgkmcnt(9)
    buffer_load_dwordx4 v195, s[4:7], s36 offen offset:3072 lds
    ds_read_b64_tr_b16 a[166:167], v200 offset:56416
    v_mfma_f32_16x16x32_bf16 v[144:147], a[176:179], a[144:147], v[144:147]
    ds_read_b64_tr_b16 a[168:169], v199 offset:51328
    v_mfma_f32_16x16x32_bf16 v[184:187], a[176:179], a[148:151], v[184:187]
    s_waitcnt lgkmcnt(9)
    ds_read_b64_tr_b16 a[170:171], v199 offset:56448
    v_mfma_f32_16x16x32_bf16 v[148:151], a[180:183], a[144:147], v[148:151]
    ds_read_b64_tr_b16 a[172:173], v200 offset:51360
    v_mfma_f32_16x16x32_bf16 v[188:191], a[180:183], a[148:151], v[188:191]
    s_waitcnt lgkmcnt(9)
    s_add_u32 m0, s38, 0x6000
    ds_read_b64_tr_b16 a[174:175], v200 offset:56480
    v_mfma_f32_16x16x32_bf16 v[112:115], a[184:187], a[152:155], v[112:115]
    buffer_load_dwordx4 v196, s[4:7], s36 offen offset:0 lds
    ds_read_b64_tr_b16 a[176:177], v199 offset:51392
    v_mfma_f32_16x16x32_bf16 v[152:155], a[184:187], a[156:159], v[152:155]
    s_waitcnt lgkmcnt(9)
    s_add_u32 s36, s36, 0x14000
    ds_read_b64_tr_b16 a[178:179], v199 offset:56512
    v_mfma_f32_16x16x32_bf16 v[116:119], a[188:191], a[152:155], v[116:119]
    ds_read_b64_tr_b16 a[180:181], v200 offset:51424
    v_mfma_f32_16x16x32_bf16 v[156:159], a[188:191], a[156:159], v[156:159]
    s_waitcnt lgkmcnt(9)
    ds_read_b64_tr_b16 a[182:183], v200 offset:56544
    v_mfma_f32_16x16x32_bf16 v[120:123], a[160:163], a[152:155], v[120:123]
    buffer_load_dwordx4 a[240:243], v197, s[8:11], s37 offen offset:0 sc1
    ds_read_b64_tr_b16 a[184:185], v199 offset:51456
    v_mfma_f32_16x16x32_bf16 v[160:163], a[160:163], a[156:159], v[160:163]
    s_waitcnt lgkmcnt(9)
    ds_read_b64_tr_b16 a[186:187], v199 offset:56576
    v_mfma_f32_16x16x32_bf16 v[124:127], a[164:167], a[152:155], v[124:127]
    ds_read_b64_tr_b16 a[188:189], v200 offset:51488
    v_mfma_f32_16x16x32_bf16 v[164:167], a[164:167], a[156:159], v[164:167]
    s_waitcnt lgkmcnt(9)
    s_cmp_eq_u32 s44, 5
    s_cbranch_scc1 P3w5_33
    s_waitcnt vmcnt(24)
P3w5_33:
    s_waitcnt vmcnt(33)
    s_barrier
    ds_read_b64_tr_b16 a[190:191], v200 offset:56608
    v_mfma_f32_16x16x32_bf16 v[128:131], a[168:171], a[152:155], v[128:131]
    ds_read_b64_tr_b16 a[160:161], v213 offset:0
    v_mfma_f32_16x16x32_bf16 v[168:171], a[168:171], a[156:159], v[168:171]
    s_waitcnt lgkmcnt(9)
    buffer_load_dwordx4 a[244:247], v197, s[8:11], s37 offen offset:1024 sc1
    ds_read_b64_tr_b16 a[162:163], v213 offset:5120
    v_mfma_f32_16x16x32_bf16 v[132:135], a[172:175], a[152:155], v[132:135]
    ds_read_b64_tr_b16 a[164:165], v214 offset:32
    v_mfma_f32_16x16x32_bf16 v[172:175], a[172:175], a[156:159], v[172:175]
    s_waitcnt lgkmcnt(9)
    ds_read_b64_tr_b16 a[166:167], v214 offset:5152
    v_mfma_f32_16x16x32_bf16 v[136:139], a[176:179], a[152:155], v[136:139]
    ds_read_b64_tr_b16 a[168:169], v213 offset:64
    v_mfma_f32_16x16x32_bf16 v[176:179], a[176:179], a[156:159], v[176:179]
    s_waitcnt lgkmcnt(9)
    buffer_load_dwordx4 a[248:251], v198, s[8:11], s37 offen offset:0 sc1
    ds_read_b64_tr_b16 a[170:171], v213 offset:5184
    v_mfma_f32_16x16x32_bf16 v[140:143], a[180:183], a[152:155], v[140:143]
    ds_read_b64_tr_b16 a[172:173], v214 offset:96
    v_mfma_f32_16x16x32_bf16 v[180:183], a[180:183], a[156:159], v[180:183]
    s_waitcnt lgkmcnt(9)
    ds_read_b64_tr_b16 a[174:175], v214 offset:5216
    v_mfma_f32_16x16x32_bf16 v[144:147], a[184:187], a[152:155], v[144:147]
    s_add_u32 s44, s44, 1
    ds_read_b64_tr_b16 a[176:177], v213 offset:128
    v_mfma_f32_16x16x32_bf16 v[184:187], a[184:187], a[156:159], v[184:187]
    s_waitcnt lgkmcnt(9)
    ds_read_b64_tr_b16 a[178:179], v213 offset:5248
    v_mfma_f32_16x16x32_bf16 v[148:151], a[188:191], a[152:155], v[148:151]
    buffer_load_dwordx4 a[252:255], v198, s[8:11], s37 offen offset:1024 sc1
    ds_read_b64_tr_b16 a[180:181], v214 offset:160
    v_mfma_f32_16x16x32_bf16 v[188:191], a[188:191], a[156:159], v[188:191]
    s_waitcnt lgkmcnt(9)
    s_add_u32 s37, s37, 0x40000
    ds_read_b64_tr_b16 a[182:183], v214 offset:5280
    s_branch P3_loop
P3_bound:
    s_nop 7
    v_cvt_pk_bf16_f32 v96, v112, v113
    v_cvt_pk_bf16_f32 v97, v114, v115
    v_cvt_pk_bf16_f32 v98, v116, v117
    v_cvt_pk_bf16_f32 v99, v118, v119
    s_add_u32 s54, s45, 0
    v_mov_b32 v112, 0
    v_permlane32_swap_b32 v96, v98
    v_permlane32_swap_b32 v97, v99
    v_mov_b32 v113, 0
    v_mov_b32 v114, 0
    v_permlane16_swap_b32 v96, v98
    v_permlane16_swap_b32 v97, v99
    v_mov_b32 v115, 0
    buffer_store_dwordx4 v[96:99], v203, s[12:15], s54 offen sc1
    v_mov_b32 v116, 0
    v_mov_b32 v117, 0
    v_mov_b32 v118, 0
    v_mov_b32 v119, 0
    v_cvt_pk_bf16_f32 v100, v120, v121
    v_cvt_pk_bf16_f32 v101, v122, v123
    v_cvt_pk_bf16_f32 v102, v124, v125
    v_cvt_pk_bf16_f32 v103, v126, v127
    s_add_u32 s54, s45, 0x1000
    v_mov_b32 v120, 0
    v_permlane32_swap_b32 v100, v102
    v_permlane32_swap_b32 v101, v103
    v_mov_b32 v121, 0
    v_mov_b32 v122, 0
    v_permlane16_swap_b32 v100, v102
    v_permlane16_swap_b32 v101, v103
    v_mov_b32 v123, 0
    buffer_store_dwordx4 v[100:103], v203, s[12:15], s54 offen sc1
    v_mov_b32 v124, 0
    v_mov_b32 v125, 0
    v_mov_b32 v126, 0
    v_mov_b32 v127, 0
    v_cvt_pk_bf16_f32 v104, v128, v129
    v_cvt_pk_bf16_f32 v105, v130, v131
    v_cvt_pk_bf16_f32 v106, v132, v133
    v_cvt_pk_bf16_f32 v107, v134, v135
    s_add_u32 s54, s45, 0x2000
    v_mov_b32 v128, 0
    v_permlane32_swap_b32 v104, v106
    v_permlane32_swap_b32 v105, v107
    v_mov_b32 v129, 0
    v_mov_b32 v130, 0
    v_permlane16_swap_b32 v104, v106
    v_permlane16_swap_b32 v105, v107
    v_mov_b32 v131, 0
    buffer_store_dwordx4 v[104:107], v203, s[12:15], s54 offen sc1
    v_mov_b32 v132, 0
    v_mov_b32 v133, 0
    v_mov_b32 v134, 0
    v_mov_b32 v135, 0
    v_cvt_pk_bf16_f32 v96, v136, v137
    v_cvt_pk_bf16_f32 v97, v138, v139
    v_cvt_pk_bf16_f32 v98, v140, v141
    v_cvt_pk_bf16_f32 v99, v142, v143
    s_add_u32 s54, s45, 0x3000
    v_mov_b32 v136, 0
    v_permlane32_swap_b32 v96, v98
    v_permlane32_swap_b32 v97, v99
    v_mov_b32 v137, 0
    v_mov_b32 v138, 0
    v_permlane16_swap_b32 v96, v98
    v_permlane16_swap_b32 v97, v99
    v_mov_b32 v139, 0
    buffer_store_dwordx4 v[96:99], v203, s[12:15], s54 offen sc1
    v_mov_b32 v140, 0
    v_mov_b32 v141, 0
    v_mov_b32 v142, 0
    v_mov_b32 v143, 0
    v_cvt_pk_bf16_f32 v100, v144, v145
    v_cvt_pk_bf16_f32 v101, v146, v147
    v_cvt_pk_bf16_f32 v102, v148, v149
    v_cvt_pk_bf16_f32 v103, v150, v151
    s_add_u32 s54, s45, 0x4000
    v_mov_b32 v144, 0
    v_permlane32_swap_b32 v100, v102
    v_permlane32_swap_b32 v101, v103
    v_mov_b32 v145, 0
    v_mov_b32 v146, 0
    v_permlane16_swap_b32 v100, v102
    v_permlane16_swap_b32 v101, v103
    v_mov_b32 v147, 0
    buffer_store_dwordx4 v[100:103], v203, s[12:15], s54 offen sc1
    v_mov_b32 v148, 0
    v_mov_b32 v149, 0
    v_mov_b32 v150, 0
    v_mov_b32 v151, 0
    v_cvt_pk_bf16_f32 v104, v152, v153
    v_cvt_pk_bf16_f32 v105, v154, v155
    v_cvt_pk_bf16_f32 v106, v156, v157
    v_cvt_pk_bf16_f32 v107, v158, v159
    s_add_u32 s54, s45, 0x5000
    v_mov_b32 v152, 0
    v_permlane32_swap_b32 v104, v106
    v_permlane32_swap_b32 v105, v107
    v_mov_b32 v153, 0
    v_mov_b32 v154, 0
    v_permlane16_swap_b32 v104, v106
    v_permlane16_swap_b32 v105, v107
    v_mov_b32 v155, 0
    buffer_store_dwordx4 v[104:107], v203, s[12:15], s54 offen sc1
    v_mov_b32 v156, 0
    v_mov_b32 v157, 0
    v_mov_b32 v158, 0
    v_mov_b32 v159, 0
    v_cvt_pk_bf16_f32 v96, v160, v161
    v_cvt_pk_bf16_f32 v97, v162, v163
    v_cvt_pk_bf16_f32 v98, v164, v165
    v_cvt_pk_bf16_f32 v99, v166, v167
    s_add_u32 s54, s45, 0x6000
    v_mov_b32 v160, 0
    v_permlane32_swap_b32 v96, v98
    v_permlane32_swap_b32 v97, v99
    v_mov_b32 v161, 0
    v_mov_b32 v162, 0
    v_permlane16_swap_b32 v96, v98
    v_permlane16_swap_b32 v97, v99
    v_mov_b32 v163, 0
    buffer_store_dwordx4 v[96:99], v203, s[12:15], s54 offen sc1
    v_mov_b32 v164, 0
    v_mov_b32 v165, 0
    v_mov_b32 v166, 0
    v_mov_b32 v167, 0
    v_cvt_pk_bf16_f32 v100, v168, v169
    v_cvt_pk_bf16_f32 v101, v170, v171
    v_cvt_pk_bf16_f32 v102, v172, v173
    v_cvt_pk_bf16_f32 v103, v174, v175
    s_add_u32 s54, s45, 0x7000
    v_mov_b32 v168, 0
    v_permlane32_swap_b32 v100, v102
    v_permlane32_swap_b32 v101, v103
    v_mov_b32 v169, 0
    v_mov_b32 v170, 0
    v_permlane16_swap_b32 v100, v102
    v_permlane16_swap_b32 v101, v103
    v_mov_b32 v171, 0
    buffer_store_dwordx4 v[100:103], v203, s[12:15], s54 offen sc1
    v_mov_b32 v172, 0
    v_mov_b32 v173, 0
    v_mov_b32 v174, 0
    v_mov_b32 v175, 0
    v_cvt_pk_bf16_f32 v104, v176, v177
    v_cvt_pk_bf16_f32 v105, v178, v179
    v_cvt_pk_bf16_f32 v106, v180, v181
    v_cvt_pk_bf16_f32 v107, v182, v183
    s_add_u32 s54, s45, 0x8000
    v_mov_b32 v176, 0
    v_permlane32_swap_b32 v104, v106
    v_permlane32_swap_b32 v105, v107
    v_mov_b32 v177, 0
    v_mov_b32 v178, 0
    v_permlane16_swap_b32 v104, v106
    v_permlane16_swap_b32 v105, v107
    v_mov_b32 v179, 0
    buffer_store_dwordx4 v[104:107], v203, s[12:15], s54 offen sc1
    v_mov_b32 v180, 0
    v_mov_b32 v181, 0
    v_mov_b32 v182, 0
    v_mov_b32 v183, 0
    v_cvt_pk_bf16_f32 v96, v184, v185
    v_cvt_pk_bf16_f32 v97, v186, v187
    v_cvt_pk_bf16_f32 v98, v188, v189
    v_cvt_pk_bf16_f32 v99, v190, v191
    s_add_u32 s54, s45, 0x9000
    v_mov_b32 v184, 0
    v_permlane32_swap_b32 v96, v98
    v_permlane32_swap_b32 v97, v99
    v_mov_b32 v185, 0
    v_mov_b32 v186, 0
    v_permlane16_swap_b32 v96, v98
    v_permlane16_swap_b32 v97, v99
    v_mov_b32 v187, 0
    buffer_store_dwordx4 v[96:99], v203, s[12:15], s54 offen sc1
    v_mov_b32 v188, 0
    v_mov_b32 v189, 0
    v_mov_b32 v190, 0
    v_mov_b32 v191, 0
    s_sub_u32 s45, s45, 0xc00000
    s_nop 1
    s_branch P3_t1
P3_side4:
    s_mov_b64 exec, s[50:51]
    buffer_load_dword v111, v110, s[96:99], 0 offen sc1
    s_mov_b64 exec, -1
    s_branch P3_u4
P3_side5:
    s_waitcnt vmcnt(9)
    v_subrev_u32 v111, s78, v111
    v_subrev_u32 v111, 3, v111
    v_cmp_ge_u32 vcc, 4, v111
    s_nop 3
    s_and_b64 s[100:101], vcc, s[50:51]
    s_cmp_eq_u64 s[100:101], s[50:51]
    s_cbranch_scc1 P3_opoll_ok
    s_mov_b32 s79, 0x10000
P3_opoll:
    s_mov_b64 exec, s[50:51]
    buffer_load_dword v111, v110, s[96:99], 0 offen sc1
    s_mov_b64 exec, -1
    s_waitcnt vmcnt(0)
    v_subrev_u32 v111, s78, v111
    v_subrev_u32 v111, 3, v111
    v_cmp_ge_u32 vcc, 4, v111
    s_nop 3
    s_and_b64 s[100:101], vcc, s[50:51]
    s_cmp_eq_u64 s[100:101], s[50:51]
    s_cbranch_scc1 P3_opoll_ok
    s_sub_u32 s79, s79, 1
    s_cmp_lg_u32 s79, 0
    s_cbranch_scc1 P3_opoll
P3_opoll_ok:
    s_add_u32 s8, s64, 0x1000000
    s_addc_u32 s9, s65, 0
    s_mov_b32 s10, 0x1000000
    s_mov_b32 s11, 0x20000
    s_mul_i32 s37, s46, 0x400000
    buffer_load_dwordx4 a[208:211], v197, s[8:11], s37 offen offset:0 sc1
    buffer_load_dwordx4 a[212:215], v197, s[8:11], s37 offen offset:1024 sc1
    buffer_load_dwordx4 a[216:219], v198, s[8:11], s37 offen offset:0 sc1
    buffer_load_dwordx4 a[220:223], v198, s[8:11], s37 offen offset:1024 sc1
    s_add_u32 s37, s37, 0x40000
    buffer_load_dwordx4 a[224:227], v197, s[8:11], s37 offen offset:0 sc1
    buffer_load_dwordx4 a[228:231], v197, s[8:11], s37 offen offset:1024 sc1
    buffer_load_dwordx4 a[232:235], v198, s[8:11], s37 offen offset:0 sc1
    buffer_load_dwordx4 a[236:239], v198, s[8:11], s37 offen offset:1024 sc1
    s_add_u32 s37, s37, 0x40000
    s_and_b32 s54, s2, 28
    s_lshl_b32 s50, 15, s54
    s_mov_b32 s51, 0
    s_branch P3_u5
P3_side18:
    s_mov_b64 exec, s[50:51]
    buffer_load_dword v111, v110, s[96:99], 0 offen sc1
    s_mov_b64 exec, -1
    s_branch P3_u0
P3_side19:
    s_waitcnt vmcnt(9)
    v_subrev_u32 v111, s78, v111
    v_subrev_u32 v111, 4, v111
    v_cmp_ge_u32 vcc, 3, v111
    s_nop 3
    s_and_b64 s[100:101], vcc, s[50:51]
    s_cmp_eq_u64 s[100:101], s[50:51]
    s_cbranch_scc1 P3_mpoll_ok
    s_mov_b32 s79, 0x10000
P3_mpoll:
    s_mov_b64 exec, s[50:51]
    buffer_load_dword v111, v110, s[96:99], 0 offen sc1
    s_mov_b64 exec, -1
    s_waitcnt vmcnt(0)
    v_subrev_u32 v111, s78, v111
    v_subrev_u32 v111, 4, v111
    v_cmp_ge_u32 vcc, 3, v111
    s_nop 3
    s_and_b64 s[100:101], vcc, s[50:51]
    s_cmp_eq_u64 s[100:101], s[50:51]
    s_cbranch_scc1 P3_mpoll_ok
    s_sub_u32 s79, s79, 1
    s_cmp_lg_u32 s79, 0
    s_cbranch_scc1 P3_mpoll
P3_mpoll_ok:
    v_and_b32 v240, 63, v0
    s_mov_b32 s16, s70
    s_mov_b32 s17, s71
    s_mov_b32 s18, 0x280000
    s_mov_b32 s19, 0x20000
    s_mov_b32 s20, s72
    s_mov_b32 s21, s73
    s_mov_b32 s22, 0x280000
    s_mov_b32 s23, 0x20000
    s_mov_b32 s28, s74
    s_mov_b32 s29, s75
    s_mov_b32 s30, 0x500
    s_mov_b32 s31, 0x20000
    s_lshl_b32 s54, s48, 4
    s_lshl_b32 s55, s46, 5
    s_add_u32 s54, s54, s55
    v_and_b32 v241, 15, v240
    v_add_u32 v241, s54, v241
    v_mul_u32_u24 v241, 0x500, v241
    v_lshrrev_b32 v242, 4, v240
    v_lshlrev_b32 v242, 4, v242
    s_mul_i32 s55, s47, 0x140
    v_add_u32 v242, s55, v242
    s_and_b32 s42, s2, 0xfc
    s_add_u32 s42, s42, s46
    s_mul_i32 s42, s42, 0xa000
    s_add_u32 s54, s41, 0
    s_cmp_ge_u32 s54, 5
    s_cselect_b32 s43, 0x5000, 0
    s_cselect_b32 s49, 5, 0
    s_sub_u32 s49, s54, s49
    s_lshl_b32 s49, s49, 6
    s_cmp_ge_u32 s54, 10
    s_cselect_b32 s53, 0x40000000, 0
    s_add_u32 s49, s49, s53
    v_add_u32 v207, s49, v242
    v_add_u32 v204, s43, v241
    v_add_u32 v204, v204, v207
    s_lshl_b32 s54, s54, 12
    s_add_u32 s54, s54, s42
    s_add_u32 s54, s54, s53
    v_lshlrev_b32 v210, 4, v240
    v_add_u32 v210, s54, v210
    s_add_u32 s54, s41, 4
    s_cmp_ge_u32 s54, 5
    s_cselect_b32 s43, 0x5000, 0
    s_cselect_b32 s49, 5, 0
    s_sub_u32 s49, s54, s49
    s_lshl_b32 s49, s49, 6
    s_cmp_ge_u32 s54, 10
    s_cselect_b32 s53, 0x40000000, 0
    s_add_u32 s49, s49, s53
    v_add_u32 v208, s49, v242
    v_add_u32 v205, s43, v241
    v_add_u32 v205, v205, v208
    s_lshl_b32 s54, s54, 12
    s_add_u32 s54, s54, s42
    s_add_u32 s54, s54, s53
    v_lshlrev_b32 v211, 4, v240
    v_add_u32 v211, s54, v211
    s_add_u32 s54, s41, 8
    s_cmp_ge_u32 s54, 5
    s_cselect_b32 s43, 0x5000, 0
    s_cselect_b32 s49, 5, 0
    s_sub_u32 s49, s54, s49
    s_lshl_b32 s49, s49, 6
    s_cmp_ge_u32 s54, 10
    s_cselect_b32 s53, 0x40000000, 0
    s_add_u32 s49, s49, s53
    v_add_u32 v209, s49, v242
    v_add_u32 v206, s43, v241
    v_add_u32 v206, v206, v209
    s_lshl_b32 s54, s54, 12
    s_add_u32 s54, s54, s42
    s_add_u32 s54, s54, s53
    v_lshlrev_b32 v212, 4, v240
    v_add_u32 v212, s54, v212
    s_mov_b32 s49, 0xc00000
    buffer_load_dwordx4 v[40:43], v210, s[12:15], s49 offen offset:0 sc1
    buffer_load_dwordx4 v[44:47], v210, s[12:15], s49 offen offset:1024 sc1
    buffer_load_dwordx4 v[48:51], v210, s[12:15], s49 offen offset:2048 sc1
    buffer_load_dwordx4 v[52:55], v210, s[12:15], s49 offen offset:3072 sc1
    buffer_load_dwordx4 v[16:19], v204, s[16:19], 0 offen
    buffer_load_dwordx4 v[28:31], v207, s[28:31], 0 offen
    buffer_load_dwordx4 v[56:59], v211, s[12:15], s49 offen offset:0 sc1
    buffer_load_dwordx4 v[60:63], v211, s[12:15], s49 offen offset:1024 sc1
    buffer_load_dwordx4 v[64:67], v211, s[12:15], s49 offen offset:2048 sc1
    buffer_load_dwordx4 v[68:71], v211, s[12:15], s49 offen offset:3072 sc1
    buffer_load_dwordx4 v[20:23], v205, s[16:19], 0 offen
    buffer_load_dwordx4 v[32:35], v208, s[28:31], 0 offen
    buffer_load_dwordx4 v[72:75], v212, s[12:15], s49 offen offset:0 sc1
    buffer_load_dwordx4 v[76:79], v212, s[12:15], s49 offen offset:1024 sc1
    buffer_load_dwordx4 v[80:83], v212, s[12:15], s49 offen offset:2048 sc1
    buffer_load_dwordx4 v[84:87], v212, s[12:15], s49 offen offset:3072 sc1
    buffer_load_dwordx4 v[24:27], v206, s[16:19], 0 offen
    buffer_load_dwordx4 v[36:39], v209, s[28:31], 0 offen
    s_branch P3_u1
P3_fin:
    s_nop 7
    v_cvt_pk_bf16_f32 v96, v112, v113
    v_cvt_pk_bf16_f32 v97, v114, v115
    v_cvt_pk_bf16_f32 v98, v116, v117
    v_cvt_pk_bf16_f32 v99, v118, v119
    s_add_u32 s54, s45, 0
    s_nop 0
    v_permlane32_swap_b32 v96, v98
    v_permlane32_swap_b32 v97, v99
    s_nop 1
    v_permlane16_swap_b32 v96, v98
    v_permlane16_swap_b32 v97, v99
    buffer_store_dwordx4 v[96:99], v203, s[12:15], s54 offen sc1
    v_cvt_pk_bf16_f32 v100, v120, v121
    v_cvt_pk_bf16_f32 v101, v122, v123
    v_cvt_pk_bf16_f32 v102, v124, v125
    v_cvt_pk_bf16_f32 v103, v126, v127
    s_add_u32 s54, s45, 0x1000
    s_nop 0
    v_permlane32_swap_b32 v100, v102
    v_permlane32_swap_b32 v101, v103
    s_nop 1
    v_permlane16_swap_b32 v100, v102
    v_permlane16_swap_b32 v101, v103
    buffer_store_dwordx4 v[100:103], v203, s[12:15], s54 offen sc1
    v_cvt_pk_bf16_f32 v104, v128, v129
    v_cvt_pk_bf16_f32 v105, v130, v131
    v_cvt_pk_bf16_f32 v106, v132, v133
    v_cvt_pk_bf16_f32 v107, v134, v135
    s_add_u32 s54, s45, 0x2000
    s_nop 0
    v_permlane32_swap_b32 v104, v106
    v_permlane32_swap_b32 v105, v107
    s_nop 1
    v_permlane16_swap_b32 v104, v106
    v_permlane16_swap_b32 v105, v107
    buffer_store_dwordx4 v[104:107], v203, s[12:15], s54 offen sc1
    v_cvt_pk_bf16_f32 v96, v136, v137
    v_cvt_pk_bf16_f32 v97, v138, v139
    v_cvt_pk_bf16_f32 v98, v140, v141
    v_cvt_pk_bf16_f32 v99, v142, v143
    s_add_u32 s54, s45, 0x3000
    s_nop 0
    v_permlane32_swap_b32 v96, v98
    v_permlane32_swap_b32 v97, v99
    s_nop 1
    v_permlane16_swap_b32 v96, v98
    v_permlane16_swap_b32 v97, v99
    buffer_store_dwordx4 v[96:99], v203, s[12:15], s54 offen sc1
    v_cvt_pk_bf16_f32 v100, v144, v145
    v_cvt_pk_bf16_f32 v101, v146, v147
    v_cvt_pk_bf16_f32 v102, v148, v149
    v_cvt_pk_bf16_f32 v103, v150, v151
    s_add_u32 s54, s45, 0x4000
    s_nop 0
    v_permlane32_swap_b32 v100, v102
    v_permlane32_swap_b32 v101, v103
    s_nop 1
    v_permlane16_swap_b32 v100, v102
    v_permlane16_swap_b32 v101, v103
    buffer_store_dwordx4 v[100:103], v203, s[12:15], s54 offen sc1
    v_cvt_pk_bf16_f32 v104, v152, v153
    v_cvt_pk_bf16_f32 v105, v154, v155
    v_cvt_pk_bf16_f32 v106, v156, v157
    v_cvt_pk_bf16_f32 v107, v158, v159
    s_add_u32 s54, s45, 0x5000
    s_nop 0
    v_permlane32_swap_b32 v104, v106
    v_permlane32_swap_b32 v105, v107
    s_nop 1
    v_permlane16_swap_b32 v104, v106
    v_permlane16_swap_b32 v105, v107
    buffer_store_dwordx4 v[104:107], v203, s[12:15], s54 offen sc1
    v_cvt_pk_bf16_f32 v96, v160, v161
    v_cvt_pk_bf16_f32 v97, v162, v163
    v_cvt_pk_bf16_f32 v98, v164, v165
    v_cvt_pk_bf16_f32 v99, v166, v167
    s_add_u32 s54, s45, 0x6000
    s_nop 0
    v_permlane32_swap_b32 v96, v98
    v_permlane32_swap_b32 v97, v99
    s_nop 1
    v_permlane16_swap_b32 v96, v98
    v_permlane16_swap_b32 v97, v99
    buffer_store_dwordx4 v[96:99], v203, s[12:15], s54 offen sc1
    v_cvt_pk_bf16_f32 v100, v168, v169
    v_cvt_pk_bf16_f32 v101, v170, v171
    v_cvt_pk_bf16_f32 v102, v172, v173
    v_cvt_pk_bf16_f32 v103, v174, v175
    s_add_u32 s54, s45, 0x7000
    s_nop 0
    v_permlane32_swap_b32 v100, v102
    v_permlane32_swap_b32 v101, v103
    s_nop 1
    v_permlane16_swap_b32 v100, v102
    v_permlane16_swap_b32 v101, v103
    buffer_store_dwordx4 v[100:103], v203, s[12:15], s54 offen sc1
    v_cvt_pk_bf16_f32 v104, v176, v177
    v_cvt_pk_bf16_f32 v105, v178, v179
    v_cvt_pk_bf16_f32 v106, v180, v181
    v_cvt_pk_bf16_f32 v107, v182, v183
    s_add_u32 s54, s45, 0x8000
    s_nop 0
    v_permlane32_swap_b32 v104, v106
    v_permlane32_swap_b32 v105, v107
    s_nop 1
    v_permlane16_swap_b32 v104, v106
    v_permlane16_swap_b32 v105, v107
    buffer_store_dwordx4 v[104:107], v203, s[12:15], s54 offen sc1
    v_cvt_pk_bf16_f32 v96, v184, v185
    v_cvt_pk_bf16_f32 v97, v186, v187
    v_cvt_pk_bf16_f32 v98, v188, v189
    v_cvt_pk_bf16_f32 v99, v190, v191
    s_add_u32 s54, s45, 0x9000
    s_nop 0
    v_permlane32_swap_b32 v96, v98
    v_permlane32_swap_b32 v97, v99
    s_nop 1
    v_permlane16_swap_b32 v96, v98
    v_permlane16_swap_b32 v97, v99
    buffer_store_dwordx4 v[96:99], v203, s[12:15], s54 offen sc1
    s_waitcnt vmcnt(10)
    s_mov_b32 s54, 0xbfb8aa3b
    v_lshlrev_b32 v216, 16, v40
    v_and_b32 v217, 0xffff0000, v40
    v_lshlrev_b32 v218, 16, v41
    v_and_b32 v219, 0xffff0000, v41
    v_lshlrev_b32 v220, 16, v42
    v_and_b32 v221, 0xffff0000, v42
    v_lshlrev_b32 v222, 16, v43
    v_and_b32 v223, 0xffff0000, v43
    v_lshlrev_b32 v240, 16, v44
    v_and_b32 v241, 0xffff0000, v44
    v_lshlrev_b32 v242, 16, v45
    v_and_b32 v243, 0xffff0000, v45
    v_lshlrev_b32 v244, 16, v46
    v_and_b32 v245, 0xffff0000, v46
    v_lshlrev_b32 v246, 16, v47
    v_and_b32 v247, 0xffff0000, v47
    v_pk_add_f32 v[216:217], v[216:217], v[240:241]
    v_pk_add_f32 v[218:219], v[218:219], v[242:243]
    v_pk_add_f32 v[220:221], v[220:221], v[244:245]
    v_pk_add_f32 v[222:223], v[222:223], v[246:247]
    v_lshlrev_b32 v240, 16, v48
    v_and_b32 v241, 0xffff0000, v48
    v_lshlrev_b32 v242, 16, v49
    v_and_b32 v243, 0xffff0000, v49
    v_lshlrev_b32 v244, 16, v50
    v_and_b32 v245, 0xffff0000, v50
    v_lshlrev_b32 v246, 16, v51
    v_and_b32 v247, 0xffff0000, v51
    v_pk_add_f32 v[216:217], v[216:217], v[240:241]
    v_pk_add_f32 v[218:219], v[218:219], v[242:243]
    v_pk_add_f32 v[220:221], v[220:221], v[244:245]
    v_pk_add_f32 v[222:223], v[222:223], v[246:247]
    v_lshlrev_b32 v240, 16, v52
    v_and_b32 v241, 0xffff0000, v52
    v_lshlrev_b32 v242, 16, v53
    v_and_b32 v243, 0xffff0000, v53
    v_lshlrev_b32 v244, 16, v54
    v_and_b32 v245, 0xffff0000, v54
    v_lshlrev_b32 v246, 16, v55
    v_and_b32 v247, 0xffff0000, v55
    v_pk_add_f32 v[216:217], v[216:217], v[240:241]
    v_pk_add_f32 v[218:219], v[218:219], v[242:243]
    v_pk_add_f32 v[220:221], v[220:221], v[244:245]
    v_pk_add_f32 v[222:223], v[222:223], v[246:247]
    v_lshlrev_b32 v240, 16, v28
    v_and_b32 v241, 0xffff0000, v28
    v_lshlrev_b32 v242, 16, v29
    v_and_b32 v243, 0xffff0000, v29
    v_lshlrev_b32 v244, 16, v30
    v_and_b32 v245, 0xffff0000, v30
    v_lshlrev_b32 v246, 16, v31
    v_and_b32 v247, 0xffff0000, v31
    v_pk_add_f32 v[216:217], v[216:217], v[240:241]
    v_pk_add_f32 v[218:219], v[218:219], v[242:243]
    v_pk_add_f32 v[220:221], v[220:221], v[244:245]
    v_pk_add_f32 v[222:223], v[222:223], v[246:247]
    v_mul_f32 v248, s54, v216
    v_mul_f32 v249, s54, v217
    v_mul_f32 v250, s54, v218
    v_mul_f32 v251, s54, v219
    v_mul_f32 v252, s54, v220
    v_mul_f32 v253, s54, v221
    v_mul_f32 v254, s54, v222
    v_mul_f32 v255, s54, v223
    v_exp_f32 v248, v248
    v_exp_f32 v249, v249
    v_exp_f32 v250, v250
    v_exp_f32 v251, v251
    v_exp_f32 v252, v252
    v_exp_f32 v253, v253
    v_exp_f32 v254, v254
    v_exp_f32 v255, v255
    v_pk_add_f32 v[248:249], v[248:249], 1.0
    v_pk_add_f32 v[250:251], v[250:251], 1.0
    v_pk_add_f32 v[252:253], v[252:253], 1.0
    v_pk_add_f32 v[254:255], v[254:255], 1.0
    v_rcp_f32 v248, v248
    v_rcp_f32 v249, v249
    v_rcp_f32 v250, v250
    v_rcp_f32 v251, v251
    v_rcp_f32 v252, v252
    v_rcp_f32 v253, v253
    v_rcp_f32 v254, v254
    v_rcp_f32 v255, v255
    s_nop 0
    v_pk_mul_f32 v[216:217], v[216:217], v[248:249]
    v_pk_mul_f32 v[218:219], v[218:219], v[250:251]
    v_pk_mul_f32 v[220:221], v[220:221], v[252:253]
    v_pk_mul_f32 v[222:223], v[222:223], v[254:255]
    v_lshlrev_b32 v224, 16, v56
    v_and_b32 v225, 0xffff0000, v56
    v_lshlrev_b32 v226, 16, v57
    v_and_b32 v227, 0xffff0000, v57
    v_lshlrev_b32 v228, 16, v58
    v_and_b32 v229, 0xffff0000, v58
    v_lshlrev_b32 v230, 16, v59
    v_and_b32 v231, 0xffff0000, v59
    v_lshlrev_b32 v240, 16, v60
    v_and_b32 v241, 0xffff0000, v60
    v_lshlrev_b32 v242, 16, v61
    v_and_b32 v243, 0xffff0000, v61
    v_lshlrev_b32 v244, 16, v62
    v_and_b32 v245, 0xffff0000, v62
    v_lshlrev_b32 v246, 16, v63
    v_and_b32 v247, 0xffff0000, v63
    v_pk_add_f32 v[224:225], v[224:225], v[240:241]
    v_pk_add_f32 v[226:227], v[226:227], v[242:243]
    v_pk_add_f32 v[228:229], v[228:229], v[244:245]
    v_pk_add_f32 v[230:231], v[230:231], v[246:247]
    v_lshlrev_b32 v240, 16, v64
    v_and_b32 v241, 0xffff0000, v64
    v_lshlrev_b32 v242, 16, v65
    v_and_b32 v243, 0xffff0000, v65
    v_lshlrev_b32 v244, 16, v66
    v_and_b32 v245, 0xffff0000, v66
    v_lshlrev_b32 v246, 16, v67
    v_and_b32 v247, 0xffff0000, v67
    v_pk_add_f32 v[224:225], v[224:225], v[240:241]
    v_pk_add_f32 v[226:227], v[226:227], v[242:243]
    v_pk_add_f32 v[228:229], v[228:229], v[244:245]
    v_pk_add_f32 v[230:231], v[230:231], v[246:247]
    v_lshlrev_b32 v240, 16, v68
    v_and_b32 v241, 0xffff0000, v68
    v_lshlrev_b32 v242, 16, v69
    v_and_b32 v243, 0xffff0000, v69
    v_lshlrev_b32 v244, 16, v70
    v_and_b32 v245, 0xffff0000, v70
    v_lshlrev_b32 v246, 16, v71
    v_and_b32 v247, 0xffff0000, v71
    v_pk_add_f32 v[224:225], v[224:225], v[240:241]
    v_pk_add_f32 v[226:227], v[226:227], v[242:243]
    v_pk_add_f32 v[228:229], v[228:229], v[244:245]
    v_pk_add_f32 v[230:231], v[230:231], v[246:247]
    v_lshlrev_b32 v240, 16, v32
    v_and_b32 v241, 0xffff0000, v32
    v_lshlrev_b32 v242, 16, v33
    v_and_b32 v243, 0xffff0000, v33
    v_lshlrev_b32 v244, 16, v34
    v_and_b32 v245, 0xffff0000, v34
    v_lshlrev_b32 v246, 16, v35
    v_and_b32 v247, 0xffff0000, v35
    v_pk_add_f32 v[224:225], v[224:225], v[240:241]
    v_pk_add_f32 v[226:227], v[226:227], v[242:243]
    v_pk_add_f32 v[228:229], v[228:229], v[244:245]
    v_pk_add_f32 v[230:231], v[230:231], v[246:247]
    v_mul_f32 v248, s54, v224
    v_mul_f32 v249, s54, v225
    v_mul_f32 v250, s54, v226
    v_mul_f32 v251, s54, v227
    v_mul_f32 v252, s54, v228
    v_mul_f32 v253, s54, v229
    v_mul_f32 v254, s54, v230
    v_mul_f32 v255, s54, v231
    v_exp_f32 v248, v248
    v_exp_f32 v249, v249
    v_exp_f32 v250, v250
    v_exp_f32 v251, v251
    v_exp_f32 v252, v252
    v_exp_f32 v253, v253
    v_exp_f32 v254, v254
    v_exp_f32 v255, v255
    v_pk_add_f32 v[248:249], v[248:249], 1.0
    v_pk_add_f32 v[250:251], v[250:251], 1.0
    v_pk_add_f32 v[252:253], v[252:253], 1.0
    v_pk_add_f32 v[254:255], v[254:255], 1.0
    v_rcp_f32 v248, v248
    v_rcp_f32 v249, v249
    v_rcp_f32 v250, v250
    v_rcp_f32 v251, v251
    v_rcp_f32 v252, v252
    v_rcp_f32 v253, v253
    v_rcp_f32 v254, v254
    v_rcp_f32 v255, v255
    s_nop 0
    v_pk_mul_f32 v[224:225], v[224:225], v[248:249]
    v_pk_mul_f32 v[226:227], v[226:227], v[250:251]
    v_pk_mul_f32 v[228:229], v[228:229], v[252:253]
    v_pk_mul_f32 v[230:231], v[230:231], v[254:255]
    v_lshlrev_b32 v232, 16, v72
    v_and_b32 v233, 0xffff0000, v72
    v_lshlrev_b32 v234, 16, v73
    v_and_b32 v235, 0xffff0000, v73
    v_lshlrev_b32 v236, 16, v74
    v_and_b32 v237, 0xffff0000, v74
    v_lshlrev_b32 v238, 16, v75
    v_and_b32 v239, 0xffff0000, v75
    v_lshlrev_b32 v240, 16, v76
    v_and_b32 v241, 0xffff0000, v76
    v_lshlrev_b32 v242, 16, v77
    v_and_b32 v243, 0xffff0000, v77
    v_lshlrev_b32 v244, 16, v78
    v_and_b32 v245, 0xffff0000, v78
    v_lshlrev_b32 v246, 16, v79
    v_and_b32 v247, 0xffff0000, v79
    v_pk_add_f32 v[232:233], v[232:233], v[240:241]
    v_pk_add_f32 v[234:235], v[234:235], v[242:243]
    v_pk_add_f32 v[236:237], v[236:237], v[244:245]
    v_pk_add_f32 v[238:239], v[238:239], v[246:247]
    v_lshlrev_b32 v240, 16, v80
    v_and_b32 v241, 0xffff0000, v80
    v_lshlrev_b32 v242, 16, v81
    v_and_b32 v243, 0xffff0000, v81
    v_lshlrev_b32 v244, 16, v82
    v_and_b32 v245, 0xffff0000, v82
    v_lshlrev_b32 v246, 16, v83
    v_and_b32 v247, 0xffff0000, v83
    v_pk_add_f32 v[232:233], v[232:233], v[240:241]
    v_pk_add_f32 v[234:235], v[234:235], v[242:243]
    v_pk_add_f32 v[236:237], v[236:237], v[244:245]
    v_pk_add_f32 v[238:239], v[238:239], v[246:247]
    v_lshlrev_b32 v240, 16, v84
    v_and_b32 v241, 0xffff0000, v84
    v_lshlrev_b32 v242, 16, v85
    v_and_b32 v243, 0xffff0000, v85
    v_lshlrev_b32 v244, 16, v86
    v_and_b32 v245, 0xffff0000, v86
    v_lshlrev_b32 v246, 16, v87
    v_and_b32 v247, 0xffff0000, v87
    v_pk_add_f32 v[232:233], v[232:233], v[240:241]
    v_pk_add_f32 v[234:235], v[234:235], v[242:243]
    v_pk_add_f32 v[236:237], v[236:237], v[244:245]
    v_pk_add_f32 v[238:239], v[238:239], v[246:247]
    v_lshlrev_b32 v240, 16, v36
    v_and_b32 v241, 0xffff0000, v36
    v_lshlrev_b32 v242, 16, v37
    v_and_b32 v243, 0xffff0000, v37
    v_lshlrev_b32 v244, 16, v38
    v_and_b32 v245, 0xffff0000, v38
    v_lshlrev_b32 v246, 16, v39
    v_and_b32 v247, 0xffff0000, v39
    v_pk_add_f32 v[232:233], v[232:233], v[240:241]
    v_pk_add_f32 v[234:235], v[234:235], v[242:243]
    v_pk_add_f32 v[236:237], v[236:237], v[244:245]
    v_pk_add_f32 v[238:239], v[238:239], v[246:247]
    v_mul_f32 v248, s54, v232
    v_mul_f32 v249, s54, v233
    v_mul_f32 v250, s54, v234
    v_mul_f32 v251, s54, v235
    v_mul_f32 v252, s54, v236
    v_mul_f32 v253, s54, v237
    v_mul_f32 v254, s54, v238
    v_mul_f32 v255, s54, v239
    v_exp_f32 v248, v248
    v_exp_f32 v249, v249
    v_exp_f32 v250, v250
    v_exp_f32 v251, v251
    v_exp_f32 v252, v252
    v_exp_f32 v253, v253
    v_exp_f32 v254, v254
    v_exp_f32 v255, v255
    v_pk_add_f32 v[248:249], v[248:249], 1.0
    v_pk_add_f32 v[250:251], v[250:251], 1.0
    v_pk_add_f32 v[252:253], v[252:253], 1.0
    v_pk_add_f32 v[254:255], v[254:255], 1.0
    v_rcp_f32 v248, v248
    v_rcp_f32 v249, v249
    v_rcp_f32 v250, v250
    v_rcp_f32 v251, v251
    v_rcp_f32 v252, v252
    v_rcp_f32 v253, v253
    v_rcp_f32 v254, v254
    v_rcp_f32 v255, v255
    s_nop 0
    v_pk_mul_f32 v[232:233], v[232:233], v[248:249]
    v_pk_mul_f32 v[234:235], v[234:235], v[250:251]
    v_pk_mul_f32 v[236:237], v[236:237], v[252:253]
    v_pk_mul_f32 v[238:239], v[238:239], v[254:255]
    s_add_u32 s3, s78, 5
    v_mov_b32 v109, s3
    s_waitcnt vmcnt(0)
    s_barrier
    buffer_store_dword v109, v108, s[96:99], 0 offen sc1
    s_mov_b32 s79, 0x10000
P3_spoll:
    s_mov_b64 exec, s[50:51]
    buffer_load_dword v111, v110, s[96:99], 0 offen sc1
    s_mov_b64 exec, -1
    s_waitcnt vmcnt(0)
    v_subrev_u32 v111, s78, v111
    v_subrev_u32 v111, 5, v111
    v_cmp_ge_u32 vcc, 2, v111
    s_nop 3
    s_and_b64 s[100:101], vcc, s[50:51]
    s_cmp_eq_u64 s[100:101], s[50:51]
    s_cbranch_scc1 P3_spoll_ok
    s_sub_u32 s79, s79, 1
    s_cmp_lg_u32 s79, 0
    s_cbranch_scc1 P3_spoll
P3_spoll_ok:
    buffer_load_dwordx4 v[40:43], v210, s[12:15], 0 offen offset:0 sc1
    buffer_load_dwordx4 v[44:47], v210, s[12:15], 0 offen offset:1024 sc1
    buffer_load_dwordx4 v[48:51], v210, s[12:15], 0 offen offset:2048 sc1
    buffer_load_dwordx4 v[52:55], v210, s[12:15], 0 offen offset:3072 sc1
    buffer_load_dwordx4 v[56:59], v211, s[12:15], 0 offen offset:0 sc1
    buffer_load_dwordx4 v[60:63], v211, s[12:15], 0 offen offset:1024 sc1
    buffer_load_dwordx4 v[64:67], v211, s[12:15], 0 offen offset:2048 sc1
    buffer_load_dwordx4 v[68:71], v211, s[12:15], 0 offen offset:3072 sc1
    buffer_load_dwordx4 v[72:75], v212, s[12:15], 0 offen offset:0 sc1
    buffer_load_dwordx4 v[76:79], v212, s[12:15], 0 offen offset:1024 sc1
    buffer_load_dwordx4 v[80:83], v212, s[12:15], 0 offen offset:2048 sc1
    buffer_load_dwordx4 v[84:87], v212, s[12:15], 0 offen offset:3072 sc1
    s_waitcnt vmcnt(8)
    v_lshlrev_b32 v96, 16, v40
    v_and_b32 v97, 0xffff0000, v40
    v_lshlrev_b32 v98, 16, v41
    v_and_b32 v99, 0xffff0000, v41
    v_lshlrev_b32 v100, 16, v42
    v_and_b32 v101, 0xffff0000, v42
    v_lshlrev_b32 v102, 16, v43
    v_and_b32 v103, 0xffff0000, v43
    v_lshlrev_b32 v240, 16, v44
    v_and_b32 v241, 0xffff0000, v44
    v_lshlrev_b32 v242, 16, v45
    v_and_b32 v243, 0xffff0000, v45
    v_lshlrev_b32 v244, 16, v46
    v_and_b32 v245, 0xffff0000, v46
    v_lshlrev_b32 v246, 16, v47
    v_and_b32 v247, 0xffff0000, v47
    v_pk_add_f32 v[96:97], v[96:97], v[240:241]
    v_pk_add_f32 v[98:99], v[98:99], v[242:243]
    v_pk_add_f32 v[100:101], v[100:101], v[244:245]
    v_pk_add_f32 v[102:103], v[102:103], v[246:247]
    v_lshlrev_b32 v240, 16, v48
    v_and_b32 v241, 0xffff0000, v48
    v_lshlrev_b32 v242, 16, v49
    v_and_b32 v243, 0xffff0000, v49
    v_lshlrev_b32 v244, 16, v50
    v_and_b32 v245, 0xffff0000, v50
    v_lshlrev_b32 v246, 16, v51
    v_and_b32 v247, 0xffff0000, v51
    v_pk_add_f32 v[96:97], v[96:97], v[240:241]
    v_pk_add_f32 v[98:99], v[98:99], v[242:243]
    v_pk_add_f32 v[100:101], v[100:101], v[244:245]
    v_pk_add_f32 v[102:103], v[102:103], v[246:247]
    v_lshlrev_b32 v240, 16, v52
    v_and_b32 v241, 0xffff0000, v52
    v_lshlrev_b32 v242, 16, v53
    v_and_b32 v243, 0xffff0000, v53
    v_lshlrev_b32 v244, 16, v54
    v_and_b32 v245, 0xffff0000, v54
    v_lshlrev_b32 v246, 16, v55
    v_and_b32 v247, 0xffff0000, v55
    v_pk_add_f32 v[96:97], v[96:97], v[240:241]
    v_pk_add_f32 v[98:99], v[98:99], v[242:243]
    v_pk_add_f32 v[100:101], v[100:101], v[244:245]
    v_pk_add_f32 v[102:103], v[102:103], v[246:247]
    v_lshlrev_b32 v240, 16, v16
    v_and_b32 v241, 0xffff0000, v16
    v_lshlrev_b32 v242, 16, v17
    v_and_b32 v243, 0xffff0000, v17
    v_lshlrev_b32 v244, 16, v18
    v_and_b32 v245, 0xffff0000, v18
    v_lshlrev_b32 v246, 16, v19
    v_and_b32 v247, 0xffff0000, v19
    v_pk_fma_f32 v[96:97], v[96:97], v[216:217], v[240:241]
    v_pk_fma_f32 v[98:99], v[98:99], v[218:219], v[242:243]
    v_pk_fma_f32 v[100:101], v[100:101], v[220:221], v[244:245]
    v_pk_fma_f32 v[102:103], v[102:103], v[222:223], v[246:247]
    v_cvt_pk_bf16_f32 v16, v96, v97
    v_cvt_pk_bf16_f32 v17, v98, v99
    v_cvt_pk_bf16_f32 v18, v100, v101
    v_cvt_pk_bf16_f32 v19, v102, v103
    buffer_store_dwordx4 v[16:19], v204, s[20:23], 0 offen
    s_waitcnt vmcnt(5)
    v_lshlrev_b32 v96, 16, v56
    v_and_b32 v97, 0xffff0000, v56
    v_lshlrev_b32 v98, 16, v57
    v_and_b32 v99, 0xffff0000, v57
    v_lshlrev_b32 v100, 16, v58
    v_and_b32 v101, 0xffff0000, v58
    v_lshlrev_b32 v102, 16, v59
    v_and_b32 v103, 0xffff0000, v59
    v_lshlrev_b32 v240, 16, v60
    v_and_b32 v241, 0xffff0000, v60
    v_lshlrev_b32 v242, 16, v61
    v_and_b32 v243, 0xffff0000, v61
    v_lshlrev_b32 v244, 16, v62
    v_and_b32 v245, 0xffff0000, v62
    v_lshlrev_b32 v246, 16, v63
    v_and_b32 v247, 0xffff0000, v63
    v_pk_add_f32 v[96:97], v[96:97], v[240:241]
    v_pk_add_f32 v[98:99], v[98:99], v[242:243]
    v_pk_add_f32 v[100:101], v[100:101], v[244:245]
    v_pk_add_f32 v[102:103], v[102:103], v[246:247]
    v_lshlrev_b32 v240, 16, v64
    v_and_b32 v241, 0xffff0000, v64
    v_lshlrev_b32 v242, 16, v65
    v_and_b32 v243, 0xffff0000, v65
    v_lshlrev_b32 v244, 16, v66
    v_and_b32 v245, 0xffff0000, v66
    v_lshlrev_b32 v246, 16, v67
    v_and_b32 v247, 0xffff0000, v67
    v_pk_add_f32 v[96:97], v[96:97], v[240:241]
    v_pk_add_f32 v[98:99], v[98:99], v[242:243]
    v_pk_add_f32 v[100:101], v[100:101], v[244:245]
    v_pk_add_f32 v[102:103], v[102:103], v[246:247]
    v_lshlrev_b32 v240, 16, v68
    v_and_b32 v241, 0xffff0000, v68
    v_lshlrev_b32 v242, 16, v69
    v_and_b32 v243, 0xffff0000, v69
    v_lshlrev_b32 v244, 16, v70
    v_and_b32 v245, 0xffff0000, v70
    v_lshlrev_b32 v246, 16, v71
    v_and_b32 v247, 0xffff0000, v71
    v_pk_add_f32 v[96:97], v[96:97], v[240:241]
    v_pk_add_f32 v[98:99], v[98:99], v[242:243]
    v_pk_add_f32 v[100:101], v[100:101], v[244:245]
    v_pk_add_f32 v[102:103], v[102:103], v[246:247]
    v_lshlrev_b32 v240, 16, v20
    v_and_b32 v241, 0xffff0000, v20
    v_lshlrev_b32 v242, 16, v21
    v_and_b32 v243, 0xffff0000, v21
    v_lshlrev_b32 v244, 16, v22
    v_and_b32 v245, 0xffff0000, v22
    v_lshlrev_b32 v246, 16, v23
    v_and_b32 v247, 0xffff0000, v23
    v_pk_fma_f32 v[96:97], v[96:97], v[224:225], v[240:241]
    v_pk_fma_f32 v[98:99], v[98:99], v[226:227], v[242:243]
    v_pk_fma_f32 v[100:101], v[100:101], v[228:229], v[244:245]
    v_pk_fma_f32 v[102:103], v[102:103], v[230:231], v[246:247]
    v_cvt_pk_bf16_f32 v20, v96, v97
    v_cvt_pk_bf16_f32 v21, v98, v99
    v_cvt_pk_bf16_f32 v22, v100, v101
    v_cvt_pk_bf16_f32 v23, v102, v103
    buffer_store_dwordx4 v[20:23], v205, s[20:23], 0 offen
    s_waitcnt vmcnt(2)
    v_lshlrev_b32 v96, 16, v72
    v_and_b32 v97, 0xffff0000, v72
    v_lshlrev_b32 v98, 16, v73
    v_and_b32 v99, 0xffff0000, v73
    v_lshlrev_b32 v100, 16, v74
    v_and_b32 v101, 0xffff0000, v74
    v_lshlrev_b32 v102, 16, v75
    v_and_b32 v103, 0xffff0000, v75
    v_lshlrev_b32 v240, 16, v76
    v_and_b32 v241, 0xffff0000, v76
    v_lshlrev_b32 v242, 16, v77
    v_and_b32 v243, 0xffff0000, v77
    v_lshlrev_b32 v244, 16, v78
    v_and_b32 v245, 0xffff0000, v78
    v_lshlrev_b32 v246, 16, v79
    v_and_b32 v247, 0xffff0000, v79
    v_pk_add_f32 v[96:97], v[96:97], v[240:241]
    v_pk_add_f32 v[98:99], v[98:99], v[242:243]
    v_pk_add_f32 v[100:101], v[100:101], v[244:245]
    v_pk_add_f32 v[102:103], v[102:103], v[246:247]
    v_lshlrev_b32 v240, 16, v80
    v_and_b32 v241, 0xffff0000, v80
    v_lshlrev_b32 v242, 16, v81
    v_and_b32 v243, 0xffff0000, v81
    v_lshlrev_b32 v244, 16, v82
    v_and_b32 v245, 0xffff0000, v82
    v_lshlrev_b32 v246, 16, v83
    v_and_b32 v247, 0xffff0000, v83
    v_pk_add_f32 v[96:97], v[96:97], v[240:241]
    v_pk_add_f32 v[98:99], v[98:99], v[242:243]
    v_pk_add_f32 v[100:101], v[100:101], v[244:245]
    v_pk_add_f32 v[102:103], v[102:103], v[246:247]
    v_lshlrev_b32 v240, 16, v84
    v_and_b32 v241, 0xffff0000, v84
    v_lshlrev_b32 v242, 16, v85
    v_and_b32 v243, 0xffff0000, v85
    v_lshlrev_b32 v244, 16, v86
    v_and_b32 v245, 0xffff0000, v86
    v_lshlrev_b32 v246, 16, v87
    v_and_b32 v247, 0xffff0000, v87
    v_pk_add_f32 v[96:97], v[96:97], v[240:241]
    v_pk_add_f32 v[98:99], v[98:99], v[242:243]
    v_pk_add_f32 v[100:101], v[100:101], v[244:245]
    v_pk_add_f32 v[102:103], v[102:103], v[246:247]
    v_lshlrev_b32 v240, 16, v24
    v_and_b32 v241, 0xffff0000, v24
    v_lshlrev_b32 v242, 16, v25
    v_and_b32 v243, 0xffff0000, v25
    v_lshlrev_b32 v244, 16, v26
    v_and_b32 v245, 0xffff0000, v26
    v_lshlrev_b32 v246, 16, v27
    v_and_b32 v247, 0xffff0000, v27
    v_pk_fma_f32 v[96:97], v[96:97], v[232:233], v[240:241]
    v_pk_fma_f32 v[98:99], v[98:99], v[234:235], v[242:243]
    v_pk_fma_f32 v[100:101], v[100:101], v[236:237], v[244:245]
    v_pk_fma_f32 v[102:103], v[102:103], v[238:239], v[246:247]
    v_cvt_pk_bf16_f32 v24, v96, v97
    v_cvt_pk_bf16_f32 v25, v98, v99
    v_cvt_pk_bf16_f32 v26, v100, v101
    v_cvt_pk_bf16_f32 v27, v102, v103
    buffer_store_dwordx4 v[24:27], v206, s[20:23], 0 offen
    s_waitcnt vmcnt(0)
FZ_end:
    s_endpgm
K1_fb:
    v_mov_b32 v21, 0xff800000
    v_mov_b32 v17, 0
    v_mov_b32 v22, 0xff800000
    v_mov_b32 v18, 0
    v_mov_b32 v23, 0xff800000
    v_mov_b32 v19, 0
    v_mov_b32 v88, 0xff800000
    v_mov_b32 v20, 0
    v_accvgpr_write_b32 a0, 0
    v_accvgpr_write_b32 a1, 0
    v_accvgpr_write_b32 a2, 0
    v_accvgpr_write_b32 a3, 0
    v_accvgpr_write_b32 a4, 0
    v_accvgpr_write_b32 a5, 0
    v_accvgpr_write_b32 a6, 0
    v_accvgpr_write_b32 a7, 0
    v_accvgpr_write_b32 a8, 0
    v_accvgpr_write_b32 a9, 0
    v_accvgpr_write_b32 a10, 0
    v_accvgpr_write_b32 a11, 0
    v_accvgpr_write_b32 a12, 0
    v_accvgpr_write_b32 a13, 0
    v_accvgpr_write_b32 a14, 0
    v_accvgpr_write_b32 a15, 0
    v_accvgpr_write_b32 a16, 0
    v_accvgpr_write_b32 a17, 0
    v_accvgpr_write_b32 a18, 0
    v_accvgpr_write_b32 a19, 0
    v_accvgpr_write_b32 a20, 0
    v_accvgpr_write_b32 a21, 0
    v_accvgpr_write_b32 a22, 0
    v_accvgpr_write_b32 a23, 0
    v_accvgpr_write_b32 a24, 0
    v_accvgpr_write_b32 a25, 0
    v_accvgpr_write_b32 a26, 0
    v_accvgpr_write_b32 a27, 0
    v_accvgpr_write_b32 a28, 0
    v_accvgpr_write_b32 a29, 0
    v_accvgpr_write_b32 a30, 0
    v_accvgpr_write_b32 a31, 0
    v_accvgpr_write_b32 a32, 0
    v_accvgpr_write_b32 a33, 0
    v_accvgpr_write_b32 a34, 0
    v_accvgpr_write_b32 a35, 0
    v_accvgpr_write_b32 a36, 0
    v_accvgpr_write_b32 a37, 0
    v_accvgpr_write_b32 a38, 0
    v_accvgpr_write_b32 a39, 0
    v_accvgpr_write_b32 a40, 0
    v_accvgpr_write_b32 a41, 0
    v_accvgpr_write_b32 a42, 0
    v_accvgpr_write_b32 a43, 0
    v_accvgpr_write_b32 a44, 0
    v_accvgpr_write_b32 a45, 0
    v_accvgpr_write_b32 a46, 0
    v_accvgpr_write_b32 a47, 0
    v_accvgpr_write_b32 a48, 0
    v_accvgpr_write_b32 a49, 0
    v_accvgpr_write_b32 a50, 0
    v_accvgpr_write_b32 a51, 0
    v_accvgpr_write_b32 a52, 0
    v_accvgpr_write_b32 a53, 0
    v_accvgpr_write_b32 a54, 0
    v_accvgpr_write_b32 a55, 0
    v_accvgpr_write_b32 a56, 0
    v_accvgpr_write_b32 a57, 0
    v_accvgpr_write_b32 a58, 0
    v_accvgpr_write_b32 a59, 0
    v_accvgpr_write_b32 a60, 0
    v_accvgpr_write_b32 a61, 0
    v_accvgpr_write_b32 a62, 0
    v_accvgpr_write_b32 a63, 0
    v_accvgpr_write_b32 a64, 0
    v_accvgpr_write_b32 a65, 0
    v_accvgpr_write_b32 a66, 0
    v_accvgpr_write_b32 a67, 0
    v_accvgpr_write_b32 a68, 0
    v_accvgpr_write_b32 a69, 0
    v_accvgpr_write_b32 a70, 0
    v_accvgpr_write_b32 a71, 0
    v_accvgpr_write_b32 a72, 0
    v_accvgpr_write_b32 a73, 0
    v_accvgpr_write_b32 a74, 0
    v_accvgpr_write_b32 a75, 0
    v_accvgpr_write_b32 a76, 0
    v_accvgpr_write_b32 a77, 0
    v_accvgpr_write_b32 a78, 0
    v_accvgpr_write_b32 a79, 0
    v_accvgpr_write_b32 a80, 0
    v_accvgpr_write_b32 a81, 0
    v_accvgpr_write_b32 a82, 0
    v_accvgpr_write_b32 a83, 0
    v_accvgpr_write_b32 a84, 0
    v_accvgpr_write_b32 a85, 0
    v_accvgpr_write_b32 a86, 0
    v_accvgpr_write_b32 a87, 0
    v_accvgpr_write_b32 a88, 0
    v_accvgpr_write_b32 a89, 0
    v_accvgpr_write_b32 a90, 0
    v_accvgpr_write_b32 a91, 0
    v_accvgpr_write_b32 a92, 0
    v_accvgpr_write_b32 a93, 0
    v_accvgpr_write_b32 a94, 0
    v_accvgpr_write_b32 a95, 0
    v_accvgpr_write_b32 a96, 0
    v_accvgpr_write_b32 a97, 0
    v_accvgpr_write_b32 a98, 0
    v_accvgpr_write_b32 a99, 0
    v_accvgpr_write_b32 a100, 0
    v_accvgpr_write_b32 a101, 0
    v_accvgpr_write_b32 a102, 0
    v_accvgpr_write_b32 a103, 0
    v_accvgpr_write_b32 a104, 0
    v_accvgpr_write_b32 a105, 0
    v_accvgpr_write_b32 a106, 0
    v_accvgpr_write_b32 a107, 0
    v_accvgpr_write_b32 a108, 0
    v_accvgpr_write_b32 a109, 0
    v_accvgpr_write_b32 a110, 0
    v_accvgpr_write_b32 a111, 0
    v_accvgpr_write_b32 a112, 0
    v_accvgpr_write_b32 a113, 0
    v_accvgpr_write_b32 a114, 0
    v_accvgpr_write_b32 a115, 0
    v_accvgpr_write_b32 a116, 0
    v_accvgpr_write_b32 a117, 0
    v_accvgpr_write_b32 a118, 0
    v_accvgpr_write_b32 a119, 0
    v_accvgpr_write_b32 a120, 0
    v_accvgpr_write_b32 a121, 0
    v_accvgpr_write_b32 a122, 0
    v_accvgpr_write_b32 a123, 0
    v_accvgpr_write_b32 a124, 0
    v_accvgpr_write_b32 a125, 0
    v_accvgpr_write_b32 a126, 0
    v_accvgpr_write_b32 a127, 0
    s_mov_b32 s36, 0
    s_waitcnt vmcnt(0) lgkmcnt(0)
K1_fb_loop:
    s_barrier
    s_mov_b32 m0, s37
    s_nop 0
    buffer_load_dwordx4 v1, s[4:7], s36 offen offset:0 lds
    buffer_load_dwordx4 v2, s[4:7], s36 offen offset:1024 lds
    s_mov_b32 m0, s38
    s_nop 0
    buffer_load_dwordx4 v3, s[8:11], s36 offen offset:0 lds
    buffer_load_dwordx4 v4, s[8:11], s36 offen offset:1024 lds
    s_waitcnt vmcnt(0)
    s_barrier
    ds_read_b128 a[128:131], v5 offset:0
    ds_read_b128 a[132:135], v6 offset:0
    ds_read_b128 a[136:139], v7 offset:0
    ds_read_b128 a[140:143], v8 offset:0
    ds_read_b128 a[144:147], v5 offset:4096
    ds_read_b128 a[148:151], v6 offset:4096
    ds_read_b128 a[152:155], v7 offset:4096
    ds_read_b128 a[156:159], v8 offset:4096
    s_waitcnt lgkmcnt(0)
    ds_read_b64_tr_b16 a[160:161], v9 offset:0
    ds_read_b64_tr_b16 a[162:163], v9 offset:4096
    ds_read_b64_tr_b16 a[164:165], v10 offset:0
    ds_read_b64_tr_b16 a[166:167], v10 offset:4096
    ds_read_b64_tr_b16 a[168:169], v11 offset:0
    ds_read_b64_tr_b16 a[170:171], v11 offset:4096
    ds_read_b64_tr_b16 a[172:173], v12 offset:0
    ds_read_b64_tr_b16 a[174:175], v12 offset:4096
    ds_read_b64_tr_b16 a[176:177], v13 offset:0
    ds_read_b64_tr_b16 a[178:179], v13 offset:4096
    ds_read_b64_tr_b16 a[180:181], v14 offset:0
    ds_read_b64_tr_b16 a[182:183], v14 offset:4096
    ds_read_b64_tr_b16 a[184:185], v15 offset:0
    ds_read_b64_tr_b16 a[186:187], v15 offset:4096
    ds_read_b64_tr_b16 a[188:189], v16 offset:0
    ds_read_b64_tr_b16 a[190:191], v16 offset:4096
    v_mfma_f32_16x16x32_bf16 v[40:43], a[128:131], v[112:115], 0
    v_mfma_f32_16x16x32_bf16 v[40:43], a[132:135], v[116:119], v[40:43]
    v_mfma_f32_16x16x32_bf16 v[40:43], a[136:139], v[120:123], v[40:43]
    v_mfma_f32_16x16x32_bf16 v[40:43], a[140:143], v[124:127], v[40:43]
    v_mfma_f32_16x16x32_bf16 v[44:47], a[144:147], v[112:115], 0
    v_mfma_f32_16x16x32_bf16 v[44:47], a[148:151], v[116:119], v[44:47]
    v_mfma_f32_16x16x32_bf16 v[44:47], a[152:155], v[120:123], v[44:47]
    v_mfma_f32_16x16x32_bf16 v[44:47], a[156:159], v[124:127], v[44:47]
    v_mfma_f32_16x16x32_bf16 v[48:51], a[128:131], v[128:131], 0
    v_mfma_f32_16x16x32_bf16 v[48:51], a[132:135], v[132:135], v[48:51]
    v_mfma_f32_16x16x32_bf16 v[48:51], a[136:139], v[136:139], v[48:51]
    v_mfma_f32_16x16x32_bf16 v[48:51], a[140:143], v[140:143], v[48:51]
    v_mfma_f32_16x16x32_bf16 v[52:55], a[144:147], v[128:131], 0
    v_mfma_f32_16x16x32_bf16 v[52:55], a[148:151], v[132:135], v[52:55]
    v_mfma_f32_16x16x32_bf16 v[52:55], a[152:155], v[136:139], v[52:55]
    v_mfma_f32_16x16x32_bf16 v[52:55], a[156:159], v[140:143], v[52:55]
    v_mfma_f32_16x16x32_bf16 v[56:59], a[128:131], v[144:147], 0
    v_mfma_f32_16x16x32_bf16 v[56:59], a[132:135], v[148:151], v[56:59]
    v_mfma_f32_16x16x32_bf16 v[56:59], a[136:139], v[152:155], v[56:59]
    v_mfma_f32_16x16x32_bf16 v[56:59], a[140:143], v[156:159], v[56:59]
    v_mfma_f32_16x16x32_bf16 v[60:63], a[144:147], v[144:147], 0
    v_mfma_f32_16x16x32_bf16 v[60:63], a[148:151], v[148:151], v[60:63]
    v_mfma_f32_16x16x32_bf16 v[60:63], a[152:155], v[152:155], v[60:63]
    v_mfma_f32_16x16x32_bf16 v[60:63], a[156:159], v[156:159], v[60:63]
    v_mfma_f32_16x16x32_bf16 v[64:67], a[128:131], v[160:163], 0
    v_mfma_f32_16x16x32_bf16 v[64:67], a[132:135], v[164:167], v[64:67]
    v_mfma_f32_16x16x32_bf16 v[64:67], a[136:139], v[168:171], v[64:67]
    v_mfma_f32_16x16x32_bf16 v[64:67], a[140:143], v[172:175], v[64:67]
    v_mfma_f32_16x16x32_bf16 v[68:71], a[144:147], v[160:163], 0
    v_mfma_f32_16x16x32_bf16 v[68:71], a[148:151], v[164:167], v[68:71]
    v_mfma_f32_16x16x32_bf16 v[68:71], a[152:155], v[168:171], v[68:71]
    v_mfma_f32_16x16x32_bf16 v[68:71], a[156:159], v[172:175], v[68:71]
    s_nop 7
    v_max3_f32 v89, v40, v41, v42
    v_max3_f32 v89, v89, v43, v44
    v_max3_f32 v89, v89, v45, v46
    v_max_f32 v89, v89, v47
    v_max3_f32 v90, v48, v49, v50
    v_max3_f32 v90, v90, v51, v52
    v_max3_f32 v90, v90, v53, v54
    v_max_f32 v90, v90, v55
    v_max3_f32 v91, v56, v57, v58
    v_max3_f32 v91, v91, v59, v60
    v_max3_f32 v91, v91, v61, v62
    v_max_f32 v91, v91, v63
    v_max3_f32 v104, v64, v65, v66
    v_max3_f32 v104, v104, v67, v68
    v_max3_f32 v104, v104, v69, v70
    v_max_f32 v104, v104, v71
    v_mov_b32 v100, v89
    v_mov_b32 v101, v90
    v_mov_b32 v102, v91
    v_mov_b32 v103, v104
    v_permlane32_swap_b32 v89, v100
    v_permlane32_swap_b32 v90, v101
    v_permlane32_swap_b32 v91, v102
    v_permlane32_swap_b32 v104, v103
    v_max_f32 v89, v89, v100
    v_max_f32 v90, v90, v101
    v_max_f32 v91, v91, v102
    v_max_f32 v104, v104, v103
    v_mov_b32 v100, v89
    v_mov_b32 v101, v90
    v_mov_b32 v102, v91
    v_mov_b32 v103, v104
    v_permlane16_swap_b32 v89, v100
    v_permlane16_swap_b32 v90, v101
    v_permlane16_swap_b32 v91, v102
    v_permlane16_swap_b32 v104, v103
    v_max_f32 v89, v89, v100
    v_max_f32 v90, v90, v101
    v_max_f32 v91, v91, v102
    v_max_f32 v104, v104, v103
    v_max_f32 v89, v89, v21
    v_max_f32 v90, v90, v22
    v_max_f32 v91, v91, v23
    v_max_f32 v104, v104, v88
    v_sub_f32 v24, v21, v89
    v_sub_f32 v25, v22, v90
    v_sub_f32 v26, v23, v91
    v_sub_f32 v27, v88, v104
    v_exp_f32 v24, v24
    v_mov_b32 v21, v89
    v_exp_f32 v25, v25
    v_mov_b32 v22, v90
    v_exp_f32 v26, v26
    v_mov_b32 v23, v91
    v_exp_f32 v27, v27
    v_mov_b32 v88, v104
    v_mul_f32 v17, v17, v24
    v_mul_f32 v18, v18, v25
    v_mul_f32 v19, v19, v26
    v_mul_f32 v20, v20, v27
    v_sub_f32 v40, v40, v21
    v_sub_f32 v41, v41, v21
    v_sub_f32 v42, v42, v21
    v_sub_f32 v43, v43, v21
    v_sub_f32 v44, v44, v21
    v_sub_f32 v45, v45, v21
    v_sub_f32 v46, v46, v21
    v_sub_f32 v47, v47, v21
    v_sub_f32 v48, v48, v22
    v_sub_f32 v49, v49, v22
    v_sub_f32 v50, v50, v22
    v_sub_f32 v51, v51, v22
    v_sub_f32 v52, v52, v22
    v_sub_f32 v53, v53, v22
    v_sub_f32 v54, v54, v22
    v_sub_f32 v55, v55, v22
    v_exp_f32 v40, v40
    v_exp_f32 v41, v41
    v_exp_f32 v42, v42
    v_exp_f32 v43, v43
    v_exp_f32 v44, v44
    v_exp_f32 v45, v45
    v_exp_f32 v46, v46
    v_exp_f32 v47, v47
    v_exp_f32 v48, v48
    v_exp_f32 v49, v49
    v_exp_f32 v50, v50
    v_exp_f32 v51, v51
    v_exp_f32 v52, v52
    v_exp_f32 v53, v53
    v_exp_f32 v54, v54
    v_exp_f32 v55, v55
    s_nop 0
    v_add_f32 v17, v17, v40
    v_add_f32 v17, v17, v41
    v_add_f32 v17, v17, v42
    v_add_f32 v17, v17, v43
    v_add_f32 v17, v17, v44
    v_add_f32 v17, v17, v45
    v_add_f32 v17, v17, v46
    v_add_f32 v17, v17, v47
    v_add_f32 v18, v18, v48
    v_add_f32 v18, v18, v49
    v_add_f32 v18, v18, v50
    v_add_f32 v18, v18, v51
    v_add_f32 v18, v18, v52
    v_add_f32 v18, v18, v53
    v_add_f32 v18, v18, v54
    v_add_f32 v18, v18, v55
    v_cvt_pk_bf16_f32 v72, v40, v41
    v_cvt_pk_bf16_f32 v73, v42, v43
    v_cvt_pk_bf16_f32 v74, v44, v45
    v_cvt_pk_bf16_f32 v75, v46, v47
    v_cvt_pk_bf16_f32 v76, v48, v49
    v_cvt_pk_bf16_f32 v77, v50, v51
    v_cvt_pk_bf16_f32 v78, v52, v53
    v_cvt_pk_bf16_f32 v79, v54, v55
    v_sub_f32 v56, v56, v23
    v_sub_f32 v57, v57, v23
    v_sub_f32 v58, v58, v23
    v_sub_f32 v59, v59, v23
    v_sub_f32 v60, v60, v23
    v_sub_f32 v61, v61, v23
    v_sub_f32 v62, v62, v23
    v_sub_f32 v63, v63, v23
    v_sub_f32 v64, v64, v88
    v_sub_f32 v65, v65, v88
    v_sub_f32 v66, v66, v88
    v_sub_f32 v67, v67, v88
    v_sub_f32 v68, v68, v88
    v_sub_f32 v69, v69, v88
    v_sub_f32 v70, v70, v88
    v_sub_f32 v71, v71, v88
    v_exp_f32 v56, v56
    v_exp_f32 v57, v57
    v_exp_f32 v58, v58
    v_exp_f32 v59, v59
    v_exp_f32 v60, v60
    v_exp_f32 v61, v61
    v_exp_f32 v62, v62
    v_exp_f32 v63, v63
    v_exp_f32 v64, v64
    v_exp_f32 v65, v65
    v_exp_f32 v66, v66
    v_exp_f32 v67, v67
    v_exp_f32 v68, v68
    v_exp_f32 v69, v69
    v_exp_f32 v70, v70
    v_exp_f32 v71, v71
    s_nop 0
    v_add_f32 v19, v19, v56
    v_add_f32 v19, v19, v57
    v_add_f32 v19, v19, v58
    v_add_f32 v19, v19, v59
    v_add_f32 v19, v19, v60
    v_add_f32 v19, v19, v61
    v_add_f32 v19, v19, v62
    v_add_f32 v19, v19, v63
    v_add_f32 v20, v20, v64
    v_add_f32 v20, v20, v65
    v_add_f32 v20, v20, v66
    v_add_f32 v20, v20, v67
    v_add_f32 v20, v20, v68
    v_add_f32 v20, v20, v69
    v_add_f32 v20, v20, v70
    v_add_f32 v20, v20, v71
    v_cvt_pk_bf16_f32 v80, v56, v57
    v_cvt_pk_bf16_f32 v81, v58, v59
    v_cvt_pk_bf16_f32 v82, v60, v61
    v_cvt_pk_bf16_f32 v83, v62, v63
    v_cvt_pk_bf16_f32 v84, v64, v65
    v_cvt_pk_bf16_f32 v85, v66, v67
    v_cvt_pk_bf16_f32 v86, v68, v69
    v_cvt_pk_bf16_f32 v87, v70, v71
    v_accvgpr_read_b32 v100, a0
    v_accvgpr_read_b32 v101, a1
    v_accvgpr_read_b32 v102, a2
    v_accvgpr_read_b32 v103, a3
    v_mul_f32 v100, v100, v24
    v_mul_f32 v101, v101, v24
    v_mul_f32 v102, v102, v24
    v_mul_f32 v103, v103, v24
    v_accvgpr_write_b32 a0, v100
    v_accvgpr_write_b32 a1, v101
    v_accvgpr_write_b32 a2, v102
    v_accvgpr_write_b32 a3, v103
    v_accvgpr_read_b32 v100, a4
    v_accvgpr_read_b32 v101, a5
    v_accvgpr_read_b32 v102, a6
    v_accvgpr_read_b32 v103, a7
    v_mul_f32 v100, v100, v25
    v_mul_f32 v101, v101, v25
    v_mul_f32 v102, v102, v25
    v_mul_f32 v103, v103, v25
    v_accvgpr_write_b32 a4, v100
    v_accvgpr_write_b32 a5, v101
    v_accvgpr_write_b32 a6, v102
    v_accvgpr_write_b32 a7, v103
    v_accvgpr_read_b32 v100, a8
    v_accvgpr_read_b32 v101, a9
    v_accvgpr_read_b32 v102, a10
    v_accvgpr_read_b32 v103, a11
    v_mul_f32 v100, v100, v26
    v_mul_f32 v101, v101, v26
    v_mul_f32 v102, v102, v26
    v_mul_f32 v103, v103, v26
    v_accvgpr_write_b32 a8, v100
    v_accvgpr_write_b32 a9, v101
    v_accvgpr_write_b32 a10, v102
    v_accvgpr_write_b32 a11, v103
    v_accvgpr_read_b32 v100, a12
    v_accvgpr_read_b32 v101, a13
    v_accvgpr_read_b32 v102, a14
    v_accvgpr_read_b32 v103, a15
    v_mul_f32 v100, v100, v27
    v_mul_f32 v101, v101, v27
    v_mul_f32 v102, v102, v27
    v_mul_f32 v103, v103, v27
    v_accvgpr_write_b32 a12, v100
    v_accvgpr_write_b32 a13, v101
    v_accvgpr_write_b32 a14, v102
    v_accvgpr_write_b32 a15, v103
    v_accvgpr_read_b32 v100, a16
    v_accvgpr_read_b32 v101, a17
    v_accvgpr_read_b32 v102, a18
    v_accvgpr_read_b32 v103, a19
    v_mul_f32 v100, v100, v24
    v_mul_f32 v101, v101, v24
    v_mul_f32 v102, v102, v24
    v_mul_f32 v103, v103, v24
    v_accvgpr_write_b32 a16, v100
    v_accvgpr_write_b32 a17, v101
    v_accvgpr_write_b32 a18, v102
    v_accvgpr_write_b32 a19, v103
    v_accvgpr_read_b32 v100, a20
    v_accvgpr_read_b32 v101, a21
    v_accvgpr_read_b32 v102, a22
    v_accvgpr_read_b32 v103, a23
    v_mul_f32 v100, v100, v25
    v_mul_f32 v101, v101, v25
    v_mul_f32 v102, v102, v25
    v_mul_f32 v103, v103, v25
    v_accvgpr_write_b32 a20, v100
    v_accvgpr_write_b32 a21, v101
    v_accvgpr_write_b32 a22, v102
    v_accvgpr_write_b32 a23, v103
    v_accvgpr_read_b32 v100, a24
    v_accvgpr_read_b32 v101, a25
    v_accvgpr_read_b32 v102, a26
    v_accvgpr_read_b32 v103, a27
    v_mul_f32 v100, v100, v26
    v_mul_f32 v101, v101, v26
    v_mul_f32 v102, v102, v26
    v_mul_f32 v103, v103, v26
    v_accvgpr_write_b32 a24, v100
    v_accvgpr_write_b32 a25, v101
    v_accvgpr_write_b32 a26, v102
    v_accvgpr_write_b32 a27, v103
    v_accvgpr_read_b32 v100, a28
    v_accvgpr_read_b32 v101, a29
    v_accvgpr_read_b32 v102, a30
    v_accvgpr_read_b32 v103, a31
    v_mul_f32 v100, v100, v27
    v_mul_f32 v101, v101, v27
    v_mul_f32 v102, v102, v27
    v_mul_f32 v103, v103, v27
    v_accvgpr_write_b32 a28, v100
    v_accvgpr_write_b32 a29, v101
    v_accvgpr_write_b32 a30, v102
    v_accvgpr_write_b32 a31, v103
    v_accvgpr_read_b32 v100, a32
    v_accvgpr_read_b32 v101, a33
    v_accvgpr_read_b32 v102, a34
    v_accvgpr_read_b32 v103, a35
    v_mul_f32 v100, v100, v24
    v_mul_f32 v101, v101, v24
    v_mul_f32 v102, v102, v24
    v_mul_f32 v103, v103, v24
    v_accvgpr_write_b32 a32, v100
    v_accvgpr_write_b32 a33, v101
    v_accvgpr_write_b32 a34, v102
    v_accvgpr_write_b32 a35, v103
    v_accvgpr_read_b32 v100, a36
    v_accvgpr_read_b32 v101, a37
    v_accvgpr_read_b32 v102, a38
    v_accvgpr_read_b32 v103, a39
    v_mul_f32 v100, v100, v25
    v_mul_f32 v101, v101, v25
    v_mul_f32 v102, v102, v25
    v_mul_f32 v103, v103, v25
    v_accvgpr_write_b32 a36, v100
    v_accvgpr_write_b32 a37, v101
    v_accvgpr_write_b32 a38, v102
    v_accvgpr_write_b32 a39, v103
    v_accvgpr_read_b32 v100, a40
    v_accvgpr_read_b32 v101, a41
    v_accvgpr_read_b32 v102, a42
    v_accvgpr_read_b32 v103, a43
    v_mul_f32 v100, v100, v26
    v_mul_f32 v101, v101, v26
    v_mul_f32 v102, v102, v26
    v_mul_f32 v103, v103, v26
    v_accvgpr_write_b32 a40, v100
    v_accvgpr_write_b32 a41, v101
    v_accvgpr_write_b32 a42, v102
    v_accvgpr_write_b32 a43, v103
    v_accvgpr_read_b32 v100, a44
    v_accvgpr_read_b32 v101, a45
    v_accvgpr_read_b32 v102, a46
    v_accvgpr_read_b32 v103, a47
    v_mul_f32 v100, v100, v27
    v_mul_f32 v101, v101, v27
    v_mul_f32 v102, v102, v27
    v_mul_f32 v103, v103, v27
    v_accvgpr_write_b32 a44, v100
    v_accvgpr_write_b32 a45, v101
    v_accvgpr_write_b32 a46, v102
    v_accvgpr_write_b32 a47, v103
    v_accvgpr_read_b32 v100, a48
    v_accvgpr_read_b32 v101, a49
    v_accvgpr_read_b32 v102, a50
    v_accvgpr_read_b32 v103, a51
    v_mul_f32 v100, v100, v24
    v_mul_f32 v101, v101, v24
    v_mul_f32 v102, v102, v24
    v_mul_f32 v103, v103, v24
    v_accvgpr_write_b32 a48, v100
    v_accvgpr_write_b32 a49, v101
    v_accvgpr_write_b32 a50, v102
    v_accvgpr_write_b32 a51, v103
    v_accvgpr_read_b32 v100, a52
    v_accvgpr_read_b32 v101, a53
    v_accvgpr_read_b32 v102, a54
    v_accvgpr_read_b32 v103, a55
    v_mul_f32 v100, v100, v25
    v_mul_f32 v101, v101, v25
    v_mul_f32 v102, v102, v25
    v_mul_f32 v103, v103, v25
    v_accvgpr_write_b32 a52, v100
    v_accvgpr_write_b32 a53, v101
    v_accvgpr_write_b32 a54, v102
    v_accvgpr_write_b32 a55, v103
    v_accvgpr_read_b32 v100, a56
    v_accvgpr_read_b32 v101, a57
    v_accvgpr_read_b32 v102, a58
    v_accvgpr_read_b32 v103, a59
    v_mul_f32 v100, v100, v26
    v_mul_f32 v101, v101, v26
    v_mul_f32 v102, v102, v26
    v_mul_f32 v103, v103, v26
    v_accvgpr_write_b32 a56, v100
    v_accvgpr_write_b32 a57, v101
    v_accvgpr_write_b32 a58, v102
    v_accvgpr_write_b32 a59, v103
    v_accvgpr_read_b32 v100, a60
    v_accvgpr_read_b32 v101, a61
    v_accvgpr_read_b32 v102, a62
    v_accvgpr_read_b32 v103, a63
    v_mul_f32 v100, v100, v27
    v_mul_f32 v101, v101, v27
    v_mul_f32 v102, v102, v27
    v_mul_f32 v103, v103, v27
    v_accvgpr_write_b32 a60, v100
    v_accvgpr_write_b32 a61, v101
    v_accvgpr_write_b32 a62, v102
    v_accvgpr_write_b32 a63, v103
    v_accvgpr_read_b32 v100, a64
    v_accvgpr_read_b32 v101, a65
    v_accvgpr_read_b32 v102, a66
    v_accvgpr_read_b32 v103, a67
    v_mul_f32 v100, v100, v24
    v_mul_f32 v101, v101, v24
    v_mul_f32 v102, v102, v24
    v_mul_f32 v103, v103, v24
    v_accvgpr_write_b32 a64, v100
    v_accvgpr_write_b32 a65, v101
    v_accvgpr_write_b32 a66, v102
    v_accvgpr_write_b32 a67, v103
    v_accvgpr_read_b32 v100, a68
    v_accvgpr_read_b32 v101, a69
    v_accvgpr_read_b32 v102, a70
    v_accvgpr_read_b32 v103, a71
    v_mul_f32 v100, v100, v25
    v_mul_f32 v101, v101, v25
    v_mul_f32 v102, v102, v25
    v_mul_f32 v103, v103, v25
    v_accvgpr_write_b32 a68, v100
    v_accvgpr_write_b32 a69, v101
    v_accvgpr_write_b32 a70, v102
    v_accvgpr_write_b32 a71, v103
    v_accvgpr_read_b32 v100, a72
    v_accvgpr_read_b32 v101, a73
    v_accvgpr_read_b32 v102, a74
    v_accvgpr_read_b32 v103, a75
    v_mul_f32 v100, v100, v26
    v_mul_f32 v101, v101, v26
    v_mul_f32 v102, v102, v26
    v_mul_f32 v103, v103, v26
    v_accvgpr_write_b32 a72, v100
    v_accvgpr_write_b32 a73, v101
    v_accvgpr_write_b32 a74, v102
    v_accvgpr_write_b32 a75, v103
    v_accvgpr_read_b32 v100, a76
    v_accvgpr_read_b32 v101, a77
    v_accvgpr_read_b32 v102, a78
    v_accvgpr_read_b32 v103, a79
    v_mul_f32 v100, v100, v27
    v_mul_f32 v101, v101, v27
    v_mul_f32 v102, v102, v27
    v_mul_f32 v103, v103, v27
    v_accvgpr_write_b32 a76, v100
    v_accvgpr_write_b32 a77, v101
    v_accvgpr_write_b32 a78, v102
    v_accvgpr_write_b32 a79, v103
    v_accvgpr_read_b32 v100, a80
    v_accvgpr_read_b32 v101, a81
    v_accvgpr_read_b32 v102, a82
    v_accvgpr_read_b32 v103, a83
    v_mul_f32 v100, v100, v24
    v_mul_f32 v101, v101, v24
    v_mul_f32 v102, v102, v24
    v_mul_f32 v103, v103, v24
    v_accvgpr_write_b32 a80, v100
    v_accvgpr_write_b32 a81, v101
    v_accvgpr_write_b32 a82, v102
    v_accvgpr_write_b32 a83, v103
    v_accvgpr_read_b32 v100, a84
    v_accvgpr_read_b32 v101, a85
    v_accvgpr_read_b32 v102, a86
    v_accvgpr_read_b32 v103, a87
    v_mul_f32 v100, v100, v25
    v_mul_f32 v101, v101, v25
    v_mul_f32 v102, v102, v25
    v_mul_f32 v103, v103, v25
    v_accvgpr_write_b32 a84, v100
    v_accvgpr_write_b32 a85, v101
    v_accvgpr_write_b32 a86, v102
    v_accvgpr_write_b32 a87, v103
    v_accvgpr_read_b32 v100, a88
    v_accvgpr_read_b32 v101, a89
    v_accvgpr_read_b32 v102, a90
    v_accvgpr_read_b32 v103, a91
    v_mul_f32 v100, v100, v26
    v_mul_f32 v101, v101, v26
    v_mul_f32 v102, v102, v26
    v_mul_f32 v103, v103, v26
    v_accvgpr_write_b32 a88, v100
    v_accvgpr_write_b32 a89, v101
    v_accvgpr_write_b32 a90, v102
    v_accvgpr_write_b32 a91, v103
    v_accvgpr_read_b32 v100, a92
    v_accvgpr_read_b32 v101, a93
    v_accvgpr_read_b32 v102, a94
    v_accvgpr_read_b32 v103, a95
    v_mul_f32 v100, v100, v27
    v_mul_f32 v101, v101, v27
    v_mul_f32 v102, v102, v27
    v_mul_f32 v103, v103, v27
    v_accvgpr_write_b32 a92, v100
    v_accvgpr_write_b32 a93, v101
    v_accvgpr_write_b32 a94, v102
    v_accvgpr_write_b32 a95, v103
    v_accvgpr_read_b32 v100, a96
    v_accvgpr_read_b32 v101, a97
    v_accvgpr_read_b32 v102, a98
    v_accvgpr_read_b32 v103, a99
    v_mul_f32 v100, v100, v24
    v_mul_f32 v101, v101, v24
    v_mul_f32 v102, v102, v24
    v_mul_f32 v103, v103, v24
    v_accvgpr_write_b32 a96, v100
    v_accvgpr_write_b32 a97, v101
    v_accvgpr_write_b32 a98, v102
    v_accvgpr_write_b32 a99, v103
    v_accvgpr_read_b32 v100, a100
    v_accvgpr_read_b32 v101, a101
    v_accvgpr_read_b32 v102, a102
    v_accvgpr_read_b32 v103, a103
    v_mul_f32 v100, v100, v25
    v_mul_f32 v101, v101, v25
    v_mul_f32 v102, v102, v25
    v_mul_f32 v103, v103, v25
    v_accvgpr_write_b32 a100, v100
    v_accvgpr_write_b32 a101, v101
    v_accvgpr_write_b32 a102, v102
    v_accvgpr_write_b32 a103, v103
    v_accvgpr_read_b32 v100, a104
    v_accvgpr_read_b32 v101, a105
    v_accvgpr_read_b32 v102, a106
    v_accvgpr_read_b32 v103, a107
    v_mul_f32 v100, v100, v26
    v_mul_f32 v101, v101, v26
    v_mul_f32 v102, v102, v26
    v_mul_f32 v103, v103, v26
    v_accvgpr_write_b32 a104, v100
    v_accvgpr_write_b32 a105, v101
    v_accvgpr_write_b32 a106, v102
    v_accvgpr_write_b32 a107, v103
    v_accvgpr_read_b32 v100, a108
    v_accvgpr_read_b32 v101, a109
    v_accvgpr_read_b32 v102, a110
    v_accvgpr_read_b32 v103, a111
    v_mul_f32 v100, v100, v27
    v_mul_f32 v101, v101, v27
    v_mul_f32 v102, v102, v27
    v_mul_f32 v103, v103, v27
    v_accvgpr_write_b32 a108, v100
    v_accvgpr_write_b32 a109, v101
    v_accvgpr_write_b32 a110, v102
    v_accvgpr_write_b32 a111, v103
    v_accvgpr_read_b32 v100, a112
    v_accvgpr_read_b32 v101, a113
    v_accvgpr_read_b32 v102, a114
    v_accvgpr_read_b32 v103, a115
    v_mul_f32 v100, v100, v24
    v_mul_f32 v101, v101, v24
    v_mul_f32 v102, v102, v24
    v_mul_f32 v103, v103, v24
    v_accvgpr_write_b32 a112, v100
    v_accvgpr_write_b32 a113, v101
    v_accvgpr_write_b32 a114, v102
    v_accvgpr_write_b32 a115, v103
    v_accvgpr_read_b32 v100, a116
    v_accvgpr_read_b32 v101, a117
    v_accvgpr_read_b32 v102, a118
    v_accvgpr_read_b32 v103, a119
    v_mul_f32 v100, v100, v25
    v_mul_f32 v101, v101, v25
    v_mul_f32 v102, v102, v25
    v_mul_f32 v103, v103, v25
    v_accvgpr_write_b32 a116, v100
    v_accvgpr_write_b32 a117, v101
    v_accvgpr_write_b32 a118, v102
    v_accvgpr_write_b32 a119, v103
    v_accvgpr_read_b32 v100, a120
    v_accvgpr_read_b32 v101, a121
    v_accvgpr_read_b32 v102, a122
    v_accvgpr_read_b32 v103, a123
    v_mul_f32 v100, v100, v26
    v_mul_f32 v101, v101, v26
    v_mul_f32 v102, v102, v26
    v_mul_f32 v103, v103, v26
    v_accvgpr_write_b32 a120, v100
    v_accvgpr_write_b32 a121, v101
    v_accvgpr_write_b32 a122, v102
    v_accvgpr_write_b32 a123, v103
    v_accvgpr_read_b32 v100, a124
    v_accvgpr_read_b32 v101, a125
    v_accvgpr_read_b32 v102, a126
    v_accvgpr_read_b32 v103, a127
    v_mul_f32 v100, v100, v27
    v_mul_f32 v101, v101, v27
    v_mul_f32 v102, v102, v27
    v_mul_f32 v103, v103, v27
    v_accvgpr_write_b32 a124, v100
    v_accvgpr_write_b32 a125, v101
    v_accvgpr_write_b32 a126, v102
    v_accvgpr_write_b32 a127, v103
    s_waitcnt lgkmcnt(0)
    s_nop 1
    v_mfma_f32_16x16x32_bf16 a[0:3], a[160:163], v[72:75], a[0:3]
    v_mfma_f32_16x16x32_bf16 a[4:7], a[160:163], v[76:79], a[4:7]
    v_mfma_f32_16x16x32_bf16 a[8:11], a[160:163], v[80:83], a[8:11]
    v_mfma_f32_16x16x32_bf16 a[12:15], a[160:163], v[84:87], a[12:15]
    v_mfma_f32_16x16x32_bf16 a[16:19], a[164:167], v[72:75], a[16:19]
    v_mfma_f32_16x16x32_bf16 a[20:23], a[164:167], v[76:79], a[20:23]
    v_mfma_f32_16x16x32_bf16 a[24:27], a[164:167], v[80:83], a[24:27]
    v_mfma_f32_16x16x32_bf16 a[28:31], a[164:167], v[84:87], a[28:31]
    v_mfma_f32_16x16x32_bf16 a[32:35], a[168:171], v[72:75], a[32:35]
    v_mfma_f32_16x16x32_bf16 a[36:39], a[168:171], v[76:79], a[36:39]
    v_mfma_f32_16x16x32_bf16 a[40:43], a[168:171], v[80:83], a[40:43]
    v_mfma_f32_16x16x32_bf16 a[44:47], a[168:171], v[84:87], a[44:47]
    v_mfma_f32_16x16x32_bf16 a[48:51], a[172:175], v[72:75], a[48:51]
    v_mfma_f32_16x16x32_bf16 a[52:55], a[172:175], v[76:79], a[52:55]
    v_mfma_f32_16x16x32_bf16 a[56:59], a[172:175], v[80:83], a[56:59]
    v_mfma_f32_16x16x32_bf16 a[60:63], a[172:175], v[84:87], a[60:63]
    v_mfma_f32_16x16x32_bf16 a[64:67], a[176:179], v[72:75], a[64:67]
    v_mfma_f32_16x16x32_bf16 a[68:71], a[176:179], v[76:79], a[68:71]
    v_mfma_f32_16x16x32_bf16 a[72:75], a[176:179], v[80:83], a[72:75]
    v_mfma_f32_16x16x32_bf16 a[76:79], a[176:179], v[84:87], a[76:79]
    v_mfma_f32_16x16x32_bf16 a[80:83], a[180:183], v[72:75], a[80:83]
    v_mfma_f32_16x16x32_bf16 a[84:87], a[180:183], v[76:79], a[84:87]
    v_mfma_f32_16x16x32_bf16 a[88:91], a[180:183], v[80:83], a[88:91]
    v_mfma_f32_16x16x32_bf16 a[92:95], a[180:183], v[84:87], a[92:95]
    v_mfma_f32_16x16x32_bf16 a[96:99], a[184:187], v[72:75], a[96:99]
    v_mfma_f32_16x16x32_bf16 a[100:103], a[184:187], v[76:79], a[100:103]
    v_mfma_f32_16x16x32_bf16 a[104:107], a[184:187], v[80:83], a[104:107]
    v_mfma_f32_16x16x32_bf16 a[108:111], a[184:187], v[84:87], a[108:111]
    v_mfma_f32_16x16x32_bf16 a[112:115], a[188:191], v[72:75], a[112:115]
    v_mfma_f32_16x16x32_bf16 a[116:119], a[188:191], v[76:79], a[116:119]
    v_mfma_f32_16x16x32_bf16 a[120:123], a[188:191], v[80:83], a[120:123]
    v_mfma_f32_16x16x32_bf16 a[124:127], a[188:191], v[84:87], a[124:127]
    s_add_u32 s36, s36, 0x2000
    s_cmp_lt_u32 s36, 0x80000
    s_nop 7
    s_cbranch_scc1 K1_fb_loop
    v_mov_b32 v88, v17
    v_mov_b32 v89, v18
    v_mov_b32 v90, v19
    v_mov_b32 v91, v20
    v_permlane32_swap_b32 v17, v88
    v_permlane32_swap_b32 v18, v89
    v_permlane32_swap_b32 v19, v90
    v_permlane32_swap_b32 v20, v91
    v_add_f32 v17, v17, v88
    v_add_f32 v18, v18, v89
    v_add_f32 v19, v19, v90
    v_add_f32 v20, v20, v91
    v_mov_b32 v88, v17
    v_mov_b32 v89, v18
    v_mov_b32 v90, v19
    v_mov_b32 v91, v20
    v_permlane16_swap_b32 v17, v88
    v_permlane16_swap_b32 v18, v89
    v_permlane16_swap_b32 v19, v90
    v_permlane16_swap_b32 v20, v91
    v_add_f32 v17, v17, v88
    v_add_f32 v18, v18, v89
    v_add_f32 v19, v19, v90
    v_add_f32 v20, v20, v91
    s_barrier
    s_mov_b32 s16, s68
    s_mov_b32 s17, s69
    s_mov_b32 s18, 0x21c000
    s_mov_b32 s19, 0x20000
    s_add_u32 s20, s64, 0x300000
    s_addc_u32 s21, s65, 0
    s_mov_b32 s22, 0x6c0000
    s_mov_b32 s23, 0x20000
    s_mul_i32 s32, s46, 0x8c000
    s_mul_i32 s33, s46, 0x1c0000
    s_mul_i32 s34, s41, 0x1400
    s_add_u32 m0, s34, 0x20000
    s_nop 0
    buffer_load_dwordx4 v192, s[16:19], s32 offen offset:0 lds
    buffer_load_dwordx4 v193, s[16:19], s32 offen offset:1024 lds
    buffer_load_dwordx4 v194, s[16:19], s32 offen offset:2048 lds
    buffer_load_dwordx4 v195, s[16:19], s32 offen offset:3072 lds
    s_add_u32 m0, s34, 0x21000
    s_nop 0
    buffer_load_dwordx4 v196, s[16:19], s32 offen offset:0 lds
    s_add_u32 s32, s32, 0x14000
    buffer_load_dwordx4 a[192:195], v197, s[20:23], s33 offen offset:0 sc1
    buffer_load_dwordx4 a[196:199], v197, s[20:23], s33 offen offset:1024 sc1
    buffer_load_dwordx4 a[200:203], v198, s[20:23], s33 offen offset:0 sc1
    buffer_load_dwordx4 a[204:207], v198, s[20:23], s33 offen offset:1024 sc1
    s_add_u32 s33, s33, 0x40000
    s_add_u32 m0, s34, 0
    s_nop 0
    buffer_load_dwordx4 v192, s[16:19], s32 offen offset:0 lds
    buffer_load_dwordx4 v193, s[16:19], s32 offen offset:1024 lds
    buffer_load_dwordx4 v194, s[16:19], s32 offen offset:2048 lds
    buffer_load_dwordx4 v195, s[16:19], s32 offen offset:3072 lds
    s_add_u32 m0, s34, 0x1000
    s_nop 0
    buffer_load_dwordx4 v196, s[16:19], s32 offen offset:0 lds
    s_add_u32 s32, s32, 0x14000
    s_add_u32 m0, s34, 0x10000
    s_nop 0
    buffer_load_dwordx4 v192, s[16:19], s32 offen offset:0 lds
    buffer_load_dwordx4 v193, s[16:19], s32 offen offset:1024 lds
    buffer_load_dwordx4 v194, s[16:19], s32 offen offset:2048 lds
    buffer_load_dwordx4 v195, s[16:19], s32 offen offset:3072 lds
    s_add_u32 m0, s34, 0x11000
    s_nop 0
    buffer_load_dwordx4 v196, s[16:19], s32 offen offset:0 lds
    s_add_u32 s32, s32, 0x14000
    buffer_load_dwordx4 a[208:211], v197, s[20:23], s33 offen offset:0 sc1
    buffer_load_dwordx4 a[212:215], v197, s[20:23], s33 offen offset:1024 sc1
    buffer_load_dwordx4 a[216:219], v198, s[20:23], s33 offen offset:0 sc1
    buffer_load_dwordx4 a[220:223], v198, s[20:23], s33 offen offset:1024 sc1
    s_add_u32 s33, s33, 0x40000
    buffer_load_dwordx4 a[224:227], v197, s[20:23], s33 offen offset:0 sc1
    buffer_load_dwordx4 a[228:231], v197, s[20:23], s33 offen offset:1024 sc1
    buffer_load_dwordx4 a[232:235], v198, s[20:23], s33 offen offset:0 sc1
    buffer_load_dwordx4 a[236:239], v198, s[20:23], s33 offen offset:1024 sc1
    s_add_u32 s33, s33, 0x40000
    buffer_load_dword v92, v215, s[20:23], 0 offen sc1
    s_waitcnt vmcnt(0)
    s_barrier
    s_branch K1_norm
.section .rodata,"a"
.p2align 6
.amdhsa_kernel recurrent_scan__gqa_block_cached__mixer_channel_mlp__prompt_kernel
  .amdhsa_next_free_vgpr 512
  .amdhsa_next_free_sgpr 102
  .amdhsa_accum_offset 256
  .amdhsa_group_segment_fixed_size 0
  .amdhsa_kernarg_size 104
  .amdhsa_user_sgpr_count 2
  .amdhsa_user_sgpr_kernarg_segment_ptr 1
  .amdhsa_system_sgpr_workgroup_id_x 1
.end_amdhsa_kernel
.p2align 6
```
